```python
import torch

def _softmax(x, axis=-1):
    return torch.softmax(x, dim=axis)
def _gelu(x):
    return torch.nn.functional.gelu(x, approximate="tanh")
def _silu(x):
    return torch.nn.functional.silu(x)
def _sigmoid(x):
    return torch.sigmoid(x)
def _layernorm(x, axis=-1, eps=1e-5):
    m = x.mean(dim=axis, keepdim=True)
    v = x.var(dim=axis, keepdim=True, unbiased=False)
    return (x - m) / torch.sqrt(v + eps)
def _scatter_add(tgt, idx, src, axis=0):
    return tgt.clone().index_add_(axis, idx, src)
def _segment_sum(src, seg, n):
    out = torch.zeros((n,) + src.shape[1:], dtype=src.dtype)
    return out.index_add_(0, seg, src)
def _pad(x, pw):
    flat = tuple(v for pair in reversed(pw) for v in pair)
    return torch.nn.functional.pad(x, flat)

kernel_name = 'standalone__gqa_softmax__near_ridge'

def setup_inputs():

    _w = (lambda a: (lambda t: t.to(torch.bfloat16) if t.is_floating_point() else t)(torch.as_tensor(a)))
    B, Hq, Hkv, Sq, Sk, D = 16, 16, 8, 192, 512, 256
    return {
        "q": _w((lambda *s: torch.randn(*s, dtype=torch.bfloat16) * 0.8)(B, Hq, Sq, D)),
        "k": _w((lambda *s: torch.randn(*s, dtype=torch.bfloat16) * 0.8)(B, Hkv, Sk, D)),
        "v": _w((lambda *s: torch.randn(*s, dtype=torch.bfloat16) * 0.05)(B, Hkv, Sk, D)),
    }

def reference(q, k, v):
    B, Hq, Sq, D = q.shape
    Hkv = k.shape[1]
    rep = Hq // Hkv
    k = (lambda x, n, axis: torch.repeat_interleave(x, n, dim=axis))(k, rep, axis=1)
    v = (lambda x, n, axis: torch.repeat_interleave(x, n, dim=axis))(v, rep, axis=1)
    scale = D ** -0.5
    scores = torch.einsum("bhqd,bhkd->bhqk", q, k) * scale
    p = _softmax(scores, axis=-1)
    return torch.einsum("bhqk,bhkd->bhqd", p, v)
```

```asm
; @launch grid=(256,1,1) block=(256,1,1) lds=163840
.amdgcn_target "amdgcn-amd-amdhsa--gfx950"
.text
.globl standalone__gqa_softmax__near_ridge_kernel
.p2align 8
.type standalone__gqa_softmax__near_ridge_kernel,@function
standalone__gqa_softmax__near_ridge_kernel:
    s_cmp_ge_u32 s2, 256
    s_cbranch_scc1 L_end
    s_load_dwordx4 s[36:39], s[0:1], 0
    s_load_dwordx4 s[40:43], s[0:1], 16
    v_lshrrev_b32 v41, 6, v0
    v_and_b32 v13, 63, v0
    s_lshr_b32 s34, s2, 3
    s_lshl_b32 s34, s34, 2
    v_readfirstlane_b32 s20, v41
    s_getpc_b64 s[56:57]
L_pc:
    s_add_u32 s56, s56, L_main-L_pc
    s_addc_u32 s57, s57, 0
    v_lshlrev_b32 v42, 4, v13
    v_mov_b32 v43, s57
    s_add_u32 s34, s34, s20
    s_lshl_b32 s34, s34, 10
    v_add_u32 v42, s34, v42
    v_add_co_u32 v42, vcc, s56, v42
    s_cmp_lt_u32 s34, L_codeend-L_main
    s_nop 0
    v_addc_co_u32 v43, vcc, 0, v43, vcc
    s_cbranch_scc0 L_nopre
    global_load_dwordx4 a[192:195], v[42:43], off
L_nopre:
    s_lshr_b32 s3, s2, 4
    s_and_b32 s32, s2, 7
    s_lshl_b32 s32, s32, 4
    s_add_u32 s3, s3, s32
    s_lshr_b32 s32, s2, 3
    s_and_b32 s32, s32, 1
    s_lshl_b32 s33, s3, 1
    s_add_u32 s32, s33, s32
    s_mul_i32 s98, s32, 98304
    s_lshl_b32 s99, s3, 18
    s_lshl_b32 s23, s20, 12
    s_lshl_b32 s24, s20, 14
    v_lshrrev_b32 v41, 3, v13
    v_and_b32 v42, 6, v41
    v_and_b32 v43, 7, v13
    v_xor_b32 v43, v43, v42
    v_lshlrev_b32 v43, 4, v43
    v_lshl_add_u32 v1, v41, 9, v43
    v_and_b32 v41, 7, v13
    v_lshrrev_b32 v42, 4, v13
    s_mul_i32 s35, s20, 48
    v_add_u32 v41, s35, v41
    v_bfe_u32 v43, v13, 3, 1
    v_lshl_add_u32 v42, v43, 2, v42
    v_lshlrev_b32 v41, 9, v41
    v_lshl_add_u32 v6, v42, 4, v41
    s_mov_b32 s22, 0
    s_mov_b32 s21, 0x3db8aa3b
    s_mov_b32 s47, 0x4b800000
    s_mov_b32 s44, 8192
    s_mov_b32 s45, 16384
    s_mov_b32 s80, 4096
    s_mov_b32 s81, 8192
    s_mov_b32 s82, 12288
    s_mov_b32 s83, 16384
    s_mov_b32 s84, 20480
    s_mov_b32 s86, 0x00ff00ff
    s_mov_b32 s87, 0x00ff00ff
    s_mov_b32 s88, 0x3db8aa3b
    s_mov_b32 s89, 0x3db8aa3b
    s_mov_b32 s10, 262144
    s_mov_b32 s11, 0x20000
    s_mov_b32 s6, 98304
    s_mov_b32 s7, 0x20000
    s_mov_b32 s14, 262144
    s_mov_b32 s15, 0x20000
    s_mov_b32 s18, 98304
    s_mov_b32 s19, 0x20000
    s_waitcnt lgkmcnt(0)
    s_add_u32 s8, s38, s99
    s_addc_u32 s9, s39, 0
    s_add_u32 s4, s36, s98
    s_addc_u32 s5, s37, 0
    s_add_u32 s12, s40, s99
    s_addc_u32 s13, s41, 0
    s_add_u32 s16, s42, s98
    s_addc_u32 s17, s43, 0
L_restart:
    s_add_u32 s33, s23, 0
    s_add_u32 m0, s23, 0
    s_nop 0
    buffer_load_dwordx4 v1, s[8:11], s33 offen offset:0 nt lds
    s_add_u32 m0, s23, 896
    s_nop 0
    buffer_load_dwordx4 v1, s[8:11], s33 offen offset:128 nt lds
    s_add_u32 m0, s23, 1792
    s_nop 0
    buffer_load_dwordx4 v1, s[8:11], s33 offen offset:256 nt lds
    s_add_u32 m0, s23, 2688
    s_nop 0
    buffer_load_dwordx4 v1, s[8:11], s33 offen offset:384 nt lds
    buffer_load_dwordx4 v[64:67], v6, s[4:7], 0 offen offset:0 nt
    buffer_load_dwordx4 v[68:71], v6, s[4:7], s80 offen offset:0 nt
    buffer_load_dwordx4 v[72:75], v6, s[4:7], 0 offen offset:128 nt
    buffer_load_dwordx4 v[76:79], v6, s[4:7], s80 offen offset:128 nt
    buffer_load_dwordx4 v[80:83], v6, s[4:7], 0 offen offset:256 nt
    buffer_load_dwordx4 v[84:87], v6, s[4:7], s80 offen offset:256 nt
    buffer_load_dwordx4 v[88:91], v6, s[4:7], 0 offen offset:384 nt
    v_and_b32 v41, 15, v13
    v_lshrrev_b32 v42, 4, v13
    v_lshrrev_b32 v43, 3, v41
    v_lshlrev_b32 v43, 12, v43
    v_and_b32 v44, 7, v41
    v_lshl_add_u32 v43, v44, 7, v43
    v_and_b32 v44, 6, v41
    v_xor_b32 v44, v44, v42
    v_lshl_add_u32 v2, v44, 4, v43
    v_xor_b32 v44, 4, v44
    v_lshl_add_u32 v3, v44, 4, v43
    v_lshrrev_b32 v43, 5, v13
    v_lshlrev_b32 v43, 10, v43
    v_lshrrev_b32 v44, 2, v13
    v_and_b32 v44, 7, v44
    v_lshl_add_u32 v43, v44, 7, v43
    v_and_b32 v45, 3, v13
    v_lshl_add_u32 v43, v45, 3, v43
    v_lshrrev_b32 v44, 1, v44
    v_xor_b32 v45, 0, v44
    v_lshl_add_u32 v49, v45, 5, v43
    v_xor_b32 v45, 1, v44
    v_lshl_add_u32 v50, v45, 5, v43
    v_xor_b32 v45, 2, v44
    v_lshl_add_u32 v51, v45, 5, v43
    v_xor_b32 v45, 3, v44
    v_lshl_add_u32 v52, v45, 5, v43
    v_mov_b32 v14, 0x3f803f80
    v_accvgpr_write_b32 a160, v14
    v_accvgpr_write_b32 a161, v14
    v_accvgpr_write_b32 a162, v14
    v_accvgpr_write_b32 a163, v14
    s_branch L_main
.p2align 12
L_main:
    buffer_load_dwordx4 v[92:95], v6, s[4:7], s80 offen offset:384 nt
    buffer_load_dwordx4 v[96:99], v6, s[4:7], s81 offen offset:0 nt
    s_waitcnt vmcnt(9)
    s_barrier
    ds_read_b128 a[96:99], v2 offset:0
    ds_read_b128 a[100:103], v3 offset:0
    ds_read_b128 a[104:107], v2 offset:1024
    ds_read_b128 a[108:111], v3 offset:1024
    ds_read_b128 a[112:115], v2 offset:2048
    ds_read_b128 a[116:119], v3 offset:2048
    ds_read_b128 a[120:123], v2 offset:3072
    ds_read_b128 a[124:127], v3 offset:3072
    ds_read_b128 a[128:131], v2 offset:8192
    ds_read_b128 a[132:135], v3 offset:8192
    ds_read_b128 a[136:139], v2 offset:9216
    ds_read_b128 a[140:143], v3 offset:9216
    ds_read_b128 a[144:147], v2 offset:10240
    ds_read_b128 a[148:151], v3 offset:10240
    ds_read_b128 a[152:155], v2 offset:11264
    ds_read_b128 a[156:159], v3 offset:11264
    buffer_load_dwordx4 v[100:103], v6, s[4:7], s82 offen offset:0 nt
    s_waitcnt vmcnt(8)
    s_mov_b64 vcc, s[86:87]
    v_cndmask_b32_dpp v56, v68, v64, vcc row_ror:8 row_mask:0xf bank_mask:0xf
    v_cndmask_b32_dpp v57, v69, v65, vcc row_ror:8 row_mask:0xf bank_mask:0xf
    v_cndmask_b32_dpp v58, v70, v66, vcc row_ror:8 row_mask:0xf bank_mask:0xf
    v_cndmask_b32_dpp v59, v71, v67, vcc row_ror:8 row_mask:0xf bank_mask:0xf
    s_not_b64 vcc, vcc
    v_cndmask_b32_dpp v68, v64, v68, vcc row_ror:8 row_mask:0xf bank_mask:0xf
    v_cndmask_b32_dpp v69, v65, v69, vcc row_ror:8 row_mask:0xf bank_mask:0xf
    v_cndmask_b32_dpp v70, v66, v70, vcc row_ror:8 row_mask:0xf bank_mask:0xf
    v_cndmask_b32_dpp v71, v67, v71, vcc row_ror:8 row_mask:0xf bank_mask:0xf
    v_lshlrev_b32 v42, 16, v56
    v_and_b32 v43, 0xffff0000, v56
    v_pk_mul_f32 v[42:43], v[42:43], s[88:89]
    v_cvt_pk_bf16_f32 v56, v42, v43
    v_lshlrev_b32 v44, 16, v57
    v_and_b32 v45, 0xffff0000, v57
    v_pk_mul_f32 v[44:45], v[44:45], s[88:89]
    v_cvt_pk_bf16_f32 v57, v44, v45
    v_lshlrev_b32 v42, 16, v58
    v_and_b32 v43, 0xffff0000, v58
    v_pk_mul_f32 v[42:43], v[42:43], s[88:89]
    v_cvt_pk_bf16_f32 v58, v42, v43
    v_lshlrev_b32 v44, 16, v59
    v_and_b32 v45, 0xffff0000, v59
    v_pk_mul_f32 v[44:45], v[44:45], s[88:89]
    v_cvt_pk_bf16_f32 v59, v44, v45
    v_accvgpr_write_b32 a0, v56
    v_accvgpr_write_b32 a1, v57
    v_accvgpr_write_b32 a2, v58
    v_accvgpr_write_b32 a3, v59
    v_lshlrev_b32 v42, 16, v68
    v_and_b32 v43, 0xffff0000, v68
    v_pk_mul_f32 v[42:43], v[42:43], s[88:89]
    v_cvt_pk_bf16_f32 v68, v42, v43
    v_lshlrev_b32 v44, 16, v69
    v_and_b32 v45, 0xffff0000, v69
    v_pk_mul_f32 v[44:45], v[44:45], s[88:89]
    v_cvt_pk_bf16_f32 v69, v44, v45
    v_lshlrev_b32 v42, 16, v70
    v_and_b32 v43, 0xffff0000, v70
    v_pk_mul_f32 v[42:43], v[42:43], s[88:89]
    v_cvt_pk_bf16_f32 v70, v42, v43
    v_lshlrev_b32 v44, 16, v71
    v_and_b32 v45, 0xffff0000, v71
    v_pk_mul_f32 v[44:45], v[44:45], s[88:89]
    v_cvt_pk_bf16_f32 v71, v44, v45
    v_accvgpr_write_b32 a4, v68
    v_accvgpr_write_b32 a5, v69
    v_accvgpr_write_b32 a6, v70
    v_accvgpr_write_b32 a7, v71
    buffer_load_dwordx4 v[104:107], v6, s[4:7], s81 offen offset:128 nt
    buffer_load_dwordx4 v[108:111], v6, s[4:7], s82 offen offset:128 nt
    s_waitcnt vmcnt(8)
    s_mov_b64 vcc, s[86:87]
    v_cndmask_b32_dpp v56, v76, v72, vcc row_ror:8 row_mask:0xf bank_mask:0xf
    v_cndmask_b32_dpp v57, v77, v73, vcc row_ror:8 row_mask:0xf bank_mask:0xf
    v_cndmask_b32_dpp v58, v78, v74, vcc row_ror:8 row_mask:0xf bank_mask:0xf
    v_cndmask_b32_dpp v59, v79, v75, vcc row_ror:8 row_mask:0xf bank_mask:0xf
    s_not_b64 vcc, vcc
    v_cndmask_b32_dpp v76, v72, v76, vcc row_ror:8 row_mask:0xf bank_mask:0xf
    v_cndmask_b32_dpp v77, v73, v77, vcc row_ror:8 row_mask:0xf bank_mask:0xf
    v_cndmask_b32_dpp v78, v74, v78, vcc row_ror:8 row_mask:0xf bank_mask:0xf
    v_cndmask_b32_dpp v79, v75, v79, vcc row_ror:8 row_mask:0xf bank_mask:0xf
    v_lshlrev_b32 v42, 16, v56
    v_and_b32 v43, 0xffff0000, v56
    v_pk_mul_f32 v[42:43], v[42:43], s[88:89]
    v_cvt_pk_bf16_f32 v56, v42, v43
    v_lshlrev_b32 v44, 16, v57
    v_and_b32 v45, 0xffff0000, v57
    v_pk_mul_f32 v[44:45], v[44:45], s[88:89]
    v_cvt_pk_bf16_f32 v57, v44, v45
    v_lshlrev_b32 v42, 16, v58
    v_and_b32 v43, 0xffff0000, v58
    v_pk_mul_f32 v[42:43], v[42:43], s[88:89]
    v_cvt_pk_bf16_f32 v58, v42, v43
    v_lshlrev_b32 v44, 16, v59
    v_and_b32 v45, 0xffff0000, v59
    v_pk_mul_f32 v[44:45], v[44:45], s[88:89]
    v_cvt_pk_bf16_f32 v59, v44, v45
    v_accvgpr_write_b32 a8, v56
    v_accvgpr_write_b32 a9, v57
    v_accvgpr_write_b32 a10, v58
    v_accvgpr_write_b32 a11, v59
    v_lshlrev_b32 v42, 16, v76
    v_and_b32 v43, 0xffff0000, v76
    v_pk_mul_f32 v[42:43], v[42:43], s[88:89]
    v_cvt_pk_bf16_f32 v76, v42, v43
    v_lshlrev_b32 v44, 16, v77
    v_and_b32 v45, 0xffff0000, v77
    v_pk_mul_f32 v[44:45], v[44:45], s[88:89]
    v_cvt_pk_bf16_f32 v77, v44, v45
    v_lshlrev_b32 v42, 16, v78
    v_and_b32 v43, 0xffff0000, v78
    v_pk_mul_f32 v[42:43], v[42:43], s[88:89]
    v_cvt_pk_bf16_f32 v78, v42, v43
    v_lshlrev_b32 v44, 16, v79
    v_and_b32 v45, 0xffff0000, v79
    v_pk_mul_f32 v[44:45], v[44:45], s[88:89]
    v_cvt_pk_bf16_f32 v79, v44, v45
    v_accvgpr_write_b32 a12, v76
    v_accvgpr_write_b32 a13, v77
    v_accvgpr_write_b32 a14, v78
    v_accvgpr_write_b32 a15, v79
    buffer_load_dwordx4 v[112:115], v6, s[4:7], s81 offen offset:256 nt
    buffer_load_dwordx4 v[116:119], v6, s[4:7], s82 offen offset:256 nt
    s_waitcnt vmcnt(8)
    s_mov_b64 vcc, s[86:87]
    v_cndmask_b32_dpp v56, v84, v80, vcc row_ror:8 row_mask:0xf bank_mask:0xf
    v_cndmask_b32_dpp v57, v85, v81, vcc row_ror:8 row_mask:0xf bank_mask:0xf
    v_cndmask_b32_dpp v58, v86, v82, vcc row_ror:8 row_mask:0xf bank_mask:0xf
    v_cndmask_b32_dpp v59, v87, v83, vcc row_ror:8 row_mask:0xf bank_mask:0xf
    s_not_b64 vcc, vcc
    v_cndmask_b32_dpp v84, v80, v84, vcc row_ror:8 row_mask:0xf bank_mask:0xf
    v_cndmask_b32_dpp v85, v81, v85, vcc row_ror:8 row_mask:0xf bank_mask:0xf
    v_cndmask_b32_dpp v86, v82, v86, vcc row_ror:8 row_mask:0xf bank_mask:0xf
    v_cndmask_b32_dpp v87, v83, v87, vcc row_ror:8 row_mask:0xf bank_mask:0xf
    v_lshlrev_b32 v42, 16, v56
    v_and_b32 v43, 0xffff0000, v56
    v_pk_mul_f32 v[42:43], v[42:43], s[88:89]
    v_cvt_pk_bf16_f32 v56, v42, v43
    v_lshlrev_b32 v44, 16, v57
    v_and_b32 v45, 0xffff0000, v57
    v_pk_mul_f32 v[44:45], v[44:45], s[88:89]
    v_cvt_pk_bf16_f32 v57, v44, v45
    v_lshlrev_b32 v42, 16, v58
    v_and_b32 v43, 0xffff0000, v58
    v_pk_mul_f32 v[42:43], v[42:43], s[88:89]
    v_cvt_pk_bf16_f32 v58, v42, v43
    v_lshlrev_b32 v44, 16, v59
    v_and_b32 v45, 0xffff0000, v59
    v_pk_mul_f32 v[44:45], v[44:45], s[88:89]
    v_cvt_pk_bf16_f32 v59, v44, v45
    v_accvgpr_write_b32 a16, v56
    v_accvgpr_write_b32 a17, v57
    v_accvgpr_write_b32 a18, v58
    v_accvgpr_write_b32 a19, v59
    v_lshlrev_b32 v42, 16, v84
    v_and_b32 v43, 0xffff0000, v84
    v_pk_mul_f32 v[42:43], v[42:43], s[88:89]
    v_cvt_pk_bf16_f32 v84, v42, v43
    v_lshlrev_b32 v44, 16, v85
    v_and_b32 v45, 0xffff0000, v85
    v_pk_mul_f32 v[44:45], v[44:45], s[88:89]
    v_cvt_pk_bf16_f32 v85, v44, v45
    v_lshlrev_b32 v42, 16, v86
    v_and_b32 v43, 0xffff0000, v86
    v_pk_mul_f32 v[42:43], v[42:43], s[88:89]
    v_cvt_pk_bf16_f32 v86, v42, v43
    v_lshlrev_b32 v44, 16, v87
    v_and_b32 v45, 0xffff0000, v87
    v_pk_mul_f32 v[44:45], v[44:45], s[88:89]
    v_cvt_pk_bf16_f32 v87, v44, v45
    v_accvgpr_write_b32 a20, v84
    v_accvgpr_write_b32 a21, v85
    v_accvgpr_write_b32 a22, v86
    v_accvgpr_write_b32 a23, v87
    buffer_load_dwordx4 v[120:123], v6, s[4:7], s81 offen offset:384 nt
    buffer_load_dwordx4 v[124:127], v6, s[4:7], s82 offen offset:384 nt
    s_waitcnt vmcnt(8) lgkmcnt(8)
    s_mov_b64 vcc, s[86:87]
    v_cndmask_b32_dpp v56, v92, v88, vcc row_ror:8 row_mask:0xf bank_mask:0xf
    v_cndmask_b32_dpp v57, v93, v89, vcc row_ror:8 row_mask:0xf bank_mask:0xf
    v_cndmask_b32_dpp v58, v94, v90, vcc row_ror:8 row_mask:0xf bank_mask:0xf
    v_cndmask_b32_dpp v59, v95, v91, vcc row_ror:8 row_mask:0xf bank_mask:0xf
    s_not_b64 vcc, vcc
    v_cndmask_b32_dpp v92, v88, v92, vcc row_ror:8 row_mask:0xf bank_mask:0xf
    v_cndmask_b32_dpp v93, v89, v93, vcc row_ror:8 row_mask:0xf bank_mask:0xf
    v_cndmask_b32_dpp v94, v90, v94, vcc row_ror:8 row_mask:0xf bank_mask:0xf
    v_cndmask_b32_dpp v95, v91, v95, vcc row_ror:8 row_mask:0xf bank_mask:0xf
    v_lshlrev_b32 v42, 16, v56
    v_and_b32 v43, 0xffff0000, v56
    v_pk_mul_f32 v[42:43], v[42:43], s[88:89]
    v_cvt_pk_bf16_f32 v56, v42, v43
    v_lshlrev_b32 v44, 16, v57
    v_and_b32 v45, 0xffff0000, v57
    v_pk_mul_f32 v[44:45], v[44:45], s[88:89]
    v_cvt_pk_bf16_f32 v57, v44, v45
    v_lshlrev_b32 v42, 16, v58
    v_and_b32 v43, 0xffff0000, v58
    v_pk_mul_f32 v[42:43], v[42:43], s[88:89]
    v_cvt_pk_bf16_f32 v58, v42, v43
    v_lshlrev_b32 v44, 16, v59
    v_and_b32 v45, 0xffff0000, v59
    v_pk_mul_f32 v[44:45], v[44:45], s[88:89]
    v_cvt_pk_bf16_f32 v59, v44, v45
    v_accvgpr_write_b32 a24, v56
    v_accvgpr_write_b32 a25, v57
    v_accvgpr_write_b32 a26, v58
    v_accvgpr_write_b32 a27, v59
    v_lshlrev_b32 v42, 16, v92
    v_and_b32 v43, 0xffff0000, v92
    v_pk_mul_f32 v[42:43], v[42:43], s[88:89]
    v_cvt_pk_bf16_f32 v92, v42, v43
    v_lshlrev_b32 v44, 16, v93
    v_and_b32 v45, 0xffff0000, v93
    v_pk_mul_f32 v[44:45], v[44:45], s[88:89]
    v_cvt_pk_bf16_f32 v93, v44, v45
    v_lshlrev_b32 v42, 16, v94
    v_and_b32 v43, 0xffff0000, v94
    v_pk_mul_f32 v[42:43], v[42:43], s[88:89]
    v_cvt_pk_bf16_f32 v94, v42, v43
    v_lshlrev_b32 v44, 16, v95
    v_and_b32 v45, 0xffff0000, v95
    v_pk_mul_f32 v[44:45], v[44:45], s[88:89]
    v_cvt_pk_bf16_f32 v95, v44, v45
    v_accvgpr_write_b32 a28, v92
    v_accvgpr_write_b32 a29, v93
    v_accvgpr_write_b32 a30, v94
    v_accvgpr_write_b32 a31, v95
    v_mfma_f32_16x16x32_bf16 v[16:19], a[96:99], a[0:3], 0
    v_mfma_f32_16x16x32_bf16 v[16:19], a[100:103], a[4:7], v[16:19]
    v_mfma_f32_16x16x32_bf16 v[16:19], a[104:107], a[8:11], v[16:19]
    v_mfma_f32_16x16x32_bf16 v[16:19], a[108:111], a[12:15], v[16:19]
    v_mfma_f32_16x16x32_bf16 v[16:19], a[112:115], a[16:19], v[16:19]
    v_mfma_f32_16x16x32_bf16 v[16:19], a[116:119], a[20:23], v[16:19]
    v_mfma_f32_16x16x32_bf16 v[16:19], a[120:123], a[24:27], v[16:19]
    v_mfma_f32_16x16x32_bf16 v[16:19], a[124:127], a[28:31], v[16:19]
    buffer_load_dwordx4 v[128:131], v6, s[4:7], s83 offen offset:0 nt
    buffer_load_dwordx4 v[132:135], v6, s[4:7], s84 offen offset:0 nt
    s_waitcnt vmcnt(8)
    s_mov_b64 vcc, s[86:87]
    v_cndmask_b32_dpp v56, v100, v96, vcc row_ror:8 row_mask:0xf bank_mask:0xf
    v_cndmask_b32_dpp v57, v101, v97, vcc row_ror:8 row_mask:0xf bank_mask:0xf
    v_cndmask_b32_dpp v58, v102, v98, vcc row_ror:8 row_mask:0xf bank_mask:0xf
    v_cndmask_b32_dpp v59, v103, v99, vcc row_ror:8 row_mask:0xf bank_mask:0xf
    s_not_b64 vcc, vcc
    v_cndmask_b32_dpp v100, v96, v100, vcc row_ror:8 row_mask:0xf bank_mask:0xf
    v_cndmask_b32_dpp v101, v97, v101, vcc row_ror:8 row_mask:0xf bank_mask:0xf
    v_cndmask_b32_dpp v102, v98, v102, vcc row_ror:8 row_mask:0xf bank_mask:0xf
    v_cndmask_b32_dpp v103, v99, v103, vcc row_ror:8 row_mask:0xf bank_mask:0xf
    v_lshlrev_b32 v42, 16, v56
    v_and_b32 v43, 0xffff0000, v56
    v_pk_mul_f32 v[42:43], v[42:43], s[88:89]
    v_cvt_pk_bf16_f32 v56, v42, v43
    v_lshlrev_b32 v44, 16, v57
    v_and_b32 v45, 0xffff0000, v57
    v_pk_mul_f32 v[44:45], v[44:45], s[88:89]
    v_cvt_pk_bf16_f32 v57, v44, v45
    v_lshlrev_b32 v42, 16, v58
    v_and_b32 v43, 0xffff0000, v58
    v_pk_mul_f32 v[42:43], v[42:43], s[88:89]
    v_cvt_pk_bf16_f32 v58, v42, v43
    v_lshlrev_b32 v44, 16, v59
    v_and_b32 v45, 0xffff0000, v59
    v_pk_mul_f32 v[44:45], v[44:45], s[88:89]
    v_cvt_pk_bf16_f32 v59, v44, v45
    v_accvgpr_write_b32 a32, v56
    v_accvgpr_write_b32 a33, v57
    v_accvgpr_write_b32 a34, v58
    v_accvgpr_write_b32 a35, v59
    v_lshlrev_b32 v42, 16, v100
    v_and_b32 v43, 0xffff0000, v100
    v_pk_mul_f32 v[42:43], v[42:43], s[88:89]
    v_cvt_pk_bf16_f32 v100, v42, v43
    v_lshlrev_b32 v44, 16, v101
    v_and_b32 v45, 0xffff0000, v101
    v_pk_mul_f32 v[44:45], v[44:45], s[88:89]
    v_cvt_pk_bf16_f32 v101, v44, v45
    v_lshlrev_b32 v42, 16, v102
    v_and_b32 v43, 0xffff0000, v102
    v_pk_mul_f32 v[42:43], v[42:43], s[88:89]
    v_cvt_pk_bf16_f32 v102, v42, v43
    v_lshlrev_b32 v44, 16, v103
    v_and_b32 v45, 0xffff0000, v103
    v_pk_mul_f32 v[44:45], v[44:45], s[88:89]
    v_cvt_pk_bf16_f32 v103, v44, v45
    v_accvgpr_write_b32 a36, v100
    v_accvgpr_write_b32 a37, v101
    v_accvgpr_write_b32 a38, v102
    v_accvgpr_write_b32 a39, v103
    s_mov_b64 exec, 0
    s_cmp_eq_u32 s20, 0
    s_cbranch_scc1 L_pg0
    s_cmp_eq_u32 s20, 1
    s_cbranch_scc1 L_pg1
    s_cmp_eq_u32 s20, 2
    s_cbranch_scc1 L_pg2
    s_branch L_pg3
L_back:
    s_mov_b64 exec, -1
    buffer_load_dwordx4 v[136:139], v6, s[4:7], s83 offen offset:128 nt
    buffer_load_dwordx4 v[140:143], v6, s[4:7], s84 offen offset:128 nt
    s_waitcnt vmcnt(8)
    s_mov_b64 vcc, s[86:87]
    v_cndmask_b32_dpp v56, v108, v104, vcc row_ror:8 row_mask:0xf bank_mask:0xf
    v_cndmask_b32_dpp v57, v109, v105, vcc row_ror:8 row_mask:0xf bank_mask:0xf
    v_cndmask_b32_dpp v58, v110, v106, vcc row_ror:8 row_mask:0xf bank_mask:0xf
    v_cndmask_b32_dpp v59, v111, v107, vcc row_ror:8 row_mask:0xf bank_mask:0xf
    s_not_b64 vcc, vcc
    v_cndmask_b32_dpp v108, v104, v108, vcc row_ror:8 row_mask:0xf bank_mask:0xf
    v_cndmask_b32_dpp v109, v105, v109, vcc row_ror:8 row_mask:0xf bank_mask:0xf
    v_cndmask_b32_dpp v110, v106, v110, vcc row_ror:8 row_mask:0xf bank_mask:0xf
    v_cndmask_b32_dpp v111, v107, v111, vcc row_ror:8 row_mask:0xf bank_mask:0xf
    v_lshlrev_b32 v42, 16, v56
    v_and_b32 v43, 0xffff0000, v56
    v_pk_mul_f32 v[42:43], v[42:43], s[88:89]
    v_cvt_pk_bf16_f32 v56, v42, v43
    v_lshlrev_b32 v44, 16, v57
    v_and_b32 v45, 0xffff0000, v57
    v_pk_mul_f32 v[44:45], v[44:45], s[88:89]
    v_cvt_pk_bf16_f32 v57, v44, v45
    v_lshlrev_b32 v42, 16, v58
    v_and_b32 v43, 0xffff0000, v58
    v_pk_mul_f32 v[42:43], v[42:43], s[88:89]
    v_cvt_pk_bf16_f32 v58, v42, v43
    v_lshlrev_b32 v44, 16, v59
    v_and_b32 v45, 0xffff0000, v59
    v_pk_mul_f32 v[44:45], v[44:45], s[88:89]
    v_cvt_pk_bf16_f32 v59, v44, v45
    v_accvgpr_write_b32 a40, v56
    v_accvgpr_write_b32 a41, v57
    v_accvgpr_write_b32 a42, v58
    v_accvgpr_write_b32 a43, v59
    v_lshlrev_b32 v42, 16, v108
    v_and_b32 v43, 0xffff0000, v108
    v_pk_mul_f32 v[42:43], v[42:43], s[88:89]
    v_cvt_pk_bf16_f32 v108, v42, v43
    v_lshlrev_b32 v44, 16, v109
    v_and_b32 v45, 0xffff0000, v109
    v_pk_mul_f32 v[44:45], v[44:45], s[88:89]
    v_cvt_pk_bf16_f32 v109, v44, v45
    v_lshlrev_b32 v42, 16, v110
    v_and_b32 v43, 0xffff0000, v110
    v_pk_mul_f32 v[42:43], v[42:43], s[88:89]
    v_cvt_pk_bf16_f32 v110, v42, v43
    v_lshlrev_b32 v44, 16, v111
    v_and_b32 v45, 0xffff0000, v111
    v_pk_mul_f32 v[44:45], v[44:45], s[88:89]
    v_cvt_pk_bf16_f32 v111, v44, v45
    v_accvgpr_write_b32 a44, v108
    v_accvgpr_write_b32 a45, v109
    v_accvgpr_write_b32 a46, v110
    v_accvgpr_write_b32 a47, v111
    buffer_load_dwordx4 v[144:147], v6, s[4:7], s83 offen offset:256 nt
    buffer_load_dwordx4 v[148:151], v6, s[4:7], s84 offen offset:256 nt
    s_waitcnt vmcnt(8)
    s_mov_b64 vcc, s[86:87]
    v_cndmask_b32_dpp v56, v116, v112, vcc row_ror:8 row_mask:0xf bank_mask:0xf
    v_cndmask_b32_dpp v57, v117, v113, vcc row_ror:8 row_mask:0xf bank_mask:0xf
    v_cndmask_b32_dpp v58, v118, v114, vcc row_ror:8 row_mask:0xf bank_mask:0xf
    v_cndmask_b32_dpp v59, v119, v115, vcc row_ror:8 row_mask:0xf bank_mask:0xf
    s_not_b64 vcc, vcc
    v_cndmask_b32_dpp v116, v112, v116, vcc row_ror:8 row_mask:0xf bank_mask:0xf
    v_cndmask_b32_dpp v117, v113, v117, vcc row_ror:8 row_mask:0xf bank_mask:0xf
    v_cndmask_b32_dpp v118, v114, v118, vcc row_ror:8 row_mask:0xf bank_mask:0xf
    v_cndmask_b32_dpp v119, v115, v119, vcc row_ror:8 row_mask:0xf bank_mask:0xf
    v_lshlrev_b32 v42, 16, v56
    v_and_b32 v43, 0xffff0000, v56
    v_pk_mul_f32 v[42:43], v[42:43], s[88:89]
    v_cvt_pk_bf16_f32 v56, v42, v43
    v_lshlrev_b32 v44, 16, v57
    v_and_b32 v45, 0xffff0000, v57
    v_pk_mul_f32 v[44:45], v[44:45], s[88:89]
    v_cvt_pk_bf16_f32 v57, v44, v45
    v_lshlrev_b32 v42, 16, v58
    v_and_b32 v43, 0xffff0000, v58
    v_pk_mul_f32 v[42:43], v[42:43], s[88:89]
    v_cvt_pk_bf16_f32 v58, v42, v43
    v_lshlrev_b32 v44, 16, v59
    v_and_b32 v45, 0xffff0000, v59
    v_pk_mul_f32 v[44:45], v[44:45], s[88:89]
    v_cvt_pk_bf16_f32 v59, v44, v45
    v_accvgpr_write_b32 a48, v56
    v_accvgpr_write_b32 a49, v57
    v_accvgpr_write_b32 a50, v58
    v_accvgpr_write_b32 a51, v59
    v_lshlrev_b32 v42, 16, v116
    v_and_b32 v43, 0xffff0000, v116
    v_pk_mul_f32 v[42:43], v[42:43], s[88:89]
    v_cvt_pk_bf16_f32 v116, v42, v43
    v_lshlrev_b32 v44, 16, v117
    v_and_b32 v45, 0xffff0000, v117
    v_pk_mul_f32 v[44:45], v[44:45], s[88:89]
    v_cvt_pk_bf16_f32 v117, v44, v45
    v_lshlrev_b32 v42, 16, v118
    v_and_b32 v43, 0xffff0000, v118
    v_pk_mul_f32 v[42:43], v[42:43], s[88:89]
    v_cvt_pk_bf16_f32 v118, v42, v43
    v_lshlrev_b32 v44, 16, v119
    v_and_b32 v45, 0xffff0000, v119
    v_pk_mul_f32 v[44:45], v[44:45], s[88:89]
    v_cvt_pk_bf16_f32 v119, v44, v45
    v_accvgpr_write_b32 a52, v116
    v_accvgpr_write_b32 a53, v117
    v_accvgpr_write_b32 a54, v118
    v_accvgpr_write_b32 a55, v119
    buffer_load_dwordx4 v[152:155], v6, s[4:7], s83 offen offset:384 nt
    buffer_load_dwordx4 v[156:159], v6, s[4:7], s84 offen offset:384 nt
    s_waitcnt vmcnt(8)
    s_mov_b64 vcc, s[86:87]
    v_cndmask_b32_dpp v56, v124, v120, vcc row_ror:8 row_mask:0xf bank_mask:0xf
    v_cndmask_b32_dpp v57, v125, v121, vcc row_ror:8 row_mask:0xf bank_mask:0xf
    v_cndmask_b32_dpp v58, v126, v122, vcc row_ror:8 row_mask:0xf bank_mask:0xf
    v_cndmask_b32_dpp v59, v127, v123, vcc row_ror:8 row_mask:0xf bank_mask:0xf
    s_not_b64 vcc, vcc
    v_cndmask_b32_dpp v124, v120, v124, vcc row_ror:8 row_mask:0xf bank_mask:0xf
    v_cndmask_b32_dpp v125, v121, v125, vcc row_ror:8 row_mask:0xf bank_mask:0xf
    v_cndmask_b32_dpp v126, v122, v126, vcc row_ror:8 row_mask:0xf bank_mask:0xf
    v_cndmask_b32_dpp v127, v123, v127, vcc row_ror:8 row_mask:0xf bank_mask:0xf
    v_lshlrev_b32 v42, 16, v56
    v_and_b32 v43, 0xffff0000, v56
    v_pk_mul_f32 v[42:43], v[42:43], s[88:89]
    v_cvt_pk_bf16_f32 v56, v42, v43
    v_lshlrev_b32 v44, 16, v57
    v_and_b32 v45, 0xffff0000, v57
    v_pk_mul_f32 v[44:45], v[44:45], s[88:89]
    v_cvt_pk_bf16_f32 v57, v44, v45
    v_lshlrev_b32 v42, 16, v58
    v_and_b32 v43, 0xffff0000, v58
    v_pk_mul_f32 v[42:43], v[42:43], s[88:89]
    v_cvt_pk_bf16_f32 v58, v42, v43
    v_lshlrev_b32 v44, 16, v59
    v_and_b32 v45, 0xffff0000, v59
    v_pk_mul_f32 v[44:45], v[44:45], s[88:89]
    v_cvt_pk_bf16_f32 v59, v44, v45
    v_accvgpr_write_b32 a56, v56
    v_accvgpr_write_b32 a57, v57
    v_accvgpr_write_b32 a58, v58
    v_accvgpr_write_b32 a59, v59
    v_lshlrev_b32 v42, 16, v124
    v_and_b32 v43, 0xffff0000, v124
    v_pk_mul_f32 v[42:43], v[42:43], s[88:89]
    v_cvt_pk_bf16_f32 v124, v42, v43
    v_lshlrev_b32 v44, 16, v125
    v_and_b32 v45, 0xffff0000, v125
    v_pk_mul_f32 v[44:45], v[44:45], s[88:89]
    v_cvt_pk_bf16_f32 v125, v44, v45
    v_lshlrev_b32 v42, 16, v126
    v_and_b32 v43, 0xffff0000, v126
    v_pk_mul_f32 v[42:43], v[42:43], s[88:89]
    v_cvt_pk_bf16_f32 v126, v42, v43
    v_lshlrev_b32 v44, 16, v127
    v_and_b32 v45, 0xffff0000, v127
    v_pk_mul_f32 v[44:45], v[44:45], s[88:89]
    v_cvt_pk_bf16_f32 v127, v44, v45
    v_accvgpr_write_b32 a60, v124
    v_accvgpr_write_b32 a61, v125
    v_accvgpr_write_b32 a62, v126
    v_accvgpr_write_b32 a63, v127
    v_mfma_f32_16x16x32_bf16 v[20:23], a[96:99], a[32:35], 0
    v_mfma_f32_16x16x32_bf16 v[20:23], a[100:103], a[36:39], v[20:23]
    v_mfma_f32_16x16x32_bf16 v[20:23], a[104:107], a[40:43], v[20:23]
    v_mfma_f32_16x16x32_bf16 v[20:23], a[108:111], a[44:47], v[20:23]
    v_mfma_f32_16x16x32_bf16 v[20:23], a[112:115], a[48:51], v[20:23]
    v_mfma_f32_16x16x32_bf16 v[20:23], a[116:119], a[52:55], v[20:23]
    v_mfma_f32_16x16x32_bf16 v[20:23], a[120:123], a[56:59], v[20:23]
    v_mfma_f32_16x16x32_bf16 v[20:23], a[124:127], a[60:63], v[20:23]
    s_add_u32 s33, s23, 16384
    s_add_u32 m0, s23, 16384
    s_nop 0
    buffer_load_dwordx4 v1, s[8:11], s33 offen offset:0 nt lds
    s_add_u32 m0, s23, 17280
    s_nop 0
    buffer_load_dwordx4 v1, s[8:11], s33 offen offset:128 nt lds
    s_waitcnt vmcnt(8)
    s_mov_b64 vcc, s[86:87]
    v_cndmask_b32_dpp v56, v132, v128, vcc row_ror:8 row_mask:0xf bank_mask:0xf
    v_cndmask_b32_dpp v57, v133, v129, vcc row_ror:8 row_mask:0xf bank_mask:0xf
    v_cndmask_b32_dpp v58, v134, v130, vcc row_ror:8 row_mask:0xf bank_mask:0xf
    v_cndmask_b32_dpp v59, v135, v131, vcc row_ror:8 row_mask:0xf bank_mask:0xf
    s_not_b64 vcc, vcc
    v_cndmask_b32_dpp v132, v128, v132, vcc row_ror:8 row_mask:0xf bank_mask:0xf
    v_cndmask_b32_dpp v133, v129, v133, vcc row_ror:8 row_mask:0xf bank_mask:0xf
    v_cndmask_b32_dpp v134, v130, v134, vcc row_ror:8 row_mask:0xf bank_mask:0xf
    v_cndmask_b32_dpp v135, v131, v135, vcc row_ror:8 row_mask:0xf bank_mask:0xf
    v_lshlrev_b32 v42, 16, v56
    v_and_b32 v43, 0xffff0000, v56
    v_pk_mul_f32 v[42:43], v[42:43], s[88:89]
    v_cvt_pk_bf16_f32 v56, v42, v43
    v_lshlrev_b32 v44, 16, v57
    v_and_b32 v45, 0xffff0000, v57
    v_pk_mul_f32 v[44:45], v[44:45], s[88:89]
    v_cvt_pk_bf16_f32 v57, v44, v45
    v_lshlrev_b32 v42, 16, v58
    v_and_b32 v43, 0xffff0000, v58
    v_pk_mul_f32 v[42:43], v[42:43], s[88:89]
    v_cvt_pk_bf16_f32 v58, v42, v43
    v_lshlrev_b32 v44, 16, v59
    v_and_b32 v45, 0xffff0000, v59
    v_pk_mul_f32 v[44:45], v[44:45], s[88:89]
    v_cvt_pk_bf16_f32 v59, v44, v45
    v_accvgpr_write_b32 a64, v56
    v_accvgpr_write_b32 a65, v57
    v_accvgpr_write_b32 a66, v58
    v_accvgpr_write_b32 a67, v59
    v_lshlrev_b32 v42, 16, v132
    v_and_b32 v43, 0xffff0000, v132
    v_pk_mul_f32 v[42:43], v[42:43], s[88:89]
    v_cvt_pk_bf16_f32 v132, v42, v43
    v_lshlrev_b32 v44, 16, v133
    v_and_b32 v45, 0xffff0000, v133
    v_pk_mul_f32 v[44:45], v[44:45], s[88:89]
    v_cvt_pk_bf16_f32 v133, v44, v45
    v_lshlrev_b32 v42, 16, v134
    v_and_b32 v43, 0xffff0000, v134
    v_pk_mul_f32 v[42:43], v[42:43], s[88:89]
    v_cvt_pk_bf16_f32 v134, v42, v43
    v_lshlrev_b32 v44, 16, v135
    v_and_b32 v45, 0xffff0000, v135
    v_pk_mul_f32 v[44:45], v[44:45], s[88:89]
    v_cvt_pk_bf16_f32 v135, v44, v45
    v_accvgpr_write_b32 a68, v132
    v_accvgpr_write_b32 a69, v133
    v_accvgpr_write_b32 a70, v134
    v_accvgpr_write_b32 a71, v135
    s_add_u32 m0, s23, 18176
    s_nop 0
    buffer_load_dwordx4 v1, s[8:11], s33 offen offset:256 nt lds
    s_add_u32 m0, s23, 19072
    s_nop 0
    buffer_load_dwordx4 v1, s[8:11], s33 offen offset:384 nt lds
    s_waitcnt vmcnt(8)
    s_mov_b64 vcc, s[86:87]
    v_cndmask_b32_dpp v56, v140, v136, vcc row_ror:8 row_mask:0xf bank_mask:0xf
    v_cndmask_b32_dpp v57, v141, v137, vcc row_ror:8 row_mask:0xf bank_mask:0xf
    v_cndmask_b32_dpp v58, v142, v138, vcc row_ror:8 row_mask:0xf bank_mask:0xf
    v_cndmask_b32_dpp v59, v143, v139, vcc row_ror:8 row_mask:0xf bank_mask:0xf
    s_not_b64 vcc, vcc
    v_cndmask_b32_dpp v140, v136, v140, vcc row_ror:8 row_mask:0xf bank_mask:0xf
    v_cndmask_b32_dpp v141, v137, v141, vcc row_ror:8 row_mask:0xf bank_mask:0xf
    v_cndmask_b32_dpp v142, v138, v142, vcc row_ror:8 row_mask:0xf bank_mask:0xf
    v_cndmask_b32_dpp v143, v139, v143, vcc row_ror:8 row_mask:0xf bank_mask:0xf
    v_lshlrev_b32 v42, 16, v56
    v_and_b32 v43, 0xffff0000, v56
    v_pk_mul_f32 v[42:43], v[42:43], s[88:89]
    v_cvt_pk_bf16_f32 v56, v42, v43
    v_lshlrev_b32 v44, 16, v57
    v_and_b32 v45, 0xffff0000, v57
    v_pk_mul_f32 v[44:45], v[44:45], s[88:89]
    v_cvt_pk_bf16_f32 v57, v44, v45
    v_lshlrev_b32 v42, 16, v58
    v_and_b32 v43, 0xffff0000, v58
    v_pk_mul_f32 v[42:43], v[42:43], s[88:89]
    v_cvt_pk_bf16_f32 v58, v42, v43
    v_lshlrev_b32 v44, 16, v59
    v_and_b32 v45, 0xffff0000, v59
    v_pk_mul_f32 v[44:45], v[44:45], s[88:89]
    v_cvt_pk_bf16_f32 v59, v44, v45
    v_accvgpr_write_b32 a72, v56
    v_accvgpr_write_b32 a73, v57
    v_accvgpr_write_b32 a74, v58
    v_accvgpr_write_b32 a75, v59
    v_lshlrev_b32 v42, 16, v140
    v_and_b32 v43, 0xffff0000, v140
    v_pk_mul_f32 v[42:43], v[42:43], s[88:89]
    v_cvt_pk_bf16_f32 v140, v42, v43
    v_lshlrev_b32 v44, 16, v141
    v_and_b32 v45, 0xffff0000, v141
    v_pk_mul_f32 v[44:45], v[44:45], s[88:89]
    v_cvt_pk_bf16_f32 v141, v44, v45
    v_lshlrev_b32 v42, 16, v142
    v_and_b32 v43, 0xffff0000, v142
    v_pk_mul_f32 v[42:43], v[42:43], s[88:89]
L_pg0:
    s_cbranch_execz L_pg4
    v_cvt_pk_bf16_f32 v142, v42, v43
    v_lshlrev_b32 v44, 16, v143
    v_and_b32 v45, 0xffff0000, v143
    v_pk_mul_f32 v[44:45], v[44:45], s[88:89]
    v_cvt_pk_bf16_f32 v143, v44, v45
    v_accvgpr_write_b32 a76, v140
    v_accvgpr_write_b32 a77, v141
    v_accvgpr_write_b32 a78, v142
    v_accvgpr_write_b32 a79, v143
    s_add_u32 s33, s23, 32768
    s_add_u32 m0, s23, 32768
    s_nop 0
    buffer_load_dwordx4 v1, s[8:11], s33 offen offset:0 nt lds
    s_add_u32 m0, s23, 33664
    s_nop 0
    buffer_load_dwordx4 v1, s[8:11], s33 offen offset:128 nt lds
    s_waitcnt vmcnt(8)
    s_mov_b64 vcc, s[86:87]
    v_cndmask_b32_dpp v56, v148, v144, vcc row_ror:8 row_mask:0xf bank_mask:0xf
    v_cndmask_b32_dpp v57, v149, v145, vcc row_ror:8 row_mask:0xf bank_mask:0xf
    v_cndmask_b32_dpp v58, v150, v146, vcc row_ror:8 row_mask:0xf bank_mask:0xf
    v_cndmask_b32_dpp v59, v151, v147, vcc row_ror:8 row_mask:0xf bank_mask:0xf
    s_not_b64 vcc, vcc
    v_cndmask_b32_dpp v148, v144, v148, vcc row_ror:8 row_mask:0xf bank_mask:0xf
    v_cndmask_b32_dpp v149, v145, v149, vcc row_ror:8 row_mask:0xf bank_mask:0xf
    v_cndmask_b32_dpp v150, v146, v150, vcc row_ror:8 row_mask:0xf bank_mask:0xf
    v_cndmask_b32_dpp v151, v147, v151, vcc row_ror:8 row_mask:0xf bank_mask:0xf
    v_lshlrev_b32 v42, 16, v56
    v_and_b32 v43, 0xffff0000, v56
    v_pk_mul_f32 v[42:43], v[42:43], s[88:89]
    v_cvt_pk_bf16_f32 v56, v42, v43
    v_lshlrev_b32 v44, 16, v57
    v_and_b32 v45, 0xffff0000, v57
    v_pk_mul_f32 v[44:45], v[44:45], s[88:89]
    v_cvt_pk_bf16_f32 v57, v44, v45
    v_lshlrev_b32 v42, 16, v58
    v_and_b32 v43, 0xffff0000, v58
    v_pk_mul_f32 v[42:43], v[42:43], s[88:89]
    v_cvt_pk_bf16_f32 v58, v42, v43
    v_lshlrev_b32 v44, 16, v59
    v_and_b32 v45, 0xffff0000, v59
    v_pk_mul_f32 v[44:45], v[44:45], s[88:89]
    v_cvt_pk_bf16_f32 v59, v44, v45
    v_accvgpr_write_b32 a80, v56
    v_accvgpr_write_b32 a81, v57
    v_accvgpr_write_b32 a82, v58
    v_accvgpr_write_b32 a83, v59
    v_lshlrev_b32 v42, 16, v148
    v_and_b32 v43, 0xffff0000, v148
    v_pk_mul_f32 v[42:43], v[42:43], s[88:89]
    v_cvt_pk_bf16_f32 v148, v42, v43
    v_lshlrev_b32 v44, 16, v149
    v_and_b32 v45, 0xffff0000, v149
    v_pk_mul_f32 v[44:45], v[44:45], s[88:89]
    v_cvt_pk_bf16_f32 v149, v44, v45
    v_lshlrev_b32 v42, 16, v150
    v_and_b32 v43, 0xffff0000, v150
    v_pk_mul_f32 v[42:43], v[42:43], s[88:89]
    v_cvt_pk_bf16_f32 v150, v42, v43
    v_lshlrev_b32 v44, 16, v151
    v_and_b32 v45, 0xffff0000, v151
    v_pk_mul_f32 v[44:45], v[44:45], s[88:89]
    v_cvt_pk_bf16_f32 v151, v44, v45
    v_accvgpr_write_b32 a84, v148
    v_accvgpr_write_b32 a85, v149
    v_accvgpr_write_b32 a86, v150
    v_accvgpr_write_b32 a87, v151
    s_add_u32 m0, s23, 34560
    s_nop 0
    buffer_load_dwordx4 v1, s[8:11], s33 offen offset:256 nt lds
    s_add_u32 m0, s23, 35456
    s_nop 0
    buffer_load_dwordx4 v1, s[8:11], s33 offen offset:384 nt lds
    s_waitcnt vmcnt(8)
    s_mov_b64 vcc, s[86:87]
    v_cndmask_b32_dpp v56, v156, v152, vcc row_ror:8 row_mask:0xf bank_mask:0xf
    v_cndmask_b32_dpp v57, v157, v153, vcc row_ror:8 row_mask:0xf bank_mask:0xf
    v_cndmask_b32_dpp v58, v158, v154, vcc row_ror:8 row_mask:0xf bank_mask:0xf
    v_cndmask_b32_dpp v59, v159, v155, vcc row_ror:8 row_mask:0xf bank_mask:0xf
    s_not_b64 vcc, vcc
    v_cndmask_b32_dpp v156, v152, v156, vcc row_ror:8 row_mask:0xf bank_mask:0xf
    v_cndmask_b32_dpp v157, v153, v157, vcc row_ror:8 row_mask:0xf bank_mask:0xf
    v_cndmask_b32_dpp v158, v154, v158, vcc row_ror:8 row_mask:0xf bank_mask:0xf
    v_cndmask_b32_dpp v159, v155, v159, vcc row_ror:8 row_mask:0xf bank_mask:0xf
    v_lshlrev_b32 v42, 16, v56
    v_and_b32 v43, 0xffff0000, v56
    v_pk_mul_f32 v[42:43], v[42:43], s[88:89]
    v_cvt_pk_bf16_f32 v56, v42, v43
    v_lshlrev_b32 v44, 16, v57
    v_and_b32 v45, 0xffff0000, v57
    v_pk_mul_f32 v[44:45], v[44:45], s[88:89]
    v_cvt_pk_bf16_f32 v57, v44, v45
    v_lshlrev_b32 v42, 16, v58
    v_and_b32 v43, 0xffff0000, v58
    v_pk_mul_f32 v[42:43], v[42:43], s[88:89]
    v_cvt_pk_bf16_f32 v58, v42, v43
    v_lshlrev_b32 v44, 16, v59
    v_and_b32 v45, 0xffff0000, v59
    v_pk_mul_f32 v[44:45], v[44:45], s[88:89]
    v_cvt_pk_bf16_f32 v59, v44, v45
    v_accvgpr_write_b32 a88, v56
    v_accvgpr_write_b32 a89, v57
    v_accvgpr_write_b32 a90, v58
    v_accvgpr_write_b32 a91, v59
    v_lshlrev_b32 v42, 16, v156
    v_and_b32 v43, 0xffff0000, v156
    v_pk_mul_f32 v[42:43], v[42:43], s[88:89]
    v_cvt_pk_bf16_f32 v156, v42, v43
    v_lshlrev_b32 v44, 16, v157
    v_and_b32 v45, 0xffff0000, v157
    v_pk_mul_f32 v[44:45], v[44:45], s[88:89]
    v_cvt_pk_bf16_f32 v157, v44, v45
    v_lshlrev_b32 v42, 16, v158
    v_and_b32 v43, 0xffff0000, v158
    v_pk_mul_f32 v[42:43], v[42:43], s[88:89]
    v_cvt_pk_bf16_f32 v158, v42, v43
    v_lshlrev_b32 v44, 16, v159
    v_and_b32 v45, 0xffff0000, v159
    v_pk_mul_f32 v[44:45], v[44:45], s[88:89]
    v_cvt_pk_bf16_f32 v159, v44, v45
    v_accvgpr_write_b32 a92, v156
    v_accvgpr_write_b32 a93, v157
    v_accvgpr_write_b32 a94, v158
    v_accvgpr_write_b32 a95, v159
    v_mfma_f32_16x16x32_bf16 v[24:27], a[96:99], a[64:67], 0
    v_mfma_f32_16x16x32_bf16 v[24:27], a[100:103], a[68:71], v[24:27]
    v_mfma_f32_16x16x32_bf16 v[24:27], a[104:107], a[72:75], v[24:27]
    v_mfma_f32_16x16x32_bf16 v[24:27], a[108:111], a[76:79], v[24:27]
    v_mfma_f32_16x16x32_bf16 v[24:27], a[112:115], a[80:83], v[24:27]
    v_mfma_f32_16x16x32_bf16 v[24:27], a[116:119], a[84:87], v[24:27]
    v_mfma_f32_16x16x32_bf16 v[24:27], a[120:123], a[88:91], v[24:27]
    v_mfma_f32_16x16x32_bf16 v[24:27], a[124:127], a[92:95], v[24:27]
    v_max3_f32 v7, v16, v17, v18
    v_max3_f32 v8, v20, v21, v22
    s_nop 0
    s_nop 0
    s_nop 0
    s_nop 0
    s_nop 0
    s_nop 0
    v_max3_f32 v9, v24, v25, v26
    v_max_f32 v7, v7, v19
    v_max_f32 v8, v8, v23
    v_max_f32 v9, v9, v27
    v_mov_b32 v41, v7
    v_mov_b32 v42, v8
    v_mov_b32 v43, v9
    v_permlane32_swap_b32 v7, v41
    v_permlane32_swap_b32 v8, v42
    v_permlane32_swap_b32 v9, v43
    v_max_f32 v7, v7, v41
    v_max_f32 v8, v8, v42
    v_max_f32 v9, v9, v43
    v_mov_b32 v41, v7
    v_mov_b32 v42, v8
    v_mov_b32 v43, v9
    v_permlane16_swap_b32 v7, v41
    v_permlane16_swap_b32 v8, v42
    v_permlane16_swap_b32 v9, v43
    v_max_f32 v7, v7, v41
    v_max_f32 v8, v8, v42
    v_max_f32 v9, v9, v43
    s_cmp_lg_u32 s22, 0
    s_cselect_b64 s[48:49], -1, 0
    v_sub_f32 v7, 0, v7
    v_sub_f32 v8, 0, v8
    v_sub_f32 v9, 0, v9
    v_cndmask_b32 v7, v7, v10, s[48:49]
    v_cndmask_b32 v8, v8, v11, s[48:49]
    v_cndmask_b32 v9, v9, v12, s[48:49]
    v_mov_b32 v54, v7
    v_mov_b32 v58, v8
    v_mov_b32 v44, v9
    v_mov_b32 v55, v7
    v_mov_b32 v59, v8
    v_mov_b32 v45, v9
    v_mov_b32 v56, v7
    v_mov_b32 v60, v8
    v_mov_b32 v46, v9
    v_mov_b32 v57, v7
    v_mov_b32 v61, v8
    v_mov_b32 v47, v9
    s_waitcnt lgkmcnt(0)
    v_mfma_f32_16x16x32_bf16 v[28:31], a[128:131], a[0:3], v[54:57]
    s_waitcnt lgkmcnt(0)
    v_add_f32 v16, v16, v54
    v_add_f32 v17, v17, v54
    s_add_u32 s26, s23, 49152
    v_mfma_f32_16x16x32_bf16 v[28:31], a[132:135], a[4:7], v[28:31]
    s_add_u32 m0, s23, 49152
    v_exp_f32 v16, v16
    v_mfma_f32_16x16x32_bf16 v[28:31], a[136:139], a[8:11], v[28:31]
    s_waitcnt vmcnt(4)
    v_add_f32 v18, v18, v54
    v_add_f32 v19, v19, v54
    v_mfma_f32_16x16x32_bf16 v[28:31], a[140:143], a[12:15], v[28:31]
    s_barrier
    v_exp_f32 v17, v17
    v_mfma_f32_16x16x32_bf16 v[28:31], a[144:147], a[16:19], v[28:31]
    buffer_load_dwordx4 v1, s[8:11], s26 offen offset:0 nt lds
    ds_read_b128 a[96:99], v2 offset:16384
    v_mfma_f32_16x16x32_bf16 v[28:31], a[148:151], a[20:23], v[28:31]
    v_exp_f32 v18, v18
    v_mfma_f32_16x16x32_bf16 v[28:31], a[152:155], a[24:27], v[28:31]
    ds_read_b128 a[100:103], v3 offset:16384
    v_cvt_pk_bf16_f32 v64, v16, v17
    v_mfma_f32_16x16x32_bf16 v[28:31], a[156:159], a[28:31], v[28:31]
    v_exp_f32 v19, v19
    v_mfma_f32_16x16x32_bf16 v[32:35], a[128:131], a[32:35], v[58:61]
    ds_read_b128 a[104:107], v2 offset:17408
    v_cvt_pk_bf16_f32 v65, v18, v19
    v_mfma_f32_16x16x32_bf16 v[32:35], a[132:135], a[36:39], v[32:35]
    v_add_f32 v20, v20, v58
    v_add_f32 v21, v21, v58
    v_mfma_f32_16x16x32_bf16 v[32:35], a[136:139], a[40:43], v[32:35]
    ds_read_b128 a[108:111], v3 offset:17408
    v_add_f32 v22, v22, v58
    v_mfma_f32_16x16x32_bf16 v[32:35], a[140:143], a[44:47], v[32:35]
    v_exp_f32 v20, v20
    v_mfma_f32_16x16x32_bf16 v[32:35], a[144:147], a[48:51], v[32:35]
    ds_read_b128 a[112:115], v2 offset:18432
    v_add_f32 v23, v23, v58
    v_mfma_f32_16x16x32_bf16 v[32:35], a[148:151], a[52:55], v[32:35]
    s_add_u32 m0, s23, 50048
    v_exp_f32 v21, v21
    v_mfma_f32_16x16x32_bf16 v[32:35], a[152:155], a[56:59], v[32:35]
    buffer_load_dwordx4 v1, s[8:11], s26 offen offset:128 nt lds
    ds_read_b128 a[116:119], v3 offset:18432
    v_mfma_f32_16x16x32_bf16 v[32:35], a[156:159], a[60:63], v[32:35]
    v_exp_f32 v22, v22
    v_mfma_f32_16x16x32_bf16 v[36:39], a[128:131], a[64:67], v[44:47]
    ds_read_b128 a[120:123], v2 offset:19456
    v_cvt_pk_bf16_f32 v68, v20, v21
    v_mfma_f32_16x16x32_bf16 v[36:39], a[132:135], a[68:71], v[36:39]
    v_exp_f32 v23, v23
    v_mfma_f32_16x16x32_bf16 v[36:39], a[136:139], a[72:75], v[36:39]
    ds_read_b128 a[124:127], v3 offset:19456
    v_cvt_pk_bf16_f32 v69, v22, v23
    v_mfma_f32_16x16x32_bf16 v[36:39], a[140:143], a[76:79], v[36:39]
    v_add_f32 v24, v24, v44
    v_add_f32 v25, v25, v44
    v_mfma_f32_16x16x32_bf16 v[36:39], a[144:147], a[80:83], v[36:39]
    v_exp_f32 v24, v24
    v_mfma_f32_16x16x32_bf16 v[36:39], a[148:151], a[84:87], v[36:39]
    v_add_f32 v26, v26, v44
    v_add_f32 v27, v27, v44
    v_mfma_f32_16x16x32_bf16 v[36:39], a[152:155], a[88:91], v[36:39]
    v_exp_f32 v25, v25
    v_mfma_f32_16x16x32_bf16 v[36:39], a[156:159], a[92:95], v[36:39]
    s_waitcnt lgkmcnt(2)
    v_exp_f32 v26, v26
    v_mfma_f32_16x16x32_bf16 v[16:19], a[96:99], a[0:3], v[54:57]
    v_exp_f32 v27, v27
    v_mfma_f32_16x16x32_bf16 v[16:19], a[100:103], a[4:7], v[16:19]
    s_add_u32 m0, s23, 50944
    v_cvt_pk_bf16_f32 v72, v24, v25
    v_cvt_pk_bf16_f32 v73, v26, v27
    v_mfma_f32_16x16x32_bf16 v[16:19], a[104:107], a[8:11], v[16:19]
    buffer_load_dwordx4 v1, s[8:11], s26 offen offset:256 nt lds
    v_mfma_f32_16x16x32_bf16 v[16:19], a[108:111], a[12:15], v[16:19]
    v_exp_f32 v28, v28
    v_mfma_f32_16x16x32_bf16 v[16:19], a[112:115], a[16:19], v[16:19]
    v_exp_f32 v29, v29
    v_mfma_f32_16x16x32_bf16 v[16:19], a[116:119], a[20:23], v[16:19]
    s_waitcnt lgkmcnt(0)
    ds_read_b128 a[128:131], v2 offset:24576
    v_cvt_pk_bf16_f32 v66, v28, v29
    v_mfma_f32_16x16x32_bf16 v[16:19], a[120:123], a[24:27], v[16:19]
    v_exp_f32 v30, v30
    v_mfma_f32_16x16x32_bf16 v[16:19], a[124:127], a[28:31], v[16:19]
    v_exp_f32 v31, v31
    v_mfma_f32_16x16x32_bf16 v[20:23], a[96:99], a[32:35], v[58:61]
    ds_read_b128 a[132:135], v3 offset:24576
    ds_read_b128 a[136:139], v2 offset:25600
    v_mfma_f32_16x16x32_bf16 v[20:23], a[100:103], a[36:39], v[20:23]
    v_exp_f32 v32, v32
    v_mfma_f32_16x16x32_bf16 v[20:23], a[104:107], a[40:43], v[20:23]
    ds_read_b128 a[140:143], v3 offset:25600
    v_cvt_pk_bf16_f32 v67, v30, v31
    v_mfma_f32_16x16x32_bf16 v[20:23], a[108:111], a[44:47], v[20:23]
    v_exp_f32 v33, v33
    v_mfma_f32_16x16x32_bf16 v[20:23], a[112:115], a[48:51], v[20:23]
    ds_read_b128 a[144:147], v2 offset:26624
    v_cvt_pk_bf16_f32 v70, v32, v33
    v_mfma_f32_16x16x32_bf16 v[20:23], a[116:119], a[52:55], v[20:23]
    s_add_u32 m0, s23, 51840
    v_exp_f32 v34, v34
    v_mfma_f32_16x16x32_bf16 v[20:23], a[120:123], a[56:59], v[20:23]
    buffer_load_dwordx4 v1, s[8:11], s26 offen offset:384 nt lds
    ds_read_b128 a[148:151], v3 offset:26624
    v_mfma_f32_16x16x32_bf16 v[20:23], a[124:127], a[60:63], v[20:23]
    v_exp_f32 v35, v35
    v_mfma_f32_16x16x32_bf16 v[24:27], a[96:99], a[64:67], v[44:47]
    ds_read_b128 a[152:155], v2 offset:27648
    v_cvt_pk_bf16_f32 v71, v34, v35
    v_mfma_f32_16x16x32_bf16 v[24:27], a[100:103], a[68:71], v[24:27]
    v_exp_f32 v36, v36
    v_mfma_f32_16x16x32_bf16 v[24:27], a[104:107], a[72:75], v[24:27]
    v_exp_f32 v37, v37
    v_mfma_f32_16x16x32_bf16 v[24:27], a[108:111], a[76:79], v[24:27]
    ds_read_b128 a[156:159], v3 offset:27648
    v_cvt_pk_bf16_f32 v74, v36, v37
    v_mfma_f32_16x16x32_bf16 v[24:27], a[112:115], a[80:83], v[24:27]
    v_exp_f32 v38, v38
    v_mfma_f32_16x16x32_bf16 v[24:27], a[116:119], a[84:87], v[24:27]
    v_exp_f32 v39, v39
    v_mfma_f32_16x16x32_bf16 v[24:27], a[120:123], a[88:91], v[24:27]
    s_add_u32 s26, s23, 65536
    v_exp_f32 v16, v16
    v_mfma_f32_16x16x32_bf16 v[24:27], a[124:127], a[92:95], v[24:27]
    s_waitcnt lgkmcnt(2)
    v_cvt_pk_bf16_f32 v75, v38, v39
    v_mov_b32 v14, v16
    v_mfma_f32_16x16x32_bf16 v[28:31], a[128:131], a[0:3], v[54:57]
    s_add_u32 m0, s23, 65536
    v_exp_f32 v17, v17
    v_mfma_f32_16x16x32_bf16 v[28:31], a[132:135], a[4:7], v[28:31]
    s_waitcnt vmcnt(4)
    v_exp_f32 v18, v18
    v_mfma_f32_16x16x32_bf16 v[28:31], a[136:139], a[8:11], v[28:31]
    s_barrier
    v_add_f32 v14, v14, v17
    v_cvt_pk_bf16_f32 v76, v16, v17
    v_mfma_f32_16x16x32_bf16 v[28:31], a[140:143], a[12:15], v[28:31]
    buffer_load_dwordx4 v1, s[8:11], s26 offen offset:0 nt lds
    v_add_f32 v14, v14, v18
    v_mfma_f32_16x16x32_bf16 v[28:31], a[144:147], a[16:19], v[28:31]
    v_exp_f32 v19, v19
    v_mfma_f32_16x16x32_bf16 v[28:31], a[148:151], a[20:23], v[28:31]
    s_waitcnt lgkmcnt(0)
    ds_read_b128 a[96:99], v2 offset:32768
    v_cvt_pk_bf16_f32 v77, v18, v19
    v_mfma_f32_16x16x32_bf16 v[28:31], a[152:155], a[24:27], v[28:31]
    ds_read_b128 a[100:103], v3 offset:32768
    v_add_f32 v14, v14, v19
    v_mfma_f32_16x16x32_bf16 v[28:31], a[156:159], a[28:31], v[28:31]
    v_exp_f32 v20, v20
    v_mfma_f32_16x16x32_bf16 a[164:167], a[160:163], v[64:67], 0
    ds_read_b128 a[104:107], v2 offset:33792
    v_mov_b32 v15, v20
    v_mfma_f32_16x16x32_bf16 v[32:35], a[128:131], a[32:35], v[58:61]
    v_exp_f32 v21, v21
    v_mfma_f32_16x16x32_bf16 v[32:35], a[132:135], a[36:39], v[32:35]
    ds_read_b128 a[108:111], v3 offset:33792
    v_add_f32 v15, v15, v21
    v_mfma_f32_16x16x32_bf16 v[32:35], a[136:139], a[40:43], v[32:35]
    v_exp_f32 v22, v22
    v_mfma_f32_16x16x32_bf16 v[32:35], a[140:143], a[44:47], v[32:35]
    ds_read_b128 a[112:115], v2 offset:34816
    v_add_f32 v15, v15, v22
    v_mfma_f32_16x16x32_bf16 v[32:35], a[144:147], a[48:51], v[32:35]
    v_exp_f32 v23, v23
    v_mfma_f32_16x16x32_bf16 v[32:35], a[148:151], a[52:55], v[32:35]
    ds_read_b128 a[116:119], v3 offset:34816
    v_cvt_pk_bf16_f32 v80, v20, v21
    v_mfma_f32_16x16x32_bf16 v[32:35], a[152:155], a[56:59], v[32:35]
    s_add_u32 m0, s23, 66432
    v_cvt_pk_bf16_f32 v81, v22, v23
    v_add_f32 v15, v15, v23
    v_mfma_f32_16x16x32_bf16 v[32:35], a[156:159], a[60:63], v[32:35]
    buffer_load_dwordx4 v1, s[8:11], s26 offen offset:128 nt lds
    ds_read_b128 a[120:123], v2 offset:35840
    v_mfma_f32_16x16x32_bf16 a[168:171], a[160:163], v[68:71], 0
    v_exp_f32 v24, v24
    v_mfma_f32_16x16x32_bf16 v[36:39], a[128:131], a[64:67], v[44:47]
    ds_read_b128 a[124:127], v3 offset:35840
    v_mov_b32 v48, v24
    v_mfma_f32_16x16x32_bf16 v[36:39], a[132:135], a[68:71], v[36:39]
    v_exp_f32 v25, v25
    v_mfma_f32_16x16x32_bf16 v[36:39], a[136:139], a[72:75], v[36:39]
    v_exp_f32 v26, v26
    v_mfma_f32_16x16x32_bf16 v[36:39], a[140:143], a[76:79], v[36:39]
    v_add_f32 v48, v48, v25
    v_cvt_pk_bf16_f32 v84, v24, v25
    v_mfma_f32_16x16x32_bf16 v[36:39], a[144:147], a[80:83], v[36:39]
    v_exp_f32 v27, v27
    v_mfma_f32_16x16x32_bf16 v[36:39], a[148:151], a[84:87], v[36:39]
    v_add_f32 v48, v48, v26
    v_cvt_pk_bf16_f32 v85, v26, v27
    v_mfma_f32_16x16x32_bf16 v[36:39], a[152:155], a[88:91], v[36:39]
    v_exp_f32 v28, v28
    v_mfma_f32_16x16x32_bf16 v[36:39], a[156:159], a[92:95], v[36:39]
    v_add_f32 v48, v48, v27
    v_add_f32 v14, v14, v28
    v_mfma_f32_16x16x32_bf16 a[172:175], a[160:163], v[72:75], 0
    s_waitcnt lgkmcnt(0)
    v_exp_f32 v29, v29
    v_mfma_f32_16x16x32_bf16 v[16:19], a[96:99], a[0:3], v[54:57]
    v_exp_f32 v30, v30
    v_mfma_f32_16x16x32_bf16 v[16:19], a[100:103], a[4:7], v[16:19]
    s_add_u32 m0, s23, 67328
    v_add_f32 v14, v14, v29
    v_cvt_pk_bf16_f32 v78, v28, v29
    v_mfma_f32_16x16x32_bf16 v[16:19], a[104:107], a[8:11], v[16:19]
    buffer_load_dwordx4 v1, s[8:11], s26 offen offset:256 nt lds
    v_add_f32 v14, v14, v30
    v_mfma_f32_16x16x32_bf16 v[16:19], a[108:111], a[12:15], v[16:19]
    v_exp_f32 v31, v31
    v_mfma_f32_16x16x32_bf16 v[16:19], a[112:115], a[16:19], v[16:19]
    ds_read_b128 a[128:131], v2 offset:40960
    v_cvt_pk_bf16_f32 v79, v30, v31
    v_mfma_f32_16x16x32_bf16 v[16:19], a[116:119], a[20:23], v[16:19]
    v_exp_f32 v32, v32
    v_mfma_f32_16x16x32_bf16 v[16:19], a[120:123], a[24:27], v[16:19]
    ds_read_b128 a[132:135], v3 offset:40960
    v_add_f32 v14, v14, v31
    v_mfma_f32_16x16x32_bf16 v[16:19], a[124:127], a[28:31], v[16:19]
    v_exp_f32 v33, v33
    v_mfma_f32_16x16x32_bf16 v[20:23], a[96:99], a[32:35], v[58:61]
    ds_read_b128 a[136:139], v2 offset:41984
    v_add_f32 v15, v15, v32
    v_mfma_f32_16x16x32_bf16 v[20:23], a[100:103], a[36:39], v[20:23]
    v_exp_f32 v34, v34
    v_mfma_f32_16x16x32_bf16 v[20:23], a[104:107], a[40:43], v[20:23]
    ds_read_b128 a[140:143], v3 offset:41984
    v_add_f32 v15, v15, v33
    v_mfma_f32_16x16x32_bf16 v[20:23], a[108:111], a[44:47], v[20:23]
    v_exp_f32 v35, v35
    v_mfma_f32_16x16x32_bf16 v[20:23], a[112:115], a[48:51], v[20:23]
    ds_read_b128 a[144:147], v2 offset:43008
    v_add_f32 v15, v15, v34
    v_mfma_f32_16x16x32_bf16 v[20:23], a[116:119], a[52:55], v[20:23]
    s_add_u32 m0, s23, 68224
    v_cvt_pk_bf16_f32 v82, v32, v33
    v_cvt_pk_bf16_f32 v83, v34, v35
    v_mfma_f32_16x16x32_bf16 v[20:23], a[120:123], a[56:59], v[20:23]
    buffer_load_dwordx4 v1, s[8:11], s26 offen offset:384 nt lds
    ds_read_b128 a[148:151], v3 offset:43008
    v_mfma_f32_16x16x32_bf16 v[20:23], a[124:127], a[60:63], v[20:23]
    v_exp_f32 v36, v36
    v_mfma_f32_16x16x32_bf16 v[24:27], a[96:99], a[64:67], v[44:47]
    ds_read_b128 a[152:155], v2 offset:44032
    v_add_f32 v15, v15, v35
    v_mfma_f32_16x16x32_bf16 v[24:27], a[100:103], a[68:71], v[24:27]
    v_exp_f32 v37, v37
    v_mfma_f32_16x16x32_bf16 v[24:27], a[104:107], a[72:75], v[24:27]
    ds_read_b128 a[156:159], v3 offset:44032
    v_add_f32 v48, v48, v36
    v_mfma_f32_16x16x32_bf16 v[24:27], a[108:111], a[76:79], v[24:27]
    v_exp_f32 v38, v38
    v_mfma_f32_16x16x32_bf16 v[24:27], a[112:115], a[80:83], v[24:27]
    v_add_f32 v48, v48, v37
    v_cvt_pk_bf16_f32 v86, v36, v37
    v_mfma_f32_16x16x32_bf16 v[24:27], a[116:119], a[84:87], v[24:27]
    v_exp_f32 v39, v39
    v_mfma_f32_16x16x32_bf16 v[24:27], a[120:123], a[88:91], v[24:27]
    s_add_u32 s26, s23, 81920
    v_add_f32 v48, v48, v38
    v_cvt_pk_bf16_f32 v87, v38, v39
    v_mfma_f32_16x16x32_bf16 v[24:27], a[124:127], a[92:95], v[24:27]
    s_waitcnt lgkmcnt(2)
    v_exp_f32 v16, v16
    v_mfma_f32_16x16x32_bf16 v[28:31], a[128:131], a[0:3], v[54:57]
    s_add_u32 m0, s23, 81920
    v_add_f32 v48, v48, v39
    v_add_f32 v14, v14, v16
    v_mfma_f32_16x16x32_bf16 v[28:31], a[132:135], a[4:7], v[28:31]
    s_waitcnt vmcnt(4)
    v_exp_f32 v17, v17
    v_mfma_f32_16x16x32_bf16 v[28:31], a[136:139], a[8:11], v[28:31]
    buffer_load_dwordx4 v1, s[8:11], s26 offen offset:0 nt lds
    v_add_f32 v14, v14, v17
    v_mfma_f32_16x16x32_bf16 v[28:31], a[140:143], a[12:15], v[28:31]
    s_barrier
    v_exp_f32 v18, v18
    v_mfma_f32_16x16x32_bf16 v[28:31], a[144:147], a[16:19], v[28:31]
    ds_read_b128 a[96:99], v2 offset:49152
    v_add_f32 v14, v14, v18
    v_mfma_f32_16x16x32_bf16 v[28:31], a[148:151], a[20:23], v[28:31]
    s_waitcnt lgkmcnt(1)
    v_exp_f32 v19, v19
    v_mfma_f32_16x16x32_bf16 v[28:31], a[152:155], a[24:27], v[28:31]
    ds_read_b128 a[100:103], v3 offset:49152
    v_cvt_pk_bf16_f32 v88, v16, v17
    v_mfma_f32_16x16x32_bf16 v[28:31], a[156:159], a[28:31], v[28:31]
    v_cvt_pk_bf16_f32 v89, v18, v19
    v_add_f32 v14, v14, v19
    v_mfma_f32_16x16x32_bf16 v[32:35], a[128:131], a[32:35], v[58:61]
    v_exp_f32 v20, v20
    v_mfma_f32_16x16x32_bf16 v[32:35], a[132:135], a[36:39], v[32:35]
    ds_read_b128 a[104:107], v2 offset:50176
    v_add_f32 v15, v15, v20
    v_mfma_f32_16x16x32_bf16 v[32:35], a[136:139], a[40:43], v[32:35]
    v_exp_f32 v21, v21
    v_mfma_f32_16x16x32_bf16 v[32:35], a[140:143], a[44:47], v[32:35]
    ds_read_b128 a[108:111], v3 offset:50176
    v_add_f32 v15, v15, v21
    v_mfma_f32_16x16x32_bf16 v[32:35], a[144:147], a[48:51], v[32:35]
    ds_read_b128 a[112:115], v2 offset:51200
    v_cvt_pk_bf16_f32 v92, v20, v21
    v_mfma_f32_16x16x32_bf16 v[32:35], a[148:151], a[52:55], v[32:35]
    s_add_u32 m0, s23, 82816
    v_exp_f32 v22, v22
    v_mfma_f32_16x16x32_bf16 v[32:35], a[152:155], a[56:59], v[32:35]
    buffer_load_dwordx4 v1, s[8:11], s26 offen offset:128 nt lds
    ds_read_b128 a[116:119], v3 offset:51200
    v_mfma_f32_16x16x32_bf16 v[32:35], a[156:159], a[60:63], v[32:35]
    v_exp_f32 v23, v23
    v_mfma_f32_16x16x32_bf16 v[36:39], a[128:131], a[64:67], v[44:47]
    ds_read_b128 a[120:123], v2 offset:52224
    v_add_f32 v15, v15, v22
    v_mfma_f32_16x16x32_bf16 v[36:39], a[132:135], a[68:71], v[36:39]
    v_cvt_pk_bf16_f32 v93, v22, v23
    v_add_f32 v15, v15, v23
    v_mfma_f32_16x16x32_bf16 v[36:39], a[136:139], a[72:75], v[36:39]
    v_exp_f32 v24, v24
    v_mfma_f32_16x16x32_bf16 v[36:39], a[140:143], a[76:79], v[36:39]
    ds_read_b128 a[124:127], v3 offset:52224
    v_add_f32 v48, v48, v24
    v_mfma_f32_16x16x32_bf16 v[36:39], a[144:147], a[80:83], v[36:39]
    v_exp_f32 v25, v25
    v_mfma_f32_16x16x32_bf16 v[36:39], a[148:151], a[84:87], v[36:39]
    v_exp_f32 v26, v26
    v_mfma_f32_16x16x32_bf16 v[36:39], a[152:155], a[88:91], v[36:39]
    v_add_f32 v48, v48, v25
    v_cvt_pk_bf16_f32 v96, v24, v25
    v_mfma_f32_16x16x32_bf16 v[36:39], a[156:159], a[92:95], v[36:39]
    s_waitcnt lgkmcnt(2)
    v_exp_f32 v27, v27
    v_mfma_f32_16x16x32_bf16 v[16:19], a[96:99], a[0:3], v[54:57]
    v_add_f32 v48, v48, v26
    v_cvt_pk_bf16_f32 v97, v26, v27
    v_mfma_f32_16x16x32_bf16 v[16:19], a[100:103], a[4:7], v[16:19]
    s_add_u32 m0, s23, 83712
    v_exp_f32 v28, v28
    v_mfma_f32_16x16x32_bf16 v[16:19], a[104:107], a[8:11], v[16:19]
    buffer_load_dwordx4 v1, s[8:11], s26 offen offset:256 nt lds
    v_add_f32 v48, v48, v27
    v_mfma_f32_16x16x32_bf16 v[16:19], a[108:111], a[12:15], v[16:19]
    v_exp_f32 v29, v29
    v_mfma_f32_16x16x32_bf16 v[16:19], a[112:115], a[16:19], v[16:19]
    ds_read_b128 a[128:131], v2 offset:57344
    v_add_f32 v14, v14, v28
    v_mfma_f32_16x16x32_bf16 v[16:19], a[116:119], a[20:23], v[16:19]
    s_waitcnt lgkmcnt(1)
    v_exp_f32 v30, v30
    v_mfma_f32_16x16x32_bf16 v[16:19], a[120:123], a[24:27], v[16:19]
    ds_read_b128 a[132:135], v3 offset:57344
    v_add_f32 v14, v14, v29
    v_mfma_f32_16x16x32_bf16 v[16:19], a[124:127], a[28:31], v[16:19]
    v_exp_f32 v31, v31
    v_mfma_f32_16x16x32_bf16 v[20:23], a[96:99], a[32:35], v[58:61]
    ds_read_b128 a[136:139], v2 offset:58368
    v_add_f32 v14, v14, v30
    v_mfma_f32_16x16x32_bf16 v[20:23], a[100:103], a[36:39], v[20:23]
    v_cvt_pk_bf16_f32 v90, v28, v29
    v_cvt_pk_bf16_f32 v91, v30, v31
    v_mfma_f32_16x16x32_bf16 v[20:23], a[104:107], a[40:43], v[20:23]
    ds_read_b128 a[140:143], v3 offset:58368
    v_add_f32 v14, v14, v31
    v_mfma_f32_16x16x32_bf16 v[20:23], a[108:111], a[44:47], v[20:23]
    v_exp_f32 v32, v32
    v_mfma_f32_16x16x32_bf16 v[20:23], a[112:115], a[48:51], v[20:23]
    ds_read_b128 a[144:147], v2 offset:59392
    v_add_f32 v15, v15, v32
    v_mfma_f32_16x16x32_bf16 v[20:23], a[116:119], a[52:55], v[20:23]
    s_add_u32 m0, s23, 84608
    v_exp_f32 v33, v33
    v_mfma_f32_16x16x32_bf16 v[20:23], a[120:123], a[56:59], v[20:23]
    buffer_load_dwordx4 v1, s[8:11], s26 offen offset:384 nt lds
    ds_read_b128 a[148:151], v3 offset:59392
    v_mfma_f32_16x16x32_bf16 v[20:23], a[124:127], a[60:63], v[20:23]
    v_exp_f32 v34, v34
    v_mfma_f32_16x16x32_bf16 v[24:27], a[96:99], a[64:67], v[44:47]
    ds_read_b128 a[152:155], v2 offset:60416
    v_add_f32 v15, v15, v33
    v_mfma_f32_16x16x32_bf16 v[24:27], a[100:103], a[68:71], v[24:27]
    v_exp_f32 v35, v35
    v_mfma_f32_16x16x32_bf16 v[24:27], a[104:107], a[72:75], v[24:27]
    ds_read_b128 a[156:159], v3 offset:60416
    v_add_f32 v15, v15, v34
    v_mfma_f32_16x16x32_bf16 v[24:27], a[108:111], a[76:79], v[24:27]
    v_add_u32 v2, 0x10000, v2
    v_cvt_pk_bf16_f32 v94, v32, v33
    v_mfma_f32_16x16x32_bf16 v[24:27], a[112:115], a[80:83], v[24:27]
    v_cvt_pk_bf16_f32 v95, v34, v35
    v_add_f32 v15, v15, v35
    v_mfma_f32_16x16x32_bf16 v[24:27], a[116:119], a[84:87], v[24:27]
    v_exp_f32 v36, v36
    v_mfma_f32_16x16x32_bf16 v[24:27], a[120:123], a[88:91], v[24:27]
    s_add_u32 s26, s23, 98304
    v_add_u32 v3, 0x10000, v3
    v_add_f32 v48, v48, v36
    v_mfma_f32_16x16x32_bf16 v[24:27], a[124:127], a[92:95], v[24:27]
    s_waitcnt lgkmcnt(2)
    v_exp_f32 v37, v37
    v_mfma_f32_16x16x32_bf16 v[28:31], a[128:131], a[0:3], v[54:57]
    s_add_u32 m0, s23, 98304
    v_exp_f32 v38, v38
    v_mfma_f32_16x16x32_bf16 v[28:31], a[132:135], a[4:7], v[28:31]
    s_waitcnt vmcnt(4)
    v_add_f32 v48, v48, v37
    v_cvt_pk_bf16_f32 v98, v36, v37
    v_mfma_f32_16x16x32_bf16 v[28:31], a[136:139], a[8:11], v[28:31]
    buffer_load_dwordx4 v1, s[8:11], s26 offen offset:0 nt lds
    v_add_f32 v48, v48, v38
    v_mfma_f32_16x16x32_bf16 v[28:31], a[140:143], a[12:15], v[28:31]
    s_barrier
    v_exp_f32 v39, v39
    v_mfma_f32_16x16x32_bf16 v[28:31], a[144:147], a[16:19], v[28:31]
    ds_read_b128 a[96:99], v2 offset:0
    v_cvt_pk_bf16_f32 v99, v38, v39
    v_mfma_f32_16x16x32_bf16 v[28:31], a[148:151], a[20:23], v[28:31]
    s_waitcnt lgkmcnt(1)
    v_exp_f32 v16, v16
    v_mfma_f32_16x16x32_bf16 v[28:31], a[152:155], a[24:27], v[28:31]
    ds_read_b128 a[100:103], v3 offset:0
    v_add_f32 v48, v48, v39
    v_mfma_f32_16x16x32_bf16 v[28:31], a[156:159], a[28:31], v[28:31]
    v_exp_f32 v17, v17
    v_mfma_f32_16x16x32_bf16 v[32:35], a[128:131], a[32:35], v[58:61]
    ds_read_b128 a[104:107], v2 offset:1024
    v_cvt_pk_bf16_f32 v100, v16, v17
    v_mfma_f32_16x16x32_bf16 v[32:35], a[132:135], a[36:39], v[32:35]
    s_add_u32 m0, s23, 99200
    v_exp_f32 v18, v18
    v_mfma_f32_16x16x32_bf16 v[32:35], a[136:139], a[40:43], v[32:35]
    buffer_load_dwordx4 v1, s[8:11], s26 offen offset:128 nt lds
    ds_read_b128 a[108:111], v3 offset:1024
    v_mfma_f32_16x16x32_bf16 v[32:35], a[140:143], a[44:47], v[32:35]
    v_exp_f32 v19, v19
    v_mfma_f32_16x16x32_bf16 v[32:35], a[144:147], a[48:51], v[32:35]
    ds_read_b128 a[112:115], v2 offset:2048
    v_cvt_pk_bf16_f32 v101, v18, v19
    v_mfma_f32_16x16x32_bf16 v[32:35], a[148:151], a[52:55], v[32:35]
    v_exp_f32 v20, v20
    v_mfma_f32_16x16x32_bf16 v[32:35], a[152:155], a[56:59], v[32:35]
L_pg1:
    s_cbranch_execz L_pg5
    v_exp_f32 v21, v21
    v_mfma_f32_16x16x32_bf16 v[32:35], a[156:159], a[60:63], v[32:35]
    ds_read_b128 a[116:119], v3 offset:2048
    v_cvt_pk_bf16_f32 v104, v20, v21
    v_mfma_f32_16x16x32_bf16 v[36:39], a[128:131], a[64:67], v[44:47]
    v_exp_f32 v22, v22
    v_mfma_f32_16x16x32_bf16 v[36:39], a[132:135], a[68:71], v[36:39]
    s_add_u32 m0, s23, 100096
    v_exp_f32 v23, v23
    v_mfma_f32_16x16x32_bf16 v[36:39], a[136:139], a[72:75], v[36:39]
    buffer_load_dwordx4 v1, s[8:11], s26 offen offset:256 nt lds
    ds_read_b128 a[120:123], v2 offset:3072
    v_mfma_f32_16x16x32_bf16 v[36:39], a[140:143], a[76:79], v[36:39]
    ds_read_b128 a[124:127], v3 offset:3072
    v_cvt_pk_bf16_f32 v105, v22, v23
    v_mfma_f32_16x16x32_bf16 v[36:39], a[144:147], a[80:83], v[36:39]
    v_exp_f32 v24, v24
    v_mfma_f32_16x16x32_bf16 v[36:39], a[148:151], a[84:87], v[36:39]
    v_exp_f32 v25, v25
    v_mfma_f32_16x16x32_bf16 v[36:39], a[152:155], a[88:91], v[36:39]
    v_exp_f32 v26, v26
    v_mfma_f32_16x16x32_bf16 v[36:39], a[156:159], a[92:95], v[36:39]
    s_waitcnt lgkmcnt(2)
    v_exp_f32 v27, v27
    v_mfma_f32_16x16x32_bf16 v[16:19], a[96:99], a[0:3], v[54:57]
    s_add_u32 m0, s23, 100992
    v_cvt_pk_bf16_f32 v108, v24, v25
    v_cvt_pk_bf16_f32 v109, v26, v27
    v_mfma_f32_16x16x32_bf16 v[16:19], a[100:103], a[4:7], v[16:19]
    buffer_load_dwordx4 v1, s[8:11], s26 offen offset:384 nt lds
    v_mfma_f32_16x16x32_bf16 v[16:19], a[104:107], a[8:11], v[16:19]
    v_exp_f32 v28, v28
    v_mfma_f32_16x16x32_bf16 v[16:19], a[108:111], a[12:15], v[16:19]
    v_exp_f32 v29, v29
    v_mfma_f32_16x16x32_bf16 v[16:19], a[112:115], a[16:19], v[16:19]
    ds_read_b128 a[128:131], v2 offset:8192
    v_cvt_pk_bf16_f32 v102, v28, v29
    v_mfma_f32_16x16x32_bf16 v[16:19], a[116:119], a[20:23], v[16:19]
    s_waitcnt lgkmcnt(1)
    v_exp_f32 v30, v30
    v_mfma_f32_16x16x32_bf16 v[16:19], a[120:123], a[24:27], v[16:19]
    v_exp_f32 v31, v31
    v_mfma_f32_16x16x32_bf16 v[16:19], a[124:127], a[28:31], v[16:19]
    s_add_u32 s26, s23, 114688
    ds_read_b128 a[132:135], v3 offset:8192
    v_cvt_pk_bf16_f32 v103, v30, v31
    v_mfma_f32_16x16x32_bf16 v[20:23], a[96:99], a[32:35], v[58:61]
    s_add_u32 m0, s23, 114688
    v_exp_f32 v32, v32
    v_mfma_f32_16x16x32_bf16 v[20:23], a[100:103], a[36:39], v[20:23]
    buffer_load_dwordx4 v1, s[8:11], s26 offen offset:0 nt lds
    ds_read_b128 a[136:139], v2 offset:9216
    v_mfma_f32_16x16x32_bf16 v[20:23], a[104:107], a[40:43], v[20:23]
    v_exp_f32 v33, v33
    v_mfma_f32_16x16x32_bf16 v[20:23], a[108:111], a[44:47], v[20:23]
    ds_read_b128 a[140:143], v3 offset:9216
    v_cvt_pk_bf16_f32 v106, v32, v33
    v_mfma_f32_16x16x32_bf16 v[20:23], a[112:115], a[48:51], v[20:23]
    v_exp_f32 v34, v34
    v_mfma_f32_16x16x32_bf16 v[20:23], a[116:119], a[52:55], v[20:23]
    v_exp_f32 v35, v35
    v_mfma_f32_16x16x32_bf16 v[20:23], a[120:123], a[56:59], v[20:23]
    ds_read_b128 a[144:147], v2 offset:10240
    ds_read_b128 a[148:151], v3 offset:10240
    v_mfma_f32_16x16x32_bf16 v[20:23], a[124:127], a[60:63], v[20:23]
    v_exp_f32 v36, v36
    v_mfma_f32_16x16x32_bf16 v[24:27], a[96:99], a[64:67], v[44:47]
    s_add_u32 m0, s23, 115584
    ds_read_b128 a[152:155], v2 offset:11264
    v_cvt_pk_bf16_f32 v107, v34, v35
    v_mfma_f32_16x16x32_bf16 v[24:27], a[100:103], a[68:71], v[24:27]
    buffer_load_dwordx4 v1, s[8:11], s26 offen offset:128 nt lds
    v_mfma_f32_16x16x32_bf16 v[24:27], a[104:107], a[72:75], v[24:27]
    v_exp_f32 v37, v37
    v_mfma_f32_16x16x32_bf16 v[24:27], a[108:111], a[76:79], v[24:27]
    ds_read_b128 a[156:159], v3 offset:11264
    v_cvt_pk_bf16_f32 v110, v36, v37
    v_mfma_f32_16x16x32_bf16 v[24:27], a[112:115], a[80:83], v[24:27]
    v_exp_f32 v38, v38
    v_mfma_f32_16x16x32_bf16 v[24:27], a[116:119], a[84:87], v[24:27]
    v_exp_f32 v39, v39
    v_mfma_f32_16x16x32_bf16 v[24:27], a[120:123], a[88:91], v[24:27]
    v_exp_f32 v16, v16
    v_mfma_f32_16x16x32_bf16 v[24:27], a[124:127], a[92:95], v[24:27]
    s_waitcnt lgkmcnt(2)
    v_cvt_pk_bf16_f32 v111, v38, v39
    v_add_f32 v14, v14, v16
    v_mfma_f32_16x16x32_bf16 v[28:31], a[128:131], a[0:3], v[54:57]
    s_add_u32 m0, s23, 116480
    v_exp_f32 v17, v17
    v_mfma_f32_16x16x32_bf16 v[28:31], a[132:135], a[4:7], v[28:31]
    buffer_load_dwordx4 v1, s[8:11], s26 offen offset:256 nt lds
    v_add_f32 v14, v14, v17
    v_mfma_f32_16x16x32_bf16 v[28:31], a[136:139], a[8:11], v[28:31]
    s_waitcnt vmcnt(3)
    v_exp_f32 v18, v18
    v_mfma_f32_16x16x32_bf16 v[28:31], a[140:143], a[12:15], v[28:31]
    s_barrier
    v_exp_f32 v19, v19
    v_mfma_f32_16x16x32_bf16 v[28:31], a[144:147], a[16:19], v[28:31]
    ds_read_b128 a[96:99], v2 offset:16384
    v_add_f32 v14, v14, v18
    v_mfma_f32_16x16x32_bf16 v[28:31], a[148:151], a[20:23], v[28:31]
    s_waitcnt lgkmcnt(1)
    v_cvt_pk_bf16_f32 v112, v16, v17
    v_cvt_pk_bf16_f32 v113, v18, v19
    v_mfma_f32_16x16x32_bf16 v[28:31], a[152:155], a[24:27], v[28:31]
    ds_read_b128 a[100:103], v3 offset:16384
    v_add_f32 v14, v14, v19
    v_mfma_f32_16x16x32_bf16 v[28:31], a[156:159], a[28:31], v[28:31]
    v_exp_f32 v20, v20
    v_mfma_f32_16x16x32_bf16 a[164:167], a[160:163], v[100:103], a[164:167]
    s_add_u32 m0, s23, 117376
    ds_read_b128 a[104:107], v2 offset:17408
    v_add_f32 v15, v15, v20
    v_mfma_f32_16x16x32_bf16 v[32:35], a[128:131], a[32:35], v[58:61]
    buffer_load_dwordx4 v1, s[8:11], s26 offen offset:384 nt lds
    v_mfma_f32_16x16x32_bf16 v[32:35], a[132:135], a[36:39], v[32:35]
    v_exp_f32 v21, v21
    v_mfma_f32_16x16x32_bf16 v[32:35], a[136:139], a[40:43], v[32:35]
    ds_read_b128 a[108:111], v3 offset:17408
    v_add_f32 v15, v15, v21
    v_mfma_f32_16x16x32_bf16 v[32:35], a[140:143], a[44:47], v[32:35]
    ds_read_b128 a[112:115], v2 offset:18432
    v_cvt_pk_bf16_f32 v116, v20, v21
    v_mfma_f32_16x16x32_bf16 v[32:35], a[144:147], a[48:51], v[32:35]
    v_exp_f32 v22, v22
    v_mfma_f32_16x16x32_bf16 v[32:35], a[148:151], a[52:55], v[32:35]
    ds_read_b128 a[116:119], v3 offset:18432
    v_add_f32 v15, v15, v22
    v_mfma_f32_16x16x32_bf16 v[32:35], a[152:155], a[56:59], v[32:35]
    v_exp_f32 v23, v23
    v_mfma_f32_16x16x32_bf16 v[32:35], a[156:159], a[60:63], v[32:35]
    s_add_u32 s26, s23, 131072
    ds_read_b128 a[120:123], v2 offset:19456
    v_cvt_pk_bf16_f32 v117, v22, v23
    v_mfma_f32_16x16x32_bf16 a[168:171], a[160:163], v[104:107], a[168:171]
    s_add_u32 m0, s23, 131072
    v_exp_f32 v24, v24
    v_mfma_f32_16x16x32_bf16 v[36:39], a[128:131], a[64:67], v[44:47]
    buffer_load_dwordx4 v1, s[8:11], s26 offen offset:0 nt lds
    ds_read_b128 a[124:127], v3 offset:19456
    v_mfma_f32_16x16x32_bf16 v[36:39], a[132:135], a[68:71], v[36:39]
    v_add_f32 v15, v15, v23
    v_add_f32 v48, v48, v24
    v_mfma_f32_16x16x32_bf16 v[36:39], a[136:139], a[72:75], v[36:39]
    v_exp_f32 v25, v25
    v_mfma_f32_16x16x32_bf16 v[36:39], a[140:143], a[76:79], v[36:39]
    v_exp_f32 v26, v26
    v_mfma_f32_16x16x32_bf16 v[36:39], a[144:147], a[80:83], v[36:39]
    v_add_f32 v48, v48, v25
    v_cvt_pk_bf16_f32 v120, v24, v25
    v_mfma_f32_16x16x32_bf16 v[36:39], a[148:151], a[84:87], v[36:39]
    v_exp_f32 v27, v27
    v_mfma_f32_16x16x32_bf16 v[36:39], a[152:155], a[88:91], v[36:39]
    v_add_f32 v48, v48, v26
    v_cvt_pk_bf16_f32 v121, v26, v27
    v_mfma_f32_16x16x32_bf16 v[36:39], a[156:159], a[92:95], v[36:39]
    s_add_u32 m0, s23, 131968
    v_exp_f32 v28, v28
    v_mfma_f32_16x16x32_bf16 a[172:175], a[160:163], v[108:111], a[172:175]
    s_waitcnt lgkmcnt(0)
    v_add_f32 v48, v48, v27
    v_add_f32 v14, v14, v28
    v_mfma_f32_16x16x32_bf16 v[16:19], a[96:99], a[0:3], v[54:57]
    buffer_load_dwordx4 v1, s[8:11], s26 offen offset:128 nt lds
    v_mfma_f32_16x16x32_bf16 v[16:19], a[100:103], a[4:7], v[16:19]
    v_exp_f32 v29, v29
    v_mfma_f32_16x16x32_bf16 v[16:19], a[104:107], a[8:11], v[16:19]
    v_exp_f32 v30, v30
    v_mfma_f32_16x16x32_bf16 v[16:19], a[108:111], a[12:15], v[16:19]
    v_add_f32 v14, v14, v29
    v_cvt_pk_bf16_f32 v114, v28, v29
    v_mfma_f32_16x16x32_bf16 v[16:19], a[112:115], a[16:19], v[16:19]
    ds_read_b128 a[128:131], v2 offset:24576
    v_add_f32 v14, v14, v30
    v_mfma_f32_16x16x32_bf16 v[16:19], a[116:119], a[20:23], v[16:19]
    v_exp_f32 v31, v31
    v_mfma_f32_16x16x32_bf16 v[16:19], a[120:123], a[24:27], v[16:19]
    s_add_u32 m0, s23, 132864
    ds_read_b128 a[132:135], v3 offset:24576
    v_cvt_pk_bf16_f32 v115, v30, v31
    v_mfma_f32_16x16x32_bf16 v[16:19], a[124:127], a[28:31], v[16:19]
    buffer_load_dwordx4 v1, s[8:11], s26 offen offset:256 nt lds
    v_add_f32 v14, v14, v31
    v_mfma_f32_16x16x32_bf16 v[20:23], a[96:99], a[32:35], v[58:61]
    v_exp_f32 v32, v32
    v_mfma_f32_16x16x32_bf16 v[20:23], a[100:103], a[36:39], v[20:23]
    ds_read_b128 a[136:139], v2 offset:25600
    v_add_f32 v15, v15, v32
    v_mfma_f32_16x16x32_bf16 v[20:23], a[104:107], a[40:43], v[20:23]
    v_exp_f32 v33, v33
    v_mfma_f32_16x16x32_bf16 v[20:23], a[108:111], a[44:47], v[20:23]
    ds_read_b128 a[140:143], v3 offset:25600
    v_add_f32 v15, v15, v33
    v_mfma_f32_16x16x32_bf16 v[20:23], a[112:115], a[48:51], v[20:23]
    ds_read_b128 a[144:147], v2 offset:26624
    v_cvt_pk_bf16_f32 v118, v32, v33
    v_mfma_f32_16x16x32_bf16 v[20:23], a[116:119], a[52:55], v[20:23]
    v_exp_f32 v34, v34
    v_mfma_f32_16x16x32_bf16 v[20:23], a[120:123], a[56:59], v[20:23]
    s_add_u32 m0, s23, 133760
    ds_read_b128 a[148:151], v3 offset:26624
    v_add_f32 v15, v15, v34
    v_mfma_f32_16x16x32_bf16 v[20:23], a[124:127], a[60:63], v[20:23]
    buffer_load_dwordx4 v1, s[8:11], s26 offen offset:384 nt lds
    v_mfma_f32_16x16x32_bf16 v[24:27], a[96:99], a[64:67], v[44:47]
    v_exp_f32 v35, v35
    v_mfma_f32_16x16x32_bf16 v[24:27], a[100:103], a[68:71], v[24:27]
    ds_read_b128 a[152:155], v2 offset:27648
    v_cvt_pk_bf16_f32 v119, v34, v35
    v_mfma_f32_16x16x32_bf16 v[24:27], a[104:107], a[72:75], v[24:27]
    ds_read_b128 a[156:159], v3 offset:27648
    v_add_f32 v15, v15, v35
    v_mfma_f32_16x16x32_bf16 v[24:27], a[108:111], a[76:79], v[24:27]
    v_exp_f32 v36, v36
    v_mfma_f32_16x16x32_bf16 v[24:27], a[112:115], a[80:83], v[24:27]
    s_add_u32 s26, s23, 147456
    v_exp_f32 v37, v37
    v_mfma_f32_16x16x32_bf16 v[24:27], a[116:119], a[84:87], v[24:27]
    s_add_u32 m0, s23, 147456
    v_add_f32 v48, v48, v36
    v_cvt_pk_bf16_f32 v122, v36, v37
    v_mfma_f32_16x16x32_bf16 v[24:27], a[120:123], a[88:91], v[24:27]
    s_waitcnt lgkmcnt(2)
    v_exp_f32 v38, v38
    v_mfma_f32_16x16x32_bf16 v[24:27], a[124:127], a[92:95], v[24:27]
    buffer_load_dwordx4 v1, s[8:11], s26 offen offset:0 nt lds
    v_add_f32 v48, v48, v37
    v_mfma_f32_16x16x32_bf16 v[28:31], a[128:131], a[0:3], v[54:57]
    v_exp_f32 v39, v39
    v_mfma_f32_16x16x32_bf16 v[28:31], a[132:135], a[4:7], v[28:31]
    v_add_f32 v48, v48, v38
    v_cvt_pk_bf16_f32 v123, v38, v39
    v_mfma_f32_16x16x32_bf16 v[28:31], a[136:139], a[8:11], v[28:31]
    v_exp_f32 v16, v16
    v_mfma_f32_16x16x32_bf16 v[28:31], a[140:143], a[12:15], v[28:31]
    v_add_f32 v48, v48, v39
    v_add_f32 v14, v14, v16
    v_mfma_f32_16x16x32_bf16 v[28:31], a[144:147], a[16:19], v[28:31]
    s_add_u32 m0, s23, 148352
    v_exp_f32 v17, v17
    v_mfma_f32_16x16x32_bf16 v[28:31], a[148:151], a[20:23], v[28:31]
    s_waitcnt lgkmcnt(0)
    ds_read_b128 a[96:99], v2 offset:32768
    v_add_f32 v14, v14, v17
    v_mfma_f32_16x16x32_bf16 v[28:31], a[152:155], a[24:27], v[28:31]
    buffer_load_dwordx4 v1, s[8:11], s26 offen offset:128 nt lds
    ds_read_b128 a[100:103], v3 offset:32768
    v_mfma_f32_16x16x32_bf16 v[28:31], a[156:159], a[28:31], v[28:31]
    v_exp_f32 v18, v18
    v_mfma_f32_16x16x32_bf16 v[32:35], a[128:131], a[32:35], v[58:61]
    ds_read_b128 a[104:107], v2 offset:33792
    v_add_f32 v14, v14, v18
    v_mfma_f32_16x16x32_bf16 v[32:35], a[132:135], a[36:39], v[32:35]
    v_exp_f32 v19, v19
    v_mfma_f32_16x16x32_bf16 v[32:35], a[136:139], a[40:43], v[32:35]
    ds_read_b128 a[108:111], v3 offset:33792
    v_cvt_pk_bf16_f32 v124, v16, v17
    v_mfma_f32_16x16x32_bf16 v[32:35], a[140:143], a[44:47], v[32:35]
    v_cvt_pk_bf16_f32 v125, v18, v19
    v_add_f32 v14, v14, v19
    v_mfma_f32_16x16x32_bf16 v[32:35], a[144:147], a[48:51], v[32:35]
    v_exp_f32 v20, v20
    v_mfma_f32_16x16x32_bf16 v[32:35], a[148:151], a[52:55], v[32:35]
    s_add_u32 m0, s23, 149248
    ds_read_b128 a[112:115], v2 offset:34816
    v_add_f32 v15, v15, v20
    v_mfma_f32_16x16x32_bf16 v[32:35], a[152:155], a[56:59], v[32:35]
    buffer_load_dwordx4 v1, s[8:11], s26 offen offset:256 nt lds
    ds_read_b128 a[116:119], v3 offset:34816
    v_mfma_f32_16x16x32_bf16 v[32:35], a[156:159], a[60:63], v[32:35]
    v_exp_f32 v21, v21
    v_mfma_f32_16x16x32_bf16 v[36:39], a[128:131], a[64:67], v[44:47]
    ds_read_b128 a[120:123], v2 offset:35840
    v_add_f32 v15, v15, v21
    v_mfma_f32_16x16x32_bf16 v[36:39], a[132:135], a[68:71], v[36:39]
    v_exp_f32 v22, v22
    v_mfma_f32_16x16x32_bf16 v[36:39], a[136:139], a[72:75], v[36:39]
    ds_read_b128 a[124:127], v3 offset:35840
    v_add_f32 v15, v15, v22
    v_mfma_f32_16x16x32_bf16 v[36:39], a[140:143], a[76:79], v[36:39]
    v_exp_f32 v23, v23
    v_mfma_f32_16x16x32_bf16 v[36:39], a[144:147], a[80:83], v[36:39]
    v_cvt_pk_bf16_f32 v128, v20, v21
    v_cvt_pk_bf16_f32 v129, v22, v23
    v_mfma_f32_16x16x32_bf16 v[36:39], a[148:151], a[84:87], v[36:39]
    s_add_u32 m0, s23, 150144
    v_exp_f32 v24, v24
    v_mfma_f32_16x16x32_bf16 v[36:39], a[152:155], a[88:91], v[36:39]
    buffer_load_dwordx4 v1, s[8:11], s26 offen offset:384 nt lds
    v_add_f32 v15, v15, v23
    v_mfma_f32_16x16x32_bf16 v[36:39], a[156:159], a[92:95], v[36:39]
    s_waitcnt lgkmcnt(2)
    v_exp_f32 v25, v25
    v_mfma_f32_16x16x32_bf16 v[16:19], a[96:99], a[0:3], v[54:57]
    v_add_f32 v48, v48, v24
    v_cvt_pk_bf16_f32 v132, v24, v25
    v_mfma_f32_16x16x32_bf16 v[16:19], a[100:103], a[4:7], v[16:19]
    v_exp_f32 v26, v26
    v_mfma_f32_16x16x32_bf16 v[16:19], a[104:107], a[8:11], v[16:19]
    s_add_u32 s26, s23, 163840
    v_exp_f32 v27, v27
    v_mfma_f32_16x16x32_bf16 v[16:19], a[108:111], a[12:15], v[16:19]
    s_add_u32 m0, s23, 0
    v_add_f32 v48, v48, v25
    v_cvt_pk_bf16_f32 v133, v26, v27
    v_mfma_f32_16x16x32_bf16 v[16:19], a[112:115], a[16:19], v[16:19]
    s_waitcnt lgkmcnt(0)
    ds_read_b128 a[128:131], v2 offset:40960
    v_add_f32 v48, v48, v26
    v_mfma_f32_16x16x32_bf16 v[16:19], a[116:119], a[20:23], v[16:19]
    buffer_load_dwordx4 v1, s[8:11], s26 offen offset:0 nt lds
    v_add_f32 v48, v48, v27
    v_mfma_f32_16x16x32_bf16 v[16:19], a[120:123], a[24:27], v[16:19]
    v_exp_f32 v28, v28
    v_mfma_f32_16x16x32_bf16 v[16:19], a[124:127], a[28:31], v[16:19]
    ds_read_b128 a[132:135], v3 offset:40960
    v_add_f32 v14, v14, v28
    v_mfma_f32_16x16x32_bf16 v[20:23], a[96:99], a[32:35], v[58:61]
    v_exp_f32 v29, v29
    v_mfma_f32_16x16x32_bf16 v[20:23], a[100:103], a[36:39], v[20:23]
    ds_read_b128 a[136:139], v2 offset:41984
    v_add_f32 v14, v14, v29
    v_mfma_f32_16x16x32_bf16 v[20:23], a[104:107], a[40:43], v[20:23]
    ds_read_b128 a[140:143], v3 offset:41984
    v_cvt_pk_bf16_f32 v126, v28, v29
    v_mfma_f32_16x16x32_bf16 v[20:23], a[108:111], a[44:47], v[20:23]
    v_exp_f32 v30, v30
    v_mfma_f32_16x16x32_bf16 v[20:23], a[112:115], a[48:51], v[20:23]
    s_add_u32 m0, s23, 896
    ds_read_b128 a[144:147], v2 offset:43008
    v_add_f32 v14, v14, v30
    v_mfma_f32_16x16x32_bf16 v[20:23], a[116:119], a[52:55], v[20:23]
    buffer_load_dwordx4 v1, s[8:11], s26 offen offset:128 nt lds
    v_mfma_f32_16x16x32_bf16 v[20:23], a[120:123], a[56:59], v[20:23]
    v_exp_f32 v31, v31
    v_mfma_f32_16x16x32_bf16 v[20:23], a[124:127], a[60:63], v[20:23]
    ds_read_b128 a[148:151], v3 offset:43008
    v_cvt_pk_bf16_f32 v127, v30, v31
    v_mfma_f32_16x16x32_bf16 v[24:27], a[96:99], a[64:67], v[44:47]
    ds_read_b128 a[152:155], v2 offset:44032
    v_add_f32 v14, v14, v31
    v_mfma_f32_16x16x32_bf16 v[24:27], a[100:103], a[68:71], v[24:27]
    v_exp_f32 v32, v32
    v_mfma_f32_16x16x32_bf16 v[24:27], a[104:107], a[72:75], v[24:27]
    ds_read_b128 a[156:159], v3 offset:44032
    v_add_f32 v15, v15, v32
    v_mfma_f32_16x16x32_bf16 v[24:27], a[108:111], a[76:79], v[24:27]
    v_exp_f32 v33, v33
    v_mfma_f32_16x16x32_bf16 v[24:27], a[112:115], a[80:83], v[24:27]
    s_add_u32 m0, s23, 1792
    v_exp_f32 v34, v34
    v_mfma_f32_16x16x32_bf16 v[24:27], a[116:119], a[84:87], v[24:27]
    buffer_load_dwordx4 v1, s[8:11], s26 offen offset:256 nt lds
    v_add_f32 v15, v15, v33
    v_mfma_f32_16x16x32_bf16 v[24:27], a[120:123], a[88:91], v[24:27]
    v_exp_f32 v35, v35
    v_mfma_f32_16x16x32_bf16 v[24:27], a[124:127], a[92:95], v[24:27]
    s_waitcnt lgkmcnt(2)
    v_add_f32 v15, v15, v34
    v_cvt_pk_bf16_f32 v130, v32, v33
    v_mfma_f32_16x16x32_bf16 v[28:31], a[128:131], a[0:3], v[54:57]
    v_cvt_pk_bf16_f32 v131, v34, v35
    v_add_f32 v15, v15, v35
    v_mfma_f32_16x16x32_bf16 v[28:31], a[132:135], a[4:7], v[28:31]
    s_add_u32 m0, s23, 2688
    v_exp_f32 v36, v36
    v_mfma_f32_16x16x32_bf16 v[28:31], a[136:139], a[8:11], v[28:31]
    s_waitcnt vmcnt(7)
    v_exp_f32 v37, v37
    v_mfma_f32_16x16x32_bf16 v[28:31], a[140:143], a[12:15], v[28:31]
    s_barrier
    v_add_f32 v48, v48, v36
    v_cvt_pk_bf16_f32 v134, v36, v37
    v_mfma_f32_16x16x32_bf16 v[28:31], a[144:147], a[16:19], v[28:31]
    buffer_load_dwordx4 v1, s[8:11], s26 offen offset:384 nt lds
    ds_read_b128 a[96:99], v2 offset:49152
    v_mfma_f32_16x16x32_bf16 v[28:31], a[148:151], a[20:23], v[28:31]
    s_waitcnt lgkmcnt(1)
    v_exp_f32 v38, v38
    v_mfma_f32_16x16x32_bf16 v[28:31], a[152:155], a[24:27], v[28:31]
    ds_read_b128 a[100:103], v3 offset:49152
    v_add_f32 v48, v48, v37
    v_mfma_f32_16x16x32_bf16 v[28:31], a[156:159], a[28:31], v[28:31]
    v_exp_f32 v39, v39
    v_mfma_f32_16x16x32_bf16 v[32:35], a[128:131], a[32:35], v[58:61]
    ds_read_b128 a[104:107], v2 offset:50176
    v_add_f32 v48, v48, v38
    v_mfma_f32_16x16x32_bf16 v[32:35], a[132:135], a[36:39], v[32:35]
    v_cvt_pk_bf16_f32 v135, v38, v39
    v_add_f32 v48, v48, v39
    v_mfma_f32_16x16x32_bf16 v[32:35], a[136:139], a[40:43], v[32:35]
    s_add_u32 s26, s23, 180224
    v_exp_f32 v16, v16
    v_mfma_f32_16x16x32_bf16 v[32:35], a[140:143], a[44:47], v[32:35]
    s_add_u32 m0, s23, 16384
    v_exp_f32 v17, v17
    v_mfma_f32_16x16x32_bf16 v[32:35], a[144:147], a[48:51], v[32:35]
    buffer_load_dwordx4 v1, s[8:11], s26 offen offset:0 nt lds
    ds_read_b128 a[108:111], v3 offset:50176
    v_mfma_f32_16x16x32_bf16 v[32:35], a[148:151], a[52:55], v[32:35]
    ds_read_b128 a[112:115], v2 offset:51200
    v_cvt_pk_bf16_f32 v136, v16, v17
    v_mfma_f32_16x16x32_bf16 v[32:35], a[152:155], a[56:59], v[32:35]
    v_exp_f32 v18, v18
    v_mfma_f32_16x16x32_bf16 v[32:35], a[156:159], a[60:63], v[32:35]
    v_exp_f32 v19, v19
    v_mfma_f32_16x16x32_bf16 v[36:39], a[128:131], a[64:67], v[44:47]
    ds_read_b128 a[116:119], v3 offset:51200
    ds_read_b128 a[120:123], v2 offset:52224
    v_mfma_f32_16x16x32_bf16 v[36:39], a[132:135], a[68:71], v[36:39]
    v_exp_f32 v20, v20
    v_mfma_f32_16x16x32_bf16 v[36:39], a[136:139], a[72:75], v[36:39]
    ds_read_b128 a[124:127], v3 offset:52224
    v_cvt_pk_bf16_f32 v137, v18, v19
    v_mfma_f32_16x16x32_bf16 v[36:39], a[140:143], a[76:79], v[36:39]
    s_add_u32 m0, s23, 17280
    v_exp_f32 v21, v21
    v_mfma_f32_16x16x32_bf16 v[36:39], a[144:147], a[80:83], v[36:39]
    buffer_load_dwordx4 v1, s[8:11], s26 offen offset:128 nt lds
    v_cvt_pk_bf16_f32 v140, v20, v21
    v_mfma_f32_16x16x32_bf16 v[36:39], a[148:151], a[84:87], v[36:39]
    v_exp_f32 v22, v22
    v_mfma_f32_16x16x32_bf16 v[36:39], a[152:155], a[88:91], v[36:39]
    v_exp_f32 v23, v23
    v_mfma_f32_16x16x32_bf16 v[36:39], a[156:159], a[92:95], v[36:39]
    s_waitcnt lgkmcnt(3)
    v_exp_f32 v24, v24
    v_mfma_f32_16x16x32_bf16 v[16:19], a[96:99], a[0:3], v[54:57]
    v_exp_f32 v25, v25
    v_mfma_f32_16x16x32_bf16 v[16:19], a[100:103], a[4:7], v[16:19]
    v_cvt_pk_bf16_f32 v141, v22, v23
    v_cvt_pk_bf16_f32 v144, v24, v25
    v_mfma_f32_16x16x32_bf16 v[16:19], a[104:107], a[8:11], v[16:19]
    s_add_u32 m0, s23, 18176
    v_exp_f32 v26, v26
    v_mfma_f32_16x16x32_bf16 v[16:19], a[108:111], a[12:15], v[16:19]
    buffer_load_dwordx4 v1, s[8:11], s26 offen offset:256 nt lds
    v_mfma_f32_16x16x32_bf16 v[16:19], a[112:115], a[16:19], v[16:19]
    s_waitcnt lgkmcnt(0)
    v_exp_f32 v27, v27
    v_mfma_f32_16x16x32_bf16 v[16:19], a[116:119], a[20:23], v[16:19]
    ds_read_b128 a[128:131], v2 offset:57344
    v_cvt_pk_bf16_f32 v145, v26, v27
    v_mfma_f32_16x16x32_bf16 v[16:19], a[120:123], a[24:27], v[16:19]
    v_exp_f32 v28, v28
    v_mfma_f32_16x16x32_bf16 v[16:19], a[124:127], a[28:31], v[16:19]
    v_exp_f32 v29, v29
    v_mfma_f32_16x16x32_bf16 v[20:23], a[96:99], a[32:35], v[58:61]
    ds_read_b128 a[132:135], v3 offset:57344
    ds_read_b128 a[136:139], v2 offset:58368
    v_mfma_f32_16x16x32_bf16 v[20:23], a[100:103], a[36:39], v[20:23]
    v_exp_f32 v30, v30
    v_mfma_f32_16x16x32_bf16 v[20:23], a[104:107], a[40:43], v[20:23]
    s_add_u32 m0, s23, 19072
    ds_read_b128 a[140:143], v3 offset:58368
    v_cvt_pk_bf16_f32 v138, v28, v29
    v_mfma_f32_16x16x32_bf16 v[20:23], a[108:111], a[44:47], v[20:23]
    buffer_load_dwordx4 v1, s[8:11], s26 offen offset:384 nt lds
    v_mfma_f32_16x16x32_bf16 v[20:23], a[112:115], a[48:51], v[20:23]
    v_exp_f32 v31, v31
    v_mfma_f32_16x16x32_bf16 v[20:23], a[116:119], a[52:55], v[20:23]
    ds_read_b128 a[144:147], v2 offset:59392
    v_cvt_pk_bf16_f32 v139, v30, v31
    v_mfma_f32_16x16x32_bf16 v[20:23], a[120:123], a[56:59], v[20:23]
    v_exp_f32 v32, v32
    v_mfma_f32_16x16x32_bf16 v[20:23], a[124:127], a[60:63], v[20:23]
    v_exp_f32 v33, v33
    v_mfma_f32_16x16x32_bf16 v[24:27], a[96:99], a[64:67], v[44:47]
    ds_read_b128 a[148:151], v3 offset:59392
    ds_read_b128 a[152:155], v2 offset:60416
    v_mfma_f32_16x16x32_bf16 v[24:27], a[100:103], a[68:71], v[24:27]
    s_add_u32 s26, s23, 196608
    v_exp_f32 v34, v34
    v_mfma_f32_16x16x32_bf16 v[24:27], a[104:107], a[72:75], v[24:27]
    s_add_u32 m0, s23, 32768
    ds_read_b128 a[156:159], v3 offset:60416
    v_cvt_pk_bf16_f32 v142, v32, v33
    v_mfma_f32_16x16x32_bf16 v[24:27], a[108:111], a[76:79], v[24:27]
    buffer_load_dwordx4 v1, s[8:11], s26 offen offset:0 nt lds
    v_add_u32 v2, 0x10000, v2
    v_mfma_f32_16x16x32_bf16 v[24:27], a[112:115], a[80:83], v[24:27]
    v_exp_f32 v35, v35
    v_mfma_f32_16x16x32_bf16 v[24:27], a[116:119], a[84:87], v[24:27]
    v_add_u32 v3, 0x10000, v3
    v_cvt_pk_bf16_f32 v143, v34, v35
    v_mfma_f32_16x16x32_bf16 v[24:27], a[120:123], a[88:91], v[24:27]
    v_exp_f32 v36, v36
    v_mfma_f32_16x16x32_bf16 v[24:27], a[124:127], a[92:95], v[24:27]
    s_waitcnt lgkmcnt(3)
    v_exp_f32 v37, v37
    v_mfma_f32_16x16x32_bf16 v[28:31], a[128:131], a[0:3], v[54:57]
    v_exp_f32 v38, v38
    v_mfma_f32_16x16x32_bf16 v[28:31], a[132:135], a[4:7], v[28:31]
    v_exp_f32 v39, v39
    v_mfma_f32_16x16x32_bf16 v[28:31], a[136:139], a[8:11], v[28:31]
    s_add_u32 m0, s23, 33664
    v_cvt_pk_bf16_f32 v146, v36, v37
    v_cvt_pk_bf16_f32 v147, v38, v39
    v_mfma_f32_16x16x32_bf16 v[28:31], a[140:143], a[12:15], v[28:31]
    buffer_load_dwordx4 v1, s[8:11], s26 offen offset:128 nt lds
    v_mfma_f32_16x16x32_bf16 v[28:31], a[144:147], a[16:19], v[28:31]
    s_waitcnt lgkmcnt(0)
    v_exp_f32 v16, v16
    v_mfma_f32_16x16x32_bf16 v[28:31], a[148:151], a[20:23], v[28:31]
    ds_read_b128 a[96:99], v2 offset:0
    v_add_f32 v14, v14, v16
    v_mfma_f32_16x16x32_bf16 v[28:31], a[152:155], a[24:27], v[28:31]
    v_exp_f32 v17, v17
    v_mfma_f32_16x16x32_bf16 v[28:31], a[156:159], a[28:31], v[28:31]
    ds_read_b128 a[100:103], v3 offset:0
    v_add_f32 v14, v14, v17
    v_mfma_f32_16x16x32_bf16 a[164:167], a[160:163], v[136:139], a[164:167]
    ds_read_b128 a[104:107], v2 offset:1024
    v_cvt_pk_bf16_f32 v148, v16, v17
    v_mfma_f32_16x16x32_bf16 v[32:35], a[128:131], a[32:35], v[58:61]
    v_exp_f32 v18, v18
    v_mfma_f32_16x16x32_bf16 v[32:35], a[132:135], a[36:39], v[32:35]
    s_add_u32 m0, s23, 34560
    ds_read_b128 a[108:111], v3 offset:1024
    v_add_f32 v14, v14, v18
    v_mfma_f32_16x16x32_bf16 v[32:35], a[136:139], a[40:43], v[32:35]
    buffer_load_dwordx4 v1, s[8:11], s26 offen offset:256 nt lds
    v_mfma_f32_16x16x32_bf16 v[32:35], a[140:143], a[44:47], v[32:35]
    v_exp_f32 v19, v19
    v_mfma_f32_16x16x32_bf16 v[32:35], a[144:147], a[48:51], v[32:35]
    ds_read_b128 a[112:115], v2 offset:2048
    v_cvt_pk_bf16_f32 v149, v18, v19
    v_mfma_f32_16x16x32_bf16 v[32:35], a[148:151], a[52:55], v[32:35]
    ds_read_b128 a[116:119], v3 offset:2048
    v_add_f32 v14, v14, v19
    v_mfma_f32_16x16x32_bf16 v[32:35], a[152:155], a[56:59], v[32:35]
    v_exp_f32 v20, v20
    v_mfma_f32_16x16x32_bf16 v[32:35], a[156:159], a[60:63], v[32:35]
    ds_read_b128 a[120:123], v2 offset:3072
    v_add_f32 v15, v15, v20
    v_mfma_f32_16x16x32_bf16 a[168:171], a[160:163], v[140:143], a[168:171]
    v_exp_f32 v21, v21
    v_mfma_f32_16x16x32_bf16 v[36:39], a[128:131], a[64:67], v[44:47]
    ds_read_b128 a[124:127], v3 offset:3072
    v_add_f32 v15, v15, v21
    v_mfma_f32_16x16x32_bf16 v[36:39], a[132:135], a[68:71], v[36:39]
    s_add_u32 m0, s23, 35456
    v_exp_f32 v22, v22
    v_mfma_f32_16x16x32_bf16 v[36:39], a[136:139], a[72:75], v[36:39]
    buffer_load_dwordx4 v1, s[8:11], s26 offen offset:384 nt lds
    v_add_f32 v15, v15, v22
    v_mfma_f32_16x16x32_bf16 v[36:39], a[140:143], a[76:79], v[36:39]
    v_exp_f32 v23, v23
    v_mfma_f32_16x16x32_bf16 v[36:39], a[144:147], a[80:83], v[36:39]
    v_cvt_pk_bf16_f32 v152, v20, v21
    v_cvt_pk_bf16_f32 v153, v22, v23
    v_mfma_f32_16x16x32_bf16 v[36:39], a[148:151], a[84:87], v[36:39]
    v_exp_f32 v24, v24
    v_mfma_f32_16x16x32_bf16 v[36:39], a[152:155], a[88:91], v[36:39]
    v_add_f32 v15, v15, v23
    v_add_f32 v48, v48, v24
    v_mfma_f32_16x16x32_bf16 v[36:39], a[156:159], a[92:95], v[36:39]
    s_add_u32 s26, s23, 212992
    v_exp_f32 v25, v25
    v_mfma_f32_16x16x32_bf16 a[172:175], a[160:163], v[144:147], a[172:175]
    s_waitcnt lgkmcnt(0)
    v_exp_f32 v26, v26
    v_mfma_f32_16x16x32_bf16 v[16:19], a[96:99], a[0:3], v[54:57]
    s_add_u32 m0, s23, 49152
    v_add_f32 v48, v48, v25
    v_cvt_pk_bf16_f32 v156, v24, v25
    v_mfma_f32_16x16x32_bf16 v[16:19], a[100:103], a[4:7], v[16:19]
    buffer_load_dwordx4 v1, s[8:11], s26 offen offset:0 nt lds
    v_add_f32 v48, v48, v26
    v_mfma_f32_16x16x32_bf16 v[16:19], a[104:107], a[8:11], v[16:19]
    v_exp_f32 v27, v27
    v_mfma_f32_16x16x32_bf16 v[16:19], a[108:111], a[12:15], v[16:19]
    v_cvt_pk_bf16_f32 v157, v26, v27
    v_add_f32 v48, v48, v27
    v_mfma_f32_16x16x32_bf16 v[16:19], a[112:115], a[16:19], v[16:19]
    v_exp_f32 v28, v28
    v_mfma_f32_16x16x32_bf16 v[16:19], a[116:119], a[20:23], v[16:19]
    ds_read_b128 a[128:131], v2 offset:8192
    v_add_f32 v14, v14, v28
    v_mfma_f32_16x16x32_bf16 v[16:19], a[120:123], a[24:27], v[16:19]
    v_exp_f32 v29, v29
    v_mfma_f32_16x16x32_bf16 v[16:19], a[124:127], a[28:31], v[16:19]
    ds_read_b128 a[132:135], v3 offset:8192
    v_add_f32 v14, v14, v29
    v_mfma_f32_16x16x32_bf16 v[20:23], a[96:99], a[32:35], v[58:61]
    s_add_u32 m0, s23, 50048
    ds_read_b128 a[136:139], v2 offset:9216
    v_cvt_pk_bf16_f32 v150, v28, v29
    v_mfma_f32_16x16x32_bf16 v[20:23], a[100:103], a[36:39], v[20:23]
    buffer_load_dwordx4 v1, s[8:11], s26 offen offset:128 nt lds
    v_mfma_f32_16x16x32_bf16 v[20:23], a[104:107], a[40:43], v[20:23]
    v_exp_f32 v30, v30
    v_mfma_f32_16x16x32_bf16 v[20:23], a[108:111], a[44:47], v[20:23]
    ds_read_b128 a[140:143], v3 offset:9216
    v_add_f32 v14, v14, v30
    v_mfma_f32_16x16x32_bf16 v[20:23], a[112:115], a[48:51], v[20:23]
    v_exp_f32 v31, v31
    v_mfma_f32_16x16x32_bf16 v[20:23], a[116:119], a[52:55], v[20:23]
    ds_read_b128 a[144:147], v2 offset:10240
    v_cvt_pk_bf16_f32 v151, v30, v31
    v_mfma_f32_16x16x32_bf16 v[20:23], a[120:123], a[56:59], v[20:23]
    ds_read_b128 a[148:151], v3 offset:10240
    v_add_f32 v14, v14, v31
    v_mfma_f32_16x16x32_bf16 v[20:23], a[124:127], a[60:63], v[20:23]
    v_exp_f32 v32, v32
    v_mfma_f32_16x16x32_bf16 v[24:27], a[96:99], a[64:67], v[44:47]
    s_add_u32 m0, s23, 50944
    ds_read_b128 a[152:155], v2 offset:11264
    v_add_f32 v15, v15, v32
    v_mfma_f32_16x16x32_bf16 v[24:27], a[100:103], a[68:71], v[24:27]
L_pg2:
    s_cbranch_execz L_pg6
    buffer_load_dwordx4 v1, s[8:11], s26 offen offset:256 nt lds
    v_mfma_f32_16x16x32_bf16 v[24:27], a[104:107], a[72:75], v[24:27]
    v_exp_f32 v33, v33
    v_mfma_f32_16x16x32_bf16 v[24:27], a[108:111], a[76:79], v[24:27]
    ds_read_b128 a[156:159], v3 offset:11264
    v_add_f32 v15, v15, v33
    v_mfma_f32_16x16x32_bf16 v[24:27], a[112:115], a[80:83], v[24:27]
    v_exp_f32 v34, v34
    v_mfma_f32_16x16x32_bf16 v[24:27], a[116:119], a[84:87], v[24:27]
    v_exp_f32 v35, v35
    v_mfma_f32_16x16x32_bf16 v[24:27], a[120:123], a[88:91], v[24:27]
    s_add_u32 m0, s23, 51840
    v_add_f32 v15, v15, v34
    v_cvt_pk_bf16_f32 v154, v32, v33
    v_mfma_f32_16x16x32_bf16 v[24:27], a[124:127], a[92:95], v[24:27]
    s_waitcnt lgkmcnt(2)
    v_cvt_pk_bf16_f32 v155, v34, v35
    v_add_f32 v15, v15, v35
    v_mfma_f32_16x16x32_bf16 v[28:31], a[128:131], a[0:3], v[54:57]
    buffer_load_dwordx4 v1, s[8:11], s26 offen offset:384 nt lds
    v_mfma_f32_16x16x32_bf16 v[28:31], a[132:135], a[4:7], v[28:31]
    v_exp_f32 v36, v36
    v_mfma_f32_16x16x32_bf16 v[28:31], a[136:139], a[8:11], v[28:31]
    s_waitcnt vmcnt(12)
    v_exp_f32 v37, v37
    v_add_f32 v48, v48, v36
    v_mfma_f32_16x16x32_bf16 v[28:31], a[140:143], a[12:15], v[28:31]
    s_barrier
    v_exp_f32 v38, v38
    v_add_f32 v48, v48, v37
    v_mfma_f32_16x16x32_bf16 v[28:31], a[144:147], a[16:19], v[28:31]
    ds_read_b128 a[96:99], v2 offset:16384
    v_add_f32 v48, v48, v38
    v_mfma_f32_16x16x32_bf16 v[28:31], a[148:151], a[20:23], v[28:31]
    s_waitcnt lgkmcnt(1)
    v_exp_f32 v39, v39
    v_mfma_f32_16x16x32_bf16 v[28:31], a[152:155], a[24:27], v[28:31]
    s_add_u32 s26, s23, 229376
    ds_read_b128 a[100:103], v3 offset:16384
    v_cvt_pk_bf16_f32 v158, v36, v37
    v_mfma_f32_16x16x32_bf16 v[28:31], a[156:159], a[28:31], v[28:31]
    s_add_u32 m0, s23, 65536
    v_cvt_pk_bf16_f32 v159, v38, v39
    v_add_f32 v48, v48, v39
    v_mfma_f32_16x16x32_bf16 v[32:35], a[128:131], a[32:35], v[58:61]
    buffer_load_dwordx4 v1, s[8:11], s26 offen offset:0 nt lds
    ds_read_b128 a[104:107], v2 offset:17408
    v_mfma_f32_16x16x32_bf16 v[32:35], a[132:135], a[36:39], v[32:35]
    v_exp_f32 v16, v16
    v_mfma_f32_16x16x32_bf16 v[32:35], a[136:139], a[40:43], v[32:35]
    ds_read_b128 a[108:111], v3 offset:17408
    v_add_f32 v14, v14, v16
    v_mfma_f32_16x16x32_bf16 v[32:35], a[140:143], a[44:47], v[32:35]
    v_exp_f32 v17, v17
    v_mfma_f32_16x16x32_bf16 v[32:35], a[144:147], a[48:51], v[32:35]
    ds_read_b128 a[112:115], v2 offset:18432
    v_add_f32 v14, v14, v17
    v_cvt_pk_bf16_f32 v160, v16, v17
    v_mfma_f32_16x16x32_bf16 v[32:35], a[148:151], a[52:55], v[32:35]
    v_exp_f32 v18, v18
    v_mfma_f32_16x16x32_bf16 v[32:35], a[152:155], a[56:59], v[32:35]
    ds_read_b128 a[116:119], v3 offset:18432
    v_add_f32 v14, v14, v18
    v_mfma_f32_16x16x32_bf16 v[32:35], a[156:159], a[60:63], v[32:35]
    s_add_u32 m0, s23, 66432
    v_exp_f32 v19, v19
    v_mfma_f32_16x16x32_bf16 v[36:39], a[128:131], a[64:67], v[44:47]
    buffer_load_dwordx4 v1, s[8:11], s26 offen offset:128 nt lds
    ds_read_b128 a[120:123], v2 offset:19456
    v_cvt_pk_bf16_f32 v161, v18, v19
    v_mfma_f32_16x16x32_bf16 v[36:39], a[132:135], a[68:71], v[36:39]
    v_exp_f32 v20, v20
    v_add_f32 v14, v14, v19
    v_mfma_f32_16x16x32_bf16 v[36:39], a[136:139], a[72:75], v[36:39]
    ds_read_b128 a[124:127], v3 offset:19456
    v_add_f32 v15, v15, v20
    v_mfma_f32_16x16x32_bf16 v[36:39], a[140:143], a[76:79], v[36:39]
    v_exp_f32 v21, v21
    v_mfma_f32_16x16x32_bf16 v[36:39], a[144:147], a[80:83], v[36:39]
    v_exp_f32 v22, v22
    v_add_f32 v15, v15, v21
    v_mfma_f32_16x16x32_bf16 v[36:39], a[148:151], a[84:87], v[36:39]
    v_exp_f32 v23, v23
    v_add_f32 v15, v15, v22
    v_mfma_f32_16x16x32_bf16 v[36:39], a[152:155], a[88:91], v[36:39]
    s_add_u32 m0, s23, 67328
    v_cvt_pk_bf16_f32 v164, v20, v21
    v_cvt_pk_bf16_f32 v165, v22, v23
    v_mfma_f32_16x16x32_bf16 v[36:39], a[156:159], a[92:95], v[36:39]
    s_waitcnt lgkmcnt(2)
    v_exp_f32 v24, v24
    v_mfma_f32_16x16x32_bf16 v[16:19], a[96:99], a[0:3], v[54:57]
    buffer_load_dwordx4 v1, s[8:11], s26 offen offset:256 nt lds
    v_add_f32 v15, v15, v23
    v_mfma_f32_16x16x32_bf16 v[16:19], a[100:103], a[4:7], v[16:19]
    v_exp_f32 v25, v25
    v_mfma_f32_16x16x32_bf16 v[16:19], a[104:107], a[8:11], v[16:19]
    v_add_f32 v48, v48, v24
    v_cvt_pk_bf16_f32 v168, v24, v25
    v_mfma_f32_16x16x32_bf16 v[16:19], a[108:111], a[12:15], v[16:19]
    v_exp_f32 v26, v26
    v_mfma_f32_16x16x32_bf16 v[16:19], a[112:115], a[16:19], v[16:19]
    ds_read_b128 a[128:131], v2 offset:24576
    v_add_f32 v48, v48, v25
    v_mfma_f32_16x16x32_bf16 v[16:19], a[116:119], a[20:23], v[16:19]
    s_waitcnt lgkmcnt(1)
    v_exp_f32 v27, v27
    v_mfma_f32_16x16x32_bf16 v[16:19], a[120:123], a[24:27], v[16:19]
    s_add_u32 m0, s23, 68224
    ds_read_b128 a[132:135], v3 offset:24576
    v_add_f32 v48, v48, v26
    v_mfma_f32_16x16x32_bf16 v[16:19], a[124:127], a[28:31], v[16:19]
    buffer_load_dwordx4 v1, s[8:11], s26 offen offset:384 nt lds
    v_cvt_pk_bf16_f32 v169, v26, v27
    v_mfma_f32_16x16x32_bf16 v[20:23], a[96:99], a[32:35], v[58:61]
    ds_read_b128 a[136:139], v2 offset:25600
    v_add_f32 v48, v48, v27
    v_mfma_f32_16x16x32_bf16 v[20:23], a[100:103], a[36:39], v[20:23]
    v_exp_f32 v28, v28
    v_mfma_f32_16x16x32_bf16 v[20:23], a[104:107], a[40:43], v[20:23]
    ds_read_b128 a[140:143], v3 offset:25600
    v_add_f32 v14, v14, v28
    v_mfma_f32_16x16x32_bf16 v[20:23], a[108:111], a[44:47], v[20:23]
    v_exp_f32 v29, v29
    v_mfma_f32_16x16x32_bf16 v[20:23], a[112:115], a[48:51], v[20:23]
    ds_read_b128 a[144:147], v2 offset:26624
    v_add_f32 v14, v14, v29
    v_mfma_f32_16x16x32_bf16 v[20:23], a[116:119], a[52:55], v[20:23]
    s_add_u32 s26, s23, 245760
    v_exp_f32 v30, v30
    v_mfma_f32_16x16x32_bf16 v[20:23], a[120:123], a[56:59], v[20:23]
    s_add_u32 m0, s23, 81920
    ds_read_b128 a[148:151], v3 offset:26624
    v_add_f32 v14, v14, v30
    v_mfma_f32_16x16x32_bf16 v[20:23], a[124:127], a[60:63], v[20:23]
    buffer_load_dwordx4 v1, s[8:11], s26 offen offset:0 nt lds
    v_cvt_pk_bf16_f32 v162, v28, v29
    v_mfma_f32_16x16x32_bf16 v[24:27], a[96:99], a[64:67], v[44:47]
    v_exp_f32 v31, v31
    v_mfma_f32_16x16x32_bf16 v[24:27], a[100:103], a[68:71], v[24:27]
    ds_read_b128 a[152:155], v2 offset:27648
    v_cvt_pk_bf16_f32 v163, v30, v31
    v_mfma_f32_16x16x32_bf16 v[24:27], a[104:107], a[72:75], v[24:27]
    ds_read_b128 a[156:159], v3 offset:27648
    v_add_f32 v14, v14, v31
    v_mfma_f32_16x16x32_bf16 v[24:27], a[108:111], a[76:79], v[24:27]
    v_exp_f32 v32, v32
    v_mfma_f32_16x16x32_bf16 v[24:27], a[112:115], a[80:83], v[24:27]
    v_exp_f32 v33, v33
    v_mfma_f32_16x16x32_bf16 v[24:27], a[116:119], a[84:87], v[24:27]
    s_add_u32 m0, s23, 82816
    v_add_f32 v15, v15, v32
    v_add_u32 v2, 0xfffe0000, v2
    v_mfma_f32_16x16x32_bf16 v[24:27], a[120:123], a[88:91], v[24:27]
    s_waitcnt lgkmcnt(2)
    v_exp_f32 v34, v34
    v_mfma_f32_16x16x32_bf16 v[24:27], a[124:127], a[92:95], v[24:27]
    buffer_load_dwordx4 v1, s[8:11], s26 offen offset:128 nt lds
    v_add_f32 v15, v15, v33
    v_mfma_f32_16x16x32_bf16 v[28:31], a[128:131], a[0:3], v[54:57]
    v_exp_f32 v35, v35
    v_mfma_f32_16x16x32_bf16 v[28:31], a[132:135], a[4:7], v[28:31]
    v_add_f32 v15, v15, v34
    v_add_u32 v3, 0xfffe0000, v3
    v_mfma_f32_16x16x32_bf16 v[28:31], a[136:139], a[8:11], v[28:31]
    v_cvt_pk_bf16_f32 v166, v32, v33
    v_cvt_pk_bf16_f32 v167, v34, v35
    v_mfma_f32_16x16x32_bf16 v[28:31], a[140:143], a[12:15], v[28:31]
    v_exp_f32 v36, v36
    v_mfma_f32_16x16x32_bf16 v[28:31], a[144:147], a[16:19], v[28:31]
    s_add_u32 m0, s23, 83712
    ds_read_b128 a[96:99], v2 offset:0
    v_add_f32 v15, v15, v35
    v_mfma_f32_16x16x32_bf16 v[28:31], a[148:151], a[20:23], v[28:31]
    s_waitcnt lgkmcnt(1)
    v_exp_f32 v37, v37
    v_mfma_f32_16x16x32_bf16 v[28:31], a[152:155], a[24:27], v[28:31]
    buffer_load_dwordx4 v1, s[8:11], s26 offen offset:256 nt lds
    ds_read_b128 a[100:103], v3 offset:0
    v_mfma_f32_16x16x32_bf16 v[28:31], a[156:159], a[28:31], v[28:31]
    v_add_f32 v48, v48, v36
    v_cvt_pk_bf16_f32 v170, v36, v37
    v_mfma_f32_16x16x32_bf16 v[32:35], a[128:131], a[32:35], v[58:61]
    ds_read_b128 a[104:107], v2 offset:1024
    v_add_f32 v48, v48, v37
    v_mfma_f32_16x16x32_bf16 v[32:35], a[132:135], a[36:39], v[32:35]
    v_exp_f32 v38, v38
    v_mfma_f32_16x16x32_bf16 v[32:35], a[136:139], a[40:43], v[32:35]
    ds_read_b128 a[108:111], v3 offset:1024
    v_add_f32 v48, v48, v38
    v_mfma_f32_16x16x32_bf16 v[32:35], a[140:143], a[44:47], v[32:35]
    v_exp_f32 v39, v39
    v_mfma_f32_16x16x32_bf16 v[32:35], a[144:147], a[48:51], v[32:35]
    ds_read_b128 a[112:115], v2 offset:2048
    v_cvt_pk_bf16_f32 v171, v38, v39
    v_mfma_f32_16x16x32_bf16 v[32:35], a[148:151], a[52:55], v[32:35]
    s_add_u32 m0, s23, 84608
    v_exp_f32 v16, v16
    v_mfma_f32_16x16x32_bf16 v[32:35], a[152:155], a[56:59], v[32:35]
    buffer_load_dwordx4 v1, s[8:11], s26 offen offset:384 nt lds
    v_add_f32 v48, v48, v39
    v_mfma_f32_16x16x32_bf16 v[32:35], a[156:159], a[60:63], v[32:35]
    v_exp_f32 v17, v17
    v_mfma_f32_16x16x32_bf16 v[36:39], a[128:131], a[64:67], v[44:47]
    ds_read_b128 a[116:119], v3 offset:2048
    ds_read_b128 a[120:123], v2 offset:3072
    v_mfma_f32_16x16x32_bf16 v[36:39], a[132:135], a[68:71], v[36:39]
    v_exp_f32 v18, v18
    v_mfma_f32_16x16x32_bf16 v[36:39], a[136:139], a[72:75], v[36:39]
    ds_read_b128 a[124:127], v3 offset:3072
    v_cvt_pk_bf16_f32 v172, v16, v17
    v_mfma_f32_16x16x32_bf16 v[36:39], a[140:143], a[76:79], v[36:39]
    v_exp_f32 v19, v19
    v_mfma_f32_16x16x32_bf16 v[36:39], a[144:147], a[80:83], v[36:39]
    s_add_u32 s27, s24, 0
    v_exp_f32 v20, v20
    v_mfma_f32_16x16x32_bf16 v[36:39], a[148:151], a[84:87], v[36:39]
    s_add_u32 m0, s23, 98304
    v_exp_f32 v21, v21
    v_mfma_f32_16x16x32_bf16 v[36:39], a[152:155], a[88:91], v[36:39]
    buffer_load_dwordx4 v1, s[12:15], s27 offen offset:0 nt lds
    v_cvt_pk_bf16_f32 v173, v18, v19
    v_mfma_f32_16x16x32_bf16 v[36:39], a[156:159], a[92:95], v[36:39]
    s_waitcnt lgkmcnt(3)
    v_exp_f32 v22, v22
    v_mfma_f32_16x16x32_bf16 v[16:19], a[96:99], a[0:3], v[54:57]
    v_exp_f32 v23, v23
    v_mfma_f32_16x16x32_bf16 v[16:19], a[100:103], a[4:7], v[16:19]
    v_cvt_pk_bf16_f32 v176, v20, v21
    v_cvt_pk_bf16_f32 v177, v22, v23
    v_mfma_f32_16x16x32_bf16 v[16:19], a[104:107], a[8:11], v[16:19]
    s_add_u32 s28, s24, 4096
    v_exp_f32 v24, v24
    v_mfma_f32_16x16x32_bf16 v[16:19], a[108:111], a[12:15], v[16:19]
    s_add_u32 m0, s23, 99328
    v_exp_f32 v25, v25
    v_mfma_f32_16x16x32_bf16 v[16:19], a[112:115], a[16:19], v[16:19]
    s_waitcnt lgkmcnt(0)
    ds_read_b128 a[128:131], v2 offset:8192
    v_cvt_pk_bf16_f32 v180, v24, v25
    v_mfma_f32_16x16x32_bf16 v[16:19], a[116:119], a[20:23], v[16:19]
    buffer_load_dwordx4 v1, s[12:15], s28 offen offset:0 nt lds
    v_mfma_f32_16x16x32_bf16 v[16:19], a[120:123], a[24:27], v[16:19]
    v_exp_f32 v26, v26
    v_mfma_f32_16x16x32_bf16 v[16:19], a[124:127], a[28:31], v[16:19]
    v_exp_f32 v27, v27
    v_mfma_f32_16x16x32_bf16 v[20:23], a[96:99], a[32:35], v[58:61]
    ds_read_b128 a[132:135], v3 offset:8192
    ds_read_b128 a[136:139], v2 offset:9216
    v_mfma_f32_16x16x32_bf16 v[20:23], a[100:103], a[36:39], v[20:23]
    v_exp_f32 v28, v28
    v_mfma_f32_16x16x32_bf16 v[20:23], a[104:107], a[40:43], v[20:23]
    ds_read_b128 a[140:143], v3 offset:9216
    v_cvt_pk_bf16_f32 v181, v26, v27
    v_mfma_f32_16x16x32_bf16 v[20:23], a[108:111], a[44:47], v[20:23]
    s_add_u32 s27, s24, 8192
    v_exp_f32 v29, v29
    v_mfma_f32_16x16x32_bf16 v[20:23], a[112:115], a[48:51], v[20:23]
    s_add_u32 m0, s23, 100352
    ds_read_b128 a[144:147], v2 offset:10240
    v_cvt_pk_bf16_f32 v174, v28, v29
    v_mfma_f32_16x16x32_bf16 v[20:23], a[116:119], a[52:55], v[20:23]
    buffer_load_dwordx4 v1, s[12:15], s27 offen offset:0 nt lds
    v_mfma_f32_16x16x32_bf16 v[20:23], a[120:123], a[56:59], v[20:23]
    v_exp_f32 v30, v30
    v_mfma_f32_16x16x32_bf16 v[20:23], a[124:127], a[60:63], v[20:23]
    v_exp_f32 v31, v31
    v_mfma_f32_16x16x32_bf16 v[24:27], a[96:99], a[64:67], v[44:47]
    ds_read_b128 a[148:151], v3 offset:10240
    ds_read_b128 a[152:155], v2 offset:11264
    v_mfma_f32_16x16x32_bf16 v[24:27], a[100:103], a[68:71], v[24:27]
    v_exp_f32 v32, v32
    v_mfma_f32_16x16x32_bf16 v[24:27], a[104:107], a[72:75], v[24:27]
    ds_read_b128 a[156:159], v3 offset:11264
    v_cvt_pk_bf16_f32 v175, v30, v31
    v_mfma_f32_16x16x32_bf16 v[24:27], a[108:111], a[76:79], v[24:27]
    s_add_u32 s28, s24, 12288
    v_exp_f32 v33, v33
    v_mfma_f32_16x16x32_bf16 v[24:27], a[112:115], a[80:83], v[24:27]
    s_add_u32 m0, s23, 101376
    v_exp_f32 v34, v34
    v_mfma_f32_16x16x32_bf16 v[24:27], a[116:119], a[84:87], v[24:27]
    buffer_load_dwordx4 v1, s[12:15], s28 offen offset:0 nt lds
    v_cvt_pk_bf16_f32 v178, v32, v33
    v_mfma_f32_16x16x32_bf16 v[24:27], a[120:123], a[88:91], v[24:27]
    v_exp_f32 v35, v35
    v_mfma_f32_16x16x32_bf16 v[24:27], a[124:127], a[92:95], v[24:27]
    s_waitcnt lgkmcnt(3)
    v_exp_f32 v36, v36
    v_mfma_f32_16x16x32_bf16 v[28:31], a[128:131], a[0:3], v[54:57]
    s_add_u32 s27, s24, 65536
    v_exp_f32 v37, v37
    v_mfma_f32_16x16x32_bf16 v[28:31], a[132:135], a[4:7], v[28:31]
    s_add_u32 m0, s23, 114688
    v_cvt_pk_bf16_f32 v179, v34, v35
    v_cvt_pk_bf16_f32 v182, v36, v37
    v_mfma_f32_16x16x32_bf16 v[28:31], a[136:139], a[8:11], v[28:31]
    s_waitcnt vmcnt(16)
    v_exp_f32 v38, v38
    v_mfma_f32_16x16x32_bf16 v[28:31], a[140:143], a[12:15], v[28:31]
    s_barrier
    v_exp_f32 v39, v39
    v_mfma_f32_16x16x32_bf16 v[28:31], a[144:147], a[16:19], v[28:31]
    s_waitcnt lgkmcnt(0)
    ds_read_b128 a[96:99], v2 offset:16384
    v_cvt_pk_bf16_f32 v183, v38, v39
    v_mfma_f32_16x16x32_bf16 v[28:31], a[148:151], a[20:23], v[28:31]
    buffer_load_dwordx4 v1, s[12:15], s27 offen offset:0 nt lds
    v_mfma_f32_16x16x32_bf16 v[28:31], a[152:155], a[24:27], v[28:31]
    v_exp_f32 v16, v16
    v_mfma_f32_16x16x32_bf16 v[28:31], a[156:159], a[28:31], v[28:31]
    ds_read_b128 a[100:103], v3 offset:16384
    v_add_f32 v14, v14, v16
    v_mfma_f32_16x16x32_bf16 a[164:167], a[160:163], v[172:175], a[164:167]
    v_exp_f32 v17, v17
    v_mfma_f32_16x16x32_bf16 v[32:35], a[128:131], a[32:35], v[58:61]
    ds_read_b128 a[104:107], v2 offset:17408
    v_add_f32 v14, v14, v17
    v_mfma_f32_16x16x32_bf16 v[32:35], a[132:135], a[36:39], v[32:35]
    ds_read_b128 a[108:111], v3 offset:17408
    v_cvt_pk_bf16_f32 v184, v16, v17
    v_mfma_f32_16x16x32_bf16 v[32:35], a[136:139], a[40:43], v[32:35]
    v_exp_f32 v18, v18
    v_mfma_f32_16x16x32_bf16 v[32:35], a[140:143], a[44:47], v[32:35]
    s_add_u32 s28, s24, 69632
    ds_read_b128 a[112:115], v2 offset:18432
    v_add_f32 v14, v14, v18
    v_mfma_f32_16x16x32_bf16 v[32:35], a[144:147], a[48:51], v[32:35]
    s_add_u32 m0, s23, 115712
    v_exp_f32 v19, v19
    v_mfma_f32_16x16x32_bf16 v[32:35], a[148:151], a[52:55], v[32:35]
    buffer_load_dwordx4 v1, s[12:15], s28 offen offset:0 nt lds
    ds_read_b128 a[116:119], v3 offset:18432
    v_mfma_f32_16x16x32_bf16 v[32:35], a[152:155], a[56:59], v[32:35]
    v_cvt_pk_bf16_f32 v185, v18, v19
    v_add_f32 v14, v14, v19
    v_mfma_f32_16x16x32_bf16 v[32:35], a[156:159], a[60:63], v[32:35]
    v_exp_f32 v20, v20
    v_mfma_f32_16x16x32_bf16 a[168:171], a[160:163], v[176:179], a[168:171]
    ds_read_b128 a[120:123], v2 offset:19456
    v_add_f32 v15, v15, v20
    v_mfma_f32_16x16x32_bf16 v[36:39], a[128:131], a[64:67], v[44:47]
    v_exp_f32 v21, v21
    v_mfma_f32_16x16x32_bf16 v[36:39], a[132:135], a[68:71], v[36:39]
    ds_read_b128 a[124:127], v3 offset:19456
    v_add_f32 v15, v15, v21
    v_mfma_f32_16x16x32_bf16 v[36:39], a[136:139], a[72:75], v[36:39]
    s_add_u32 s27, s24, 73728
    v_exp_f32 v22, v22
    v_mfma_f32_16x16x32_bf16 v[36:39], a[140:143], a[76:79], v[36:39]
    s_add_u32 m0, s23, 116736
    v_exp_f32 v23, v23
    v_mfma_f32_16x16x32_bf16 v[36:39], a[144:147], a[80:83], v[36:39]
    buffer_load_dwordx4 v1, s[12:15], s27 offen offset:0 nt lds
    v_add_f32 v15, v15, v22
    v_mfma_f32_16x16x32_bf16 v[36:39], a[148:151], a[84:87], v[36:39]
    v_cvt_pk_bf16_f32 v188, v20, v21
    v_cvt_pk_bf16_f32 v189, v22, v23
    v_mfma_f32_16x16x32_bf16 v[36:39], a[152:155], a[88:91], v[36:39]
    v_exp_f32 v24, v24
    v_mfma_f32_16x16x32_bf16 v[36:39], a[156:159], a[92:95], v[36:39]
    v_add_f32 v15, v15, v23
    v_add_f32 v48, v48, v24
    v_mfma_f32_16x16x32_bf16 a[172:175], a[160:163], v[180:183], a[172:175]
    s_waitcnt lgkmcnt(1)
    v_exp_f32 v25, v25
    v_mfma_f32_16x16x32_bf16 v[16:19], a[96:99], a[0:3], v[54:57]
    v_exp_f32 v26, v26
    v_mfma_f32_16x16x32_bf16 v[16:19], a[100:103], a[4:7], v[16:19]
    s_add_u32 s28, s24, 77824
    v_add_f32 v48, v48, v25
    v_cvt_pk_bf16_f32 v192, v24, v25
    v_mfma_f32_16x16x32_bf16 v[16:19], a[104:107], a[8:11], v[16:19]
    s_add_u32 m0, s23, 117760
    v_exp_f32 v27, v27
    v_mfma_f32_16x16x32_bf16 v[16:19], a[108:111], a[12:15], v[16:19]
    buffer_load_dwordx4 v1, s[12:15], s28 offen offset:0 nt lds
    v_add_f32 v48, v48, v26
    v_mfma_f32_16x16x32_bf16 v[16:19], a[112:115], a[16:19], v[16:19]
    ds_read_b128 a[128:131], v2 offset:24576
    v_cvt_pk_bf16_f32 v193, v26, v27
    v_mfma_f32_16x16x32_bf16 v[16:19], a[116:119], a[20:23], v[16:19]
    v_exp_f32 v28, v28
    v_mfma_f32_16x16x32_bf16 v[16:19], a[120:123], a[24:27], v[16:19]
    s_waitcnt lgkmcnt(1)
    ds_read_b128 a[132:135], v3 offset:24576
    v_add_f32 v48, v48, v27
    v_mfma_f32_16x16x32_bf16 v[16:19], a[124:127], a[28:31], v[16:19]
    v_exp_f32 v29, v29
    v_mfma_f32_16x16x32_bf16 v[20:23], a[96:99], a[32:35], v[58:61]
    ds_read_b128 a[136:139], v2 offset:25600
    v_add_f32 v14, v14, v28
    v_mfma_f32_16x16x32_bf16 v[20:23], a[100:103], a[36:39], v[20:23]
    s_add_u32 s27, s24, 131072
    v_exp_f32 v30, v30
    v_mfma_f32_16x16x32_bf16 v[20:23], a[104:107], a[40:43], v[20:23]
    s_add_u32 m0, s23, 131072
    ds_read_b128 a[140:143], v3 offset:25600
    v_add_f32 v14, v14, v29
    v_mfma_f32_16x16x32_bf16 v[20:23], a[108:111], a[44:47], v[20:23]
    buffer_load_dwordx4 v1, s[12:15], s27 offen offset:0 nt lds
    v_add_f32 v14, v14, v30
    v_mfma_f32_16x16x32_bf16 v[20:23], a[112:115], a[48:51], v[20:23]
    ds_read_b128 a[144:147], v2 offset:26624
    v_cvt_pk_bf16_f32 v186, v28, v29
    v_mfma_f32_16x16x32_bf16 v[20:23], a[116:119], a[52:55], v[20:23]
    v_exp_f32 v31, v31
    v_mfma_f32_16x16x32_bf16 v[20:23], a[120:123], a[56:59], v[20:23]
    ds_read_b128 a[148:151], v3 offset:26624
    v_cvt_pk_bf16_f32 v187, v30, v31
    v_mfma_f32_16x16x32_bf16 v[20:23], a[124:127], a[60:63], v[20:23]
    v_exp_f32 v32, v32
    v_mfma_f32_16x16x32_bf16 v[24:27], a[96:99], a[64:67], v[44:47]
    ds_read_b128 a[152:155], v2 offset:27648
    v_add_f32 v14, v14, v31
    v_mfma_f32_16x16x32_bf16 v[24:27], a[100:103], a[68:71], v[24:27]
    s_add_u32 s28, s24, 135168
    v_exp_f32 v33, v33
    v_mfma_f32_16x16x32_bf16 v[24:27], a[104:107], a[72:75], v[24:27]
    s_add_u32 m0, s23, 132096
    ds_read_b128 a[156:159], v3 offset:27648
    v_add_f32 v15, v15, v32
    v_mfma_f32_16x16x32_bf16 v[24:27], a[108:111], a[76:79], v[24:27]
    buffer_load_dwordx4 v1, s[12:15], s28 offen offset:0 nt lds
    v_add_f32 v15, v15, v33
    v_mfma_f32_16x16x32_bf16 v[24:27], a[112:115], a[80:83], v[24:27]
    v_exp_f32 v34, v34
    v_mfma_f32_16x16x32_bf16 v[24:27], a[116:119], a[84:87], v[24:27]
    v_exp_f32 v35, v35
    v_mfma_f32_16x16x32_bf16 v[24:27], a[120:123], a[88:91], v[24:27]
    v_add_f32 v15, v15, v34
    v_cvt_pk_bf16_f32 v190, v32, v33
    v_mfma_f32_16x16x32_bf16 v[24:27], a[124:127], a[92:95], v[24:27]
    s_waitcnt lgkmcnt(2)
    v_cvt_pk_bf16_f32 v191, v34, v35
    v_add_f32 v15, v15, v35
    v_mfma_f32_16x16x32_bf16 v[28:31], a[128:131], a[0:3], v[54:57]
    s_add_u32 s27, s24, 139264
    v_exp_f32 v36, v36
    v_mfma_f32_16x16x32_bf16 v[28:31], a[132:135], a[4:7], v[28:31]
    s_add_u32 m0, s23, 133120
    v_exp_f32 v37, v37
    v_add_f32 v48, v48, v36
    v_mfma_f32_16x16x32_bf16 v[28:31], a[136:139], a[8:11], v[28:31]
    buffer_load_dwordx4 v1, s[12:15], s27 offen offset:0 nt lds
    v_add_f32 v48, v48, v37
    v_mfma_f32_16x16x32_bf16 v[28:31], a[140:143], a[12:15], v[28:31]
    v_exp_f32 v38, v38
    v_mfma_f32_16x16x32_bf16 v[28:31], a[144:147], a[16:19], v[28:31]
    ds_read_b128 a[96:99], v2 offset:32768
    v_add_f32 v48, v48, v38
    v_mfma_f32_16x16x32_bf16 v[28:31], a[148:151], a[20:23], v[28:31]
    s_waitcnt lgkmcnt(1)
    v_exp_f32 v39, v39
    v_mfma_f32_16x16x32_bf16 v[28:31], a[152:155], a[24:27], v[28:31]
    ds_read_b128 a[100:103], v3 offset:32768
    v_cvt_pk_bf16_f32 v194, v36, v37
    v_mfma_f32_16x16x32_bf16 v[28:31], a[156:159], a[28:31], v[28:31]
    v_cvt_pk_bf16_f32 v195, v38, v39
    v_add_f32 v48, v48, v39
    v_mfma_f32_16x16x32_bf16 v[32:35], a[128:131], a[32:35], v[58:61]
    s_add_u32 s28, s24, 143360
    v_exp_f32 v16, v16
    v_mfma_f32_16x16x32_bf16 v[32:35], a[132:135], a[36:39], v[32:35]
    s_add_u32 m0, s23, 134144
    ds_read_b128 a[104:107], v2 offset:33792
    v_add_f32 v14, v14, v16
    v_mfma_f32_16x16x32_bf16 v[32:35], a[136:139], a[40:43], v[32:35]
    buffer_load_dwordx4 v1, s[12:15], s28 offen offset:0 nt lds
    ds_read_b128 a[108:111], v3 offset:33792
    v_mfma_f32_16x16x32_bf16 v[32:35], a[140:143], a[44:47], v[32:35]
    v_exp_f32 v17, v17
    v_mfma_f32_16x16x32_bf16 v[32:35], a[144:147], a[48:51], v[32:35]
    ds_read_b128 a[112:115], v2 offset:34816
    v_add_f32 v14, v14, v17
    v_mfma_f32_16x16x32_bf16 v[32:35], a[148:151], a[52:55], v[32:35]
    v_exp_f32 v18, v18
    v_mfma_f32_16x16x32_bf16 v[32:35], a[152:155], a[56:59], v[32:35]
    ds_read_b128 a[116:119], v3 offset:34816
    v_add_f32 v14, v14, v18
    v_mfma_f32_16x16x32_bf16 v[32:35], a[156:159], a[60:63], v[32:35]
    v_exp_f32 v19, v19
    v_mfma_f32_16x16x32_bf16 v[36:39], a[128:131], a[64:67], v[44:47]
    s_add_u32 s27, s24, 196608
    ds_read_b128 a[120:123], v2 offset:35840
    v_cvt_pk_bf16_f32 v196, v16, v17
    v_mfma_f32_16x16x32_bf16 v[36:39], a[132:135], a[68:71], v[36:39]
    s_add_u32 m0, s23, 147456
    v_cvt_pk_bf16_f32 v197, v18, v19
    v_add_f32 v14, v14, v19
    v_mfma_f32_16x16x32_bf16 v[36:39], a[136:139], a[72:75], v[36:39]
    buffer_load_dwordx4 v1, s[12:15], s27 offen offset:0 nt lds
    ds_read_b128 a[124:127], v3 offset:35840
    v_mfma_f32_16x16x32_bf16 v[36:39], a[140:143], a[76:79], v[36:39]
    v_exp_f32 v20, v20
    v_mfma_f32_16x16x32_bf16 v[36:39], a[144:147], a[80:83], v[36:39]
    v_exp_f32 v21, v21
    v_add_f32 v15, v15, v20
    v_mfma_f32_16x16x32_bf16 v[36:39], a[148:151], a[84:87], v[36:39]
    v_exp_f32 v22, v22
    v_mfma_f32_16x16x32_bf16 v[36:39], a[152:155], a[88:91], v[36:39]
    s_add_u32 s28, s24, 200704
    v_add_f32 v15, v15, v21
    v_cvt_pk_bf16_f32 v200, v20, v21
    v_mfma_f32_16x16x32_bf16 v[36:39], a[156:159], a[92:95], v[36:39]
    s_waitcnt lgkmcnt(2)
    v_exp_f32 v23, v23
    v_mfma_f32_16x16x32_bf16 v[16:19], a[96:99], a[0:3], v[54:57]
    s_add_u32 m0, s23, 148480
    v_add_f32 v15, v15, v22
    v_cvt_pk_bf16_f32 v201, v22, v23
    v_mfma_f32_16x16x32_bf16 v[16:19], a[100:103], a[4:7], v[16:19]
    buffer_load_dwordx4 v1, s[12:15], s28 offen offset:0 nt lds
    v_add_f32 v15, v15, v23
    v_mfma_f32_16x16x32_bf16 v[16:19], a[104:107], a[8:11], v[16:19]
    v_exp_f32 v24, v24
    v_mfma_f32_16x16x32_bf16 v[16:19], a[108:111], a[12:15], v[16:19]
    v_exp_f32 v25, v25
    v_mfma_f32_16x16x32_bf16 v[16:19], a[112:115], a[16:19], v[16:19]
    ds_read_b128 a[128:131], v2 offset:40960
    v_add_f32 v48, v48, v24
    v_mfma_f32_16x16x32_bf16 v[16:19], a[116:119], a[20:23], v[16:19]
    s_waitcnt lgkmcnt(1)
    v_exp_f32 v26, v26
    v_mfma_f32_16x16x32_bf16 v[16:19], a[120:123], a[24:27], v[16:19]
    ds_read_b128 a[132:135], v3 offset:40960
    v_add_f32 v48, v48, v25
    v_mfma_f32_16x16x32_bf16 v[16:19], a[124:127], a[28:31], v[16:19]
    s_add_u32 s27, s24, 204800
    v_exp_f32 v27, v27
    v_mfma_f32_16x16x32_bf16 v[20:23], a[96:99], a[32:35], v[58:61]
    s_add_u32 m0, s23, 149504
    ds_read_b128 a[136:139], v2 offset:41984
    v_add_f32 v48, v48, v26
    v_mfma_f32_16x16x32_bf16 v[20:23], a[100:103], a[36:39], v[20:23]
    buffer_load_dwordx4 v1, s[12:15], s27 offen offset:0 nt lds
    v_cvt_pk_bf16_f32 v204, v24, v25
    v_mfma_f32_16x16x32_bf16 v[20:23], a[104:107], a[40:43], v[20:23]
    ds_read_b128 a[140:143], v3 offset:41984
    v_cvt_pk_bf16_f32 v205, v26, v27
    v_mfma_f32_16x16x32_bf16 v[20:23], a[108:111], a[44:47], v[20:23]
    v_exp_f32 v28, v28
    v_mfma_f32_16x16x32_bf16 v[20:23], a[112:115], a[48:51], v[20:23]
    ds_read_b128 a[144:147], v2 offset:43008
    v_add_f32 v48, v48, v27
    v_mfma_f32_16x16x32_bf16 v[20:23], a[116:119], a[52:55], v[20:23]
    v_exp_f32 v29, v29
    v_mfma_f32_16x16x32_bf16 v[20:23], a[120:123], a[56:59], v[20:23]
    ds_read_b128 a[148:151], v3 offset:43008
    v_add_f32 v14, v14, v28
    v_mfma_f32_16x16x32_bf16 v[20:23], a[124:127], a[60:63], v[20:23]
    s_add_u32 s28, s24, 208896
    v_exp_f32 v30, v30
    v_mfma_f32_16x16x32_bf16 v[24:27], a[96:99], a[64:67], v[44:47]
    s_add_u32 m0, s23, 150528
    ds_read_b128 a[152:155], v2 offset:44032
    v_add_f32 v14, v14, v29
    v_mfma_f32_16x16x32_bf16 v[24:27], a[100:103], a[68:71], v[24:27]
    buffer_load_dwordx4 v1, s[12:15], s28 offen offset:0 nt lds
    v_add_f32 v14, v14, v30
    v_mfma_f32_16x16x32_bf16 v[24:27], a[104:107], a[72:75], v[24:27]
    ds_read_b128 a[156:159], v3 offset:44032
    v_cvt_pk_bf16_f32 v198, v28, v29
    v_mfma_f32_16x16x32_bf16 v[24:27], a[108:111], a[76:79], v[24:27]
    v_exp_f32 v31, v31
    v_mfma_f32_16x16x32_bf16 v[24:27], a[112:115], a[80:83], v[24:27]
    v_cvt_pk_bf16_f32 v199, v30, v31
    v_add_f32 v14, v14, v31
    v_mfma_f32_16x16x32_bf16 v[24:27], a[116:119], a[84:87], v[24:27]
    v_exp_f32 v32, v32
    v_mfma_f32_16x16x32_bf16 v[24:27], a[120:123], a[88:91], v[24:27]
    v_exp_f32 v33, v33
    v_mfma_f32_16x16x32_bf16 v[24:27], a[124:127], a[92:95], v[24:27]
    s_waitcnt lgkmcnt(2)
    v_add_f32 v15, v15, v32
    v_cvt_pk_bf16_f32 v202, v32, v33
    v_mfma_f32_16x16x32_bf16 v[28:31], a[128:131], a[0:3], v[54:57]
    v_exp_f32 v34, v34
    v_mfma_f32_16x16x32_bf16 v[28:31], a[132:135], a[4:7], v[28:31]
    s_add_u32 s27, s24, 128
    v_exp_f32 v35, v35
    v_mfma_f32_16x16x32_bf16 v[28:31], a[136:139], a[8:11], v[28:31]
    s_waitcnt vmcnt(20)
    v_add_f32 v15, v15, v33
    v_cvt_pk_bf16_f32 v203, v34, v35
    v_mfma_f32_16x16x32_bf16 v[28:31], a[140:143], a[12:15], v[28:31]
    s_barrier
    v_exp_f32 v36, v36
    v_mfma_f32_16x16x32_bf16 v[28:31], a[144:147], a[16:19], v[28:31]
    s_add_u32 m0, s23, 0
    ds_read_b128 a[96:99], v2 offset:49152
    v_add_f32 v15, v15, v34
    v_mfma_f32_16x16x32_bf16 v[28:31], a[148:151], a[20:23], v[28:31]
    s_waitcnt lgkmcnt(1)
    v_add_f32 v15, v15, v35
    v_add_f32 v48, v48, v36
    v_mfma_f32_16x16x32_bf16 v[28:31], a[152:155], a[24:27], v[28:31]
    buffer_load_dwordx4 v1, s[12:15], s27 offen offset:0 nt lds
    ds_read_b128 a[100:103], v3 offset:49152
    v_mfma_f32_16x16x32_bf16 v[28:31], a[156:159], a[28:31], v[28:31]
    v_exp_f32 v37, v37
    v_mfma_f32_16x16x32_bf16 v[32:35], a[128:131], a[32:35], v[58:61]
    ds_read_b128 a[104:107], v2 offset:50176
    v_add_f32 v48, v48, v37
    v_mfma_f32_16x16x32_bf16 v[32:35], a[132:135], a[36:39], v[32:35]
    v_exp_f32 v38, v38
    v_mfma_f32_16x16x32_bf16 v[32:35], a[136:139], a[40:43], v[32:35]
    ds_read_b128 a[108:111], v3 offset:50176
    v_add_f32 v48, v48, v38
    v_mfma_f32_16x16x32_bf16 v[32:35], a[140:143], a[44:47], v[32:35]
L_pg3:
    s_cbranch_execz L_pg7
    v_exp_f32 v39, v39
    v_mfma_f32_16x16x32_bf16 v[32:35], a[144:147], a[48:51], v[32:35]
    s_add_u32 s28, s24, 4224
    ds_read_b128 a[112:115], v2 offset:51200
    v_cvt_pk_bf16_f32 v206, v36, v37
    v_mfma_f32_16x16x32_bf16 v[32:35], a[148:151], a[52:55], v[32:35]
    s_add_u32 m0, s23, 1024
    v_cvt_pk_bf16_f32 v207, v38, v39
    v_add_f32 v48, v48, v39
    v_mfma_f32_16x16x32_bf16 v[32:35], a[152:155], a[56:59], v[32:35]
    buffer_load_dwordx4 v1, s[12:15], s28 offen offset:0 nt lds
    ds_read_b128 a[116:119], v3 offset:51200
    v_mfma_f32_16x16x32_bf16 v[32:35], a[156:159], a[60:63], v[32:35]
    v_exp_f32 v16, v16
    v_mfma_f32_16x16x32_bf16 v[36:39], a[128:131], a[64:67], v[44:47]
    v_exp_f32 v17, v17
    v_mfma_f32_16x16x32_bf16 v[36:39], a[132:135], a[68:71], v[36:39]
    ds_read_b128 a[120:123], v2 offset:52224
    v_cvt_pk_bf16_f32 v208, v16, v17
    v_mfma_f32_16x16x32_bf16 v[36:39], a[136:139], a[72:75], v[36:39]
    v_exp_f32 v18, v18
    v_mfma_f32_16x16x32_bf16 v[36:39], a[140:143], a[76:79], v[36:39]
    v_exp_f32 v19, v19
    v_mfma_f32_16x16x32_bf16 v[36:39], a[144:147], a[80:83], v[36:39]
    s_add_u32 s27, s24, 8320
    ds_read_b128 a[124:127], v3 offset:52224
    v_cvt_pk_bf16_f32 v209, v18, v19
    v_mfma_f32_16x16x32_bf16 v[36:39], a[148:151], a[84:87], v[36:39]
    s_add_u32 m0, s23, 2048
    v_exp_f32 v20, v20
    v_mfma_f32_16x16x32_bf16 v[36:39], a[152:155], a[88:91], v[36:39]
    buffer_load_dwordx4 v1, s[12:15], s27 offen offset:0 nt lds
    v_mfma_f32_16x16x32_bf16 v[36:39], a[156:159], a[92:95], v[36:39]
    s_waitcnt lgkmcnt(2)
    v_exp_f32 v21, v21
    v_mfma_f32_16x16x32_bf16 v[16:19], a[96:99], a[0:3], v[54:57]
    v_exp_f32 v22, v22
    v_mfma_f32_16x16x32_bf16 v[16:19], a[100:103], a[4:7], v[16:19]
    v_exp_f32 v23, v23
    v_mfma_f32_16x16x32_bf16 v[16:19], a[104:107], a[8:11], v[16:19]
    v_cvt_pk_bf16_f32 v212, v20, v21
    v_cvt_pk_bf16_f32 v213, v22, v23
    v_mfma_f32_16x16x32_bf16 v[16:19], a[108:111], a[12:15], v[16:19]
    s_add_u32 s28, s24, 12416
    v_exp_f32 v24, v24
    v_mfma_f32_16x16x32_bf16 v[16:19], a[112:115], a[16:19], v[16:19]
    s_add_u32 m0, s23, 3072
    v_exp_f32 v25, v25
    v_mfma_f32_16x16x32_bf16 v[16:19], a[116:119], a[20:23], v[16:19]
    s_waitcnt lgkmcnt(0)
    ds_read_b128 a[128:131], v2 offset:57344
    v_cvt_pk_bf16_f32 v216, v24, v25
    v_mfma_f32_16x16x32_bf16 v[16:19], a[120:123], a[24:27], v[16:19]
    buffer_load_dwordx4 v1, s[12:15], s28 offen offset:0 nt lds
    ds_read_b128 a[132:135], v3 offset:57344
    v_mfma_f32_16x16x32_bf16 v[16:19], a[124:127], a[28:31], v[16:19]
    v_exp_f32 v26, v26
    v_mfma_f32_16x16x32_bf16 v[20:23], a[96:99], a[32:35], v[58:61]
    s_add_u32 s27, s24, 65664
    v_exp_f32 v27, v27
    v_mfma_f32_16x16x32_bf16 v[20:23], a[100:103], a[36:39], v[20:23]
    s_add_u32 m0, s23, 16384
    ds_read_b128 a[136:139], v2 offset:58368
    v_cvt_pk_bf16_f32 v217, v26, v27
    v_mfma_f32_16x16x32_bf16 v[20:23], a[104:107], a[40:43], v[20:23]
    buffer_load_dwordx4 v1, s[12:15], s27 offen offset:0 nt lds
    ds_read_b128 a[140:143], v3 offset:58368
    v_mfma_f32_16x16x32_bf16 v[20:23], a[108:111], a[44:47], v[20:23]
    v_exp_f32 v28, v28
    v_mfma_f32_16x16x32_bf16 v[20:23], a[112:115], a[48:51], v[20:23]
    v_exp_f32 v29, v29
    v_mfma_f32_16x16x32_bf16 v[20:23], a[116:119], a[52:55], v[20:23]
    s_add_u32 s28, s24, 69760
    ds_read_b128 a[144:147], v2 offset:59392
    v_cvt_pk_bf16_f32 v210, v28, v29
    v_mfma_f32_16x16x32_bf16 v[20:23], a[120:123], a[56:59], v[20:23]
    s_add_u32 m0, s23, 17408
    v_exp_f32 v30, v30
    v_mfma_f32_16x16x32_bf16 v[20:23], a[124:127], a[60:63], v[20:23]
    buffer_load_dwordx4 v1, s[12:15], s28 offen offset:0 nt lds
    ds_read_b128 a[148:151], v3 offset:59392
    v_mfma_f32_16x16x32_bf16 v[24:27], a[96:99], a[64:67], v[44:47]
    v_exp_f32 v31, v31
    v_mfma_f32_16x16x32_bf16 v[24:27], a[100:103], a[68:71], v[24:27]
    ds_read_b128 a[152:155], v2 offset:60416
    v_cvt_pk_bf16_f32 v211, v30, v31
    v_mfma_f32_16x16x32_bf16 v[24:27], a[104:107], a[72:75], v[24:27]
    v_exp_f32 v32, v32
    v_mfma_f32_16x16x32_bf16 v[24:27], a[108:111], a[76:79], v[24:27]
    ds_read_b128 a[156:159], v3 offset:60416
    v_add_u32 v2, 0x10000, v2
    v_mfma_f32_16x16x32_bf16 v[24:27], a[112:115], a[80:83], v[24:27]
    s_add_u32 s27, s24, 73856
    v_exp_f32 v33, v33
    v_mfma_f32_16x16x32_bf16 v[24:27], a[116:119], a[84:87], v[24:27]
    s_add_u32 m0, s23, 18432
    v_exp_f32 v34, v34
    v_mfma_f32_16x16x32_bf16 v[24:27], a[120:123], a[88:91], v[24:27]
    s_waitcnt lgkmcnt(3)
    v_exp_f32 v35, v35
    v_mfma_f32_16x16x32_bf16 v[24:27], a[124:127], a[92:95], v[24:27]
    buffer_load_dwordx4 v1, s[12:15], s27 offen offset:0 nt lds
    v_add_u32 v3, 0x10000, v3
    v_mfma_f32_16x16x32_bf16 v[28:31], a[128:131], a[0:3], v[54:57]
    v_cvt_pk_bf16_f32 v214, v32, v33
    v_cvt_pk_bf16_f32 v215, v34, v35
    v_mfma_f32_16x16x32_bf16 v[28:31], a[132:135], a[4:7], v[28:31]
    v_exp_f32 v36, v36
    v_mfma_f32_16x16x32_bf16 v[28:31], a[136:139], a[8:11], v[28:31]
    v_exp_f32 v37, v37
    v_mfma_f32_16x16x32_bf16 v[28:31], a[140:143], a[12:15], v[28:31]
    v_exp_f32 v38, v38
    v_mfma_f32_16x16x32_bf16 v[28:31], a[144:147], a[16:19], v[28:31]
    s_waitcnt lgkmcnt(0)
    ds_read_b128 a[96:99], v2 offset:0
    v_cvt_pk_bf16_f32 v218, v36, v37
    v_mfma_f32_16x16x32_bf16 v[28:31], a[148:151], a[20:23], v[28:31]
    s_add_u32 s28, s24, 77952
    v_exp_f32 v39, v39
    v_mfma_f32_16x16x32_bf16 v[28:31], a[152:155], a[24:27], v[28:31]
    s_add_u32 m0, s23, 19456
    ds_read_b128 a[100:103], v3 offset:0
    v_cvt_pk_bf16_f32 v219, v38, v39
    v_mfma_f32_16x16x32_bf16 v[28:31], a[156:159], a[28:31], v[28:31]
    buffer_load_dwordx4 v1, s[12:15], s28 offen offset:0 nt lds
    v_mfma_f32_16x16x32_bf16 a[164:167], a[160:163], v[208:211], a[164:167]
    v_exp_f32 v16, v16
    v_mfma_f32_16x16x32_bf16 v[32:35], a[128:131], a[32:35], v[58:61]
    ds_read_b128 a[104:107], v2 offset:1024
    v_add_f32 v14, v14, v16
    v_mfma_f32_16x16x32_bf16 v[32:35], a[132:135], a[36:39], v[32:35]
    v_exp_f32 v17, v17
    v_mfma_f32_16x16x32_bf16 v[32:35], a[136:139], a[40:43], v[32:35]
    ds_read_b128 a[108:111], v3 offset:1024
    v_add_f32 v14, v14, v17
    v_mfma_f32_16x16x32_bf16 v[32:35], a[140:143], a[44:47], v[32:35]
    ds_read_b128 a[112:115], v2 offset:2048
    v_cvt_pk_bf16_f32 v220, v16, v17
    v_mfma_f32_16x16x32_bf16 v[32:35], a[144:147], a[48:51], v[32:35]
    v_exp_f32 v18, v18
    v_mfma_f32_16x16x32_bf16 v[32:35], a[148:151], a[52:55], v[32:35]
    ds_read_b128 a[116:119], v3 offset:2048
    v_add_f32 v14, v14, v18
    v_mfma_f32_16x16x32_bf16 v[32:35], a[152:155], a[56:59], v[32:35]
    v_exp_f32 v19, v19
    v_mfma_f32_16x16x32_bf16 v[32:35], a[156:159], a[60:63], v[32:35]
    ds_read_b128 a[120:123], v2 offset:3072
    v_cvt_pk_bf16_f32 v221, v18, v19
    v_mfma_f32_16x16x32_bf16 a[168:171], a[160:163], v[212:215], a[168:171]
    v_exp_f32 v20, v20
    v_mfma_f32_16x16x32_bf16 v[36:39], a[128:131], a[64:67], v[44:47]
    ds_read_b128 a[124:127], v3 offset:3072
    v_add_f32 v14, v14, v19
    v_mfma_f32_16x16x32_bf16 v[36:39], a[132:135], a[68:71], v[36:39]
    v_exp_f32 v21, v21
    v_mfma_f32_16x16x32_bf16 v[36:39], a[136:139], a[72:75], v[36:39]
    v_add_f32 v15, v15, v20
    v_cvt_pk_bf16_f32 v224, v20, v21
    v_mfma_f32_16x16x32_bf16 v[36:39], a[140:143], a[76:79], v[36:39]
    v_exp_f32 v22, v22
    v_mfma_f32_16x16x32_bf16 v[36:39], a[144:147], a[80:83], v[36:39]
    v_exp_f32 v23, v23
    v_mfma_f32_16x16x32_bf16 v[36:39], a[148:151], a[84:87], v[36:39]
    v_add_f32 v15, v15, v21
    v_cvt_pk_bf16_f32 v225, v22, v23
    v_mfma_f32_16x16x32_bf16 v[36:39], a[152:155], a[88:91], v[36:39]
    v_exp_f32 v24, v24
    v_mfma_f32_16x16x32_bf16 v[36:39], a[156:159], a[92:95], v[36:39]
    v_add_f32 v15, v15, v22
    v_add_f32 v48, v48, v24
    v_mfma_f32_16x16x32_bf16 a[172:175], a[160:163], v[216:219], a[172:175]
    s_waitcnt lgkmcnt(0)
    v_exp_f32 v25, v25
    v_mfma_f32_16x16x32_bf16 v[16:19], a[96:99], a[0:3], v[54:57]
    v_add_f32 v15, v15, v23
    v_add_f32 v48, v48, v25
    v_mfma_f32_16x16x32_bf16 v[16:19], a[100:103], a[4:7], v[16:19]
    v_exp_f32 v26, v26
    v_mfma_f32_16x16x32_bf16 v[16:19], a[104:107], a[8:11], v[16:19]
    v_exp_f32 v27, v27
    v_mfma_f32_16x16x32_bf16 v[16:19], a[108:111], a[12:15], v[16:19]
    v_add_f32 v48, v48, v26
    v_cvt_pk_bf16_f32 v228, v24, v25
    v_mfma_f32_16x16x32_bf16 v[16:19], a[112:115], a[16:19], v[16:19]
    ds_read_b128 a[128:131], v2 offset:8192
    v_cvt_pk_bf16_f32 v229, v26, v27
    v_mfma_f32_16x16x32_bf16 v[16:19], a[116:119], a[20:23], v[16:19]
    v_exp_f32 v28, v28
    v_mfma_f32_16x16x32_bf16 v[16:19], a[120:123], a[24:27], v[16:19]
    ds_read_b128 a[132:135], v3 offset:8192
    v_add_f32 v48, v48, v27
    v_mfma_f32_16x16x32_bf16 v[16:19], a[124:127], a[28:31], v[16:19]
    v_exp_f32 v29, v29
    v_mfma_f32_16x16x32_bf16 v[20:23], a[96:99], a[32:35], v[58:61]
    ds_read_b128 a[136:139], v2 offset:9216
    v_add_f32 v14, v14, v28
    v_mfma_f32_16x16x32_bf16 v[20:23], a[100:103], a[36:39], v[20:23]
    v_exp_f32 v30, v30
    v_mfma_f32_16x16x32_bf16 v[20:23], a[104:107], a[40:43], v[20:23]
    ds_read_b128 a[140:143], v3 offset:9216
    v_add_f32 v14, v14, v29
    v_mfma_f32_16x16x32_bf16 v[20:23], a[108:111], a[44:47], v[20:23]
    v_exp_f32 v31, v31
    v_mfma_f32_16x16x32_bf16 v[20:23], a[112:115], a[48:51], v[20:23]
    ds_read_b128 a[144:147], v2 offset:10240
    v_add_f32 v14, v14, v30
    v_mfma_f32_16x16x32_bf16 v[20:23], a[116:119], a[52:55], v[20:23]
    v_cvt_pk_bf16_f32 v222, v28, v29
    v_cvt_pk_bf16_f32 v223, v30, v31
    v_mfma_f32_16x16x32_bf16 v[20:23], a[120:123], a[56:59], v[20:23]
    ds_read_b128 a[148:151], v3 offset:10240
    v_add_f32 v14, v14, v31
    v_mfma_f32_16x16x32_bf16 v[20:23], a[124:127], a[60:63], v[20:23]
    v_exp_f32 v32, v32
    v_mfma_f32_16x16x32_bf16 v[24:27], a[96:99], a[64:67], v[44:47]
    ds_read_b128 a[152:155], v2 offset:11264
    v_add_f32 v15, v15, v32
    v_mfma_f32_16x16x32_bf16 v[24:27], a[100:103], a[68:71], v[24:27]
    v_exp_f32 v33, v33
    v_mfma_f32_16x16x32_bf16 v[24:27], a[104:107], a[72:75], v[24:27]
    ds_read_b128 a[156:159], v3 offset:11264
    v_add_f32 v15, v15, v33
    v_mfma_f32_16x16x32_bf16 v[24:27], a[108:111], a[76:79], v[24:27]
    v_exp_f32 v34, v34
    v_mfma_f32_16x16x32_bf16 v[24:27], a[112:115], a[80:83], v[24:27]
    v_exp_f32 v35, v35
    v_mfma_f32_16x16x32_bf16 v[24:27], a[116:119], a[84:87], v[24:27]
    v_add_f32 v15, v15, v34
    v_cvt_pk_bf16_f32 v226, v32, v33
    v_mfma_f32_16x16x32_bf16 v[24:27], a[120:123], a[88:91], v[24:27]
    v_cvt_pk_bf16_f32 v227, v34, v35
    v_add_f32 v15, v15, v35
    v_mfma_f32_16x16x32_bf16 v[24:27], a[124:127], a[92:95], v[24:27]
    s_waitcnt lgkmcnt(2)
    v_exp_f32 v36, v36
    v_mfma_f32_16x16x32_bf16 v[28:31], a[128:131], a[0:3], v[54:57]
    v_exp_f32 v37, v37
    v_mfma_f32_16x16x32_bf16 v[28:31], a[132:135], a[4:7], v[28:31]
    s_add_u32 s27, s24, 131200
    v_add_f32 v48, v48, v36
    v_cvt_pk_bf16_f32 v230, v36, v37
    v_mfma_f32_16x16x32_bf16 v[28:31], a[136:139], a[8:11], v[28:31]
    s_waitcnt vmcnt(24)
    v_exp_f32 v38, v38
    v_add_f32 v48, v48, v37
    v_mfma_f32_16x16x32_bf16 v[28:31], a[140:143], a[12:15], v[28:31]
    s_barrier
    v_exp_f32 v39, v39
    v_add_f32 v48, v48, v38
    v_mfma_f32_16x16x32_bf16 v[28:31], a[144:147], a[16:19], v[28:31]
    s_add_u32 m0, s23, 32768
    ds_read_b128 a[96:99], v2 offset:16384
    v_cvt_pk_bf16_f32 v231, v38, v39
    v_mfma_f32_16x16x32_bf16 v[28:31], a[148:151], a[20:23], v[28:31]
    s_waitcnt lgkmcnt(1)
    v_exp_f32 v16, v16
    v_mfma_f32_16x16x32_bf16 v[28:31], a[152:155], a[24:27], v[28:31]
    buffer_load_dwordx4 v1, s[12:15], s27 offen offset:0 nt lds
    ds_read_b128 a[100:103], v3 offset:16384
    v_mfma_f32_16x16x32_bf16 v[28:31], a[156:159], a[28:31], v[28:31]
    v_add_f32 v48, v48, v39
    v_add_f32 v14, v14, v16
    v_mfma_f32_16x16x32_bf16 v[32:35], a[128:131], a[32:35], v[58:61]
    v_exp_f32 v17, v17
    v_mfma_f32_16x16x32_bf16 v[32:35], a[132:135], a[36:39], v[32:35]
    ds_read_b128 a[104:107], v2 offset:17408
    v_add_f32 v14, v14, v17
    v_mfma_f32_16x16x32_bf16 v[32:35], a[136:139], a[40:43], v[32:35]
    ds_read_b128 a[108:111], v3 offset:17408
    v_cvt_pk_bf16_f32 v232, v16, v17
    v_mfma_f32_16x16x32_bf16 v[32:35], a[140:143], a[44:47], v[32:35]
    v_exp_f32 v18, v18
    v_mfma_f32_16x16x32_bf16 v[32:35], a[144:147], a[48:51], v[32:35]
    s_add_u32 s28, s24, 135296
    ds_read_b128 a[112:115], v2 offset:18432
    v_add_f32 v14, v14, v18
    v_mfma_f32_16x16x32_bf16 v[32:35], a[148:151], a[52:55], v[32:35]
    s_add_u32 m0, s23, 33792
    v_exp_f32 v19, v19
    v_mfma_f32_16x16x32_bf16 v[32:35], a[152:155], a[56:59], v[32:35]
    buffer_load_dwordx4 v1, s[12:15], s28 offen offset:0 nt lds
    ds_read_b128 a[116:119], v3 offset:18432
    v_mfma_f32_16x16x32_bf16 v[32:35], a[156:159], a[60:63], v[32:35]
    v_cvt_pk_bf16_f32 v233, v18, v19
    v_add_f32 v14, v14, v19
    v_mfma_f32_16x16x32_bf16 v[36:39], a[128:131], a[64:67], v[44:47]
    v_exp_f32 v20, v20
    ds_read_b128 a[120:123], v2 offset:19456
    v_mfma_f32_16x16x32_bf16 v[36:39], a[132:135], a[68:71], v[36:39]
    v_exp_f32 v21, v21
    v_mfma_f32_16x16x32_bf16 v[36:39], a[136:139], a[72:75], v[36:39]
    ds_read_b128 a[124:127], v3 offset:19456
    v_add_f32 v15, v15, v20
    v_cvt_pk_bf16_f32 v236, v20, v21
    v_mfma_f32_16x16x32_bf16 v[36:39], a[140:143], a[76:79], v[36:39]
    v_exp_f32 v22, v22
    v_mfma_f32_16x16x32_bf16 v[36:39], a[144:147], a[80:83], v[36:39]
    s_add_u32 s27, s24, 139392
    v_exp_f32 v23, v23
    v_add_f32 v15, v15, v21
    v_mfma_f32_16x16x32_bf16 v[36:39], a[148:151], a[84:87], v[36:39]
    s_add_u32 m0, s23, 34816
    v_add_f32 v15, v15, v22
    v_cvt_pk_bf16_f32 v237, v22, v23
    v_mfma_f32_16x16x32_bf16 v[36:39], a[152:155], a[88:91], v[36:39]
    buffer_load_dwordx4 v1, s[12:15], s27 offen offset:0 nt lds
    v_add_f32 v15, v15, v23
    v_mfma_f32_16x16x32_bf16 v[36:39], a[156:159], a[92:95], v[36:39]
    s_waitcnt lgkmcnt(2)
    v_exp_f32 v24, v24
    v_mfma_f32_16x16x32_bf16 v[16:19], a[96:99], a[0:3], v[54:57]
    v_exp_f32 v25, v25
    v_mfma_f32_16x16x32_bf16 v[16:19], a[100:103], a[4:7], v[16:19]
    v_add_f32 v48, v48, v24
    v_cvt_pk_bf16_f32 v240, v24, v25
    v_mfma_f32_16x16x32_bf16 v[16:19], a[104:107], a[8:11], v[16:19]
    v_exp_f32 v26, v26
    v_mfma_f32_16x16x32_bf16 v[16:19], a[108:111], a[12:15], v[16:19]
    s_add_u32 s28, s24, 143488
    v_add_f32 v48, v48, v25
    v_add_u32 v4, 0x18000, v51
    v_mfma_f32_16x16x32_bf16 v[16:19], a[112:115], a[16:19], v[16:19]
    s_add_u32 m0, s23, 35840
    ds_read_b128 a[128:131], v2 offset:24576
    v_add_f32 v48, v48, v26
    v_mfma_f32_16x16x32_bf16 v[16:19], a[116:119], a[20:23], v[16:19]
    s_waitcnt lgkmcnt(1)
    v_exp_f32 v27, v27
    v_mfma_f32_16x16x32_bf16 v[16:19], a[120:123], a[24:27], v[16:19]
    buffer_load_dwordx4 v1, s[12:15], s28 offen offset:0 nt lds
    ds_read_b128 a[132:135], v3 offset:24576
    v_mfma_f32_16x16x32_bf16 v[16:19], a[124:127], a[28:31], v[16:19]
    v_cvt_pk_bf16_f32 v241, v26, v27
    v_add_f32 v48, v48, v27
    v_mfma_f32_16x16x32_bf16 v[20:23], a[96:99], a[32:35], v[58:61]
    s_add_u32 s27, s24, 196736
    ds_read_b128 a[136:139], v2 offset:25600
    v_add_u32 v5, 0x18000, v52
    v_mfma_f32_16x16x32_bf16 v[20:23], a[100:103], a[36:39], v[20:23]
    s_add_u32 m0, s23, 49152
    v_exp_f32 v28, v28
    v_mfma_f32_16x16x32_bf16 v[20:23], a[104:107], a[40:43], v[20:23]
    buffer_load_dwordx4 v1, s[12:15], s27 offen offset:0 nt lds
    ds_read_b128 a[140:143], v3 offset:25600
    v_mfma_f32_16x16x32_bf16 v[20:23], a[108:111], a[44:47], v[20:23]
    v_exp_f32 v29, v29
    v_mfma_f32_16x16x32_bf16 v[20:23], a[112:115], a[48:51], v[20:23]
    s_add_u32 s28, s24, 200832
    ds_read_b128 a[144:147], v2 offset:26624
    v_add_f32 v14, v14, v28
    v_mfma_f32_16x16x32_bf16 v[20:23], a[116:119], a[52:55], v[20:23]
    s_add_u32 m0, s23, 50176
    v_exp_f32 v30, v30
    v_mfma_f32_16x16x32_bf16 v[20:23], a[120:123], a[56:59], v[20:23]
    buffer_load_dwordx4 v1, s[12:15], s28 offen offset:0 nt lds
    ds_read_b128 a[148:151], v3 offset:26624
    v_mfma_f32_16x16x32_bf16 v[20:23], a[124:127], a[60:63], v[20:23]
    v_add_f32 v14, v14, v29
    v_cvt_pk_bf16_f32 v234, v28, v29
    v_mfma_f32_16x16x32_bf16 v[24:27], a[96:99], a[64:67], v[44:47]
    s_add_u32 s27, s24, 204928
    ds_read_b128 a[152:155], v2 offset:27648
    v_add_f32 v14, v14, v30
    v_mfma_f32_16x16x32_bf16 v[24:27], a[100:103], a[68:71], v[24:27]
    s_add_u32 m0, s23, 51200
    v_exp_f32 v31, v31
    v_mfma_f32_16x16x32_bf16 v[24:27], a[104:107], a[72:75], v[24:27]
    buffer_load_dwordx4 v1, s[12:15], s27 offen offset:0 nt lds
    ds_read_b128 a[156:159], v3 offset:27648
    v_mfma_f32_16x16x32_bf16 v[24:27], a[108:111], a[76:79], v[24:27]
    v_cvt_pk_bf16_f32 v235, v30, v31
    v_add_f32 v14, v14, v31
    v_mfma_f32_16x16x32_bf16 v[24:27], a[112:115], a[80:83], v[24:27]
    s_add_u32 s28, s24, 209024
    v_exp_f32 v32, v32
    v_mfma_f32_16x16x32_bf16 v[24:27], a[116:119], a[84:87], v[24:27]
    s_add_u32 m0, s23, 52224
    v_exp_f32 v33, v33
    v_mfma_f32_16x16x32_bf16 v[24:27], a[120:123], a[88:91], v[24:27]
    buffer_load_dwordx4 v1, s[12:15], s28 offen offset:0 nt lds
    v_add_f32 v15, v15, v32
    v_mfma_f32_16x16x32_bf16 v[24:27], a[124:127], a[92:95], v[24:27]
    s_waitcnt lgkmcnt(2)
    v_exp_f32 v34, v34
    v_mfma_f32_16x16x32_bf16 v[28:31], a[128:131], a[0:3], v[54:57]
    v_add_f32 v15, v15, v33
    v_add_u32 v2, 0x18000, v49
    v_mfma_f32_16x16x32_bf16 v[28:31], a[132:135], a[4:7], v[28:31]
    v_exp_f32 v35, v35
    v_mfma_f32_16x16x32_bf16 v[28:31], a[136:139], a[8:11], v[28:31]
    v_add_f32 v15, v15, v34
    v_cvt_pk_bf16_f32 v238, v32, v33
    v_mfma_f32_16x16x32_bf16 v[28:31], a[140:143], a[12:15], v[28:31]
    s_waitcnt vmcnt(16)
    v_cvt_pk_bf16_f32 v239, v34, v35
    v_add_f32 v15, v15, v35
    v_mfma_f32_16x16x32_bf16 v[28:31], a[144:147], a[16:19], v[28:31]
    s_barrier
    v_exp_f32 v36, v36
    v_mfma_f32_16x16x32_bf16 v[28:31], a[148:151], a[20:23], v[28:31]
    s_waitcnt lgkmcnt(0)
    v_exp_f32 v37, v37
    v_mfma_f32_16x16x32_bf16 v[28:31], a[152:155], a[24:27], v[28:31]
    s_add_u32 s27, s24, 256
    ds_read_b64_tr_b16 a[96:97], v2 offset:0
    v_add_f32 v48, v48, v36
    v_mfma_f32_16x16x32_bf16 v[28:31], a[156:159], a[28:31], v[28:31]
    s_add_u32 m0, s23, 65536
    v_exp_f32 v38, v38
    v_mfma_f32_16x16x32_bf16 v[32:35], a[128:131], a[32:35], v[58:61]
    buffer_load_dwordx4 v1, s[12:15], s27 offen offset:0 nt lds
    ds_read_b64_tr_b16 a[98:99], v2 offset:2048
    v_mfma_f32_16x16x32_bf16 v[32:35], a[132:135], a[36:39], v[32:35]
    v_add_f32 v48, v48, v37
    v_cvt_pk_bf16_f32 v242, v36, v37
    v_mfma_f32_16x16x32_bf16 v[32:35], a[136:139], a[40:43], v[32:35]
    s_add_u32 s28, s24, 4352
    ds_read_b64_tr_b16 a[100:101], v2 offset:4096
    v_add_f32 v48, v48, v38
    v_mfma_f32_16x16x32_bf16 v[32:35], a[140:143], a[44:47], v[32:35]
    s_add_u32 m0, s23, 66560
    v_exp_f32 v39, v39
    v_mfma_f32_16x16x32_bf16 v[32:35], a[144:147], a[48:51], v[32:35]
    buffer_load_dwordx4 v1, s[12:15], s28 offen offset:0 nt lds
    ds_read_b64_tr_b16 a[102:103], v2 offset:6144
    v_mfma_f32_16x16x32_bf16 v[32:35], a[148:151], a[52:55], v[32:35]
    v_cvt_pk_bf16_f32 v243, v38, v39
    v_add_f32 v48, v48, v39
    v_mfma_f32_16x16x32_bf16 v[32:35], a[152:155], a[56:59], v[32:35]
    s_add_u32 s27, s24, 8448
    ds_read_b64_tr_b16 a[104:105], v2 offset:8192
    v_add_u32 v3, 0x18000, v50
    v_mfma_f32_16x16x32_bf16 v[32:35], a[156:159], a[60:63], v[32:35]
    s_add_u32 m0, s23, 67584
    v_exp_f32 v16, v16
    v_mfma_f32_16x16x32_bf16 v[36:39], a[128:131], a[64:67], v[44:47]
    buffer_load_dwordx4 v1, s[12:15], s27 offen offset:0 nt lds
    ds_read_b64_tr_b16 a[106:107], v2 offset:10240
    v_mfma_f32_16x16x32_bf16 v[36:39], a[132:135], a[68:71], v[36:39]
    v_exp_f32 v17, v17
    v_mfma_f32_16x16x32_bf16 v[36:39], a[136:139], a[72:75], v[36:39]
    s_add_u32 s28, s24, 12544
    ds_read_b64_tr_b16 a[108:109], v2 offset:12288
    v_cvt_pk_bf16_f32 v244, v16, v17
    v_mfma_f32_16x16x32_bf16 v[36:39], a[140:143], a[76:79], v[36:39]
    s_add_u32 m0, s23, 68608
    v_exp_f32 v18, v18
    v_mfma_f32_16x16x32_bf16 v[36:39], a[144:147], a[80:83], v[36:39]
    buffer_load_dwordx4 v1, s[12:15], s28 offen offset:0 nt lds
    ds_read_b64_tr_b16 a[110:111], v2 offset:14336
    v_mfma_f32_16x16x32_bf16 v[36:39], a[148:151], a[84:87], v[36:39]
    v_exp_f32 v19, v19
    v_mfma_f32_16x16x32_bf16 v[36:39], a[152:155], a[88:91], v[36:39]
    v_exp_f32 v20, v20
    v_mfma_f32_16x16x32_bf16 v[36:39], a[156:159], a[92:95], v[36:39]
    s_waitcnt lgkmcnt(4)
    v_exp_f32 v21, v21
    v_mfma_f32_16x16x32_bf16 a[0:3], a[96:99], v[64:67], 0
    ds_read_b64_tr_b16 a[112:113], v3 offset:0
    v_cvt_pk_bf16_f32 v245, v18, v19
    v_mfma_f32_16x16x32_bf16 a[0:3], a[100:103], v[76:79], a[0:3]
    s_waitcnt lgkmcnt(3)
    ds_read_b64_tr_b16 a[114:115], v3 offset:2048
    v_cvt_pk_bf16_f32 v248, v20, v21
    v_mfma_f32_16x16x32_bf16 a[0:3], a[104:107], v[88:91], a[0:3]
    s_waitcnt lgkmcnt(2)
    ds_read_b64_tr_b16 a[116:117], v3 offset:4096
    ds_read_b64_tr_b16 a[128:129], v4 offset:0
    v_mfma_f32_16x16x32_bf16 a[0:3], a[108:111], v[100:103], a[0:3]
    ds_read_b64_tr_b16 a[118:119], v3 offset:6144
    ds_read_b64_tr_b16 a[130:131], v4 offset:2048
    v_mfma_f32_16x16x32_bf16 a[4:7], a[96:99], v[68:71], 0
    ds_read_b64_tr_b16 a[120:121], v3 offset:8192
    ds_read_b64_tr_b16 a[132:133], v4 offset:4096
    v_mfma_f32_16x16x32_bf16 a[4:7], a[100:103], v[80:83], a[4:7]
    ds_read_b64_tr_b16 a[122:123], v3 offset:10240
    ds_read_b64_tr_b16 a[134:135], v4 offset:6144
    v_mfma_f32_16x16x32_bf16 a[4:7], a[104:107], v[92:95], a[4:7]
    ds_read_b64_tr_b16 a[124:125], v3 offset:12288
    ds_read_b64_tr_b16 a[136:137], v4 offset:8192
    v_mfma_f32_16x16x32_bf16 a[4:7], a[108:111], v[104:107], a[4:7]
    ds_read_b64_tr_b16 a[126:127], v3 offset:14336
    ds_read_b64_tr_b16 a[138:139], v4 offset:10240
    v_mfma_f32_16x16x32_bf16 a[8:11], a[96:99], v[72:75], 0
    v_exp_f32 v22, v22
    v_mfma_f32_16x16x32_bf16 a[8:11], a[100:103], v[84:87], a[8:11]
    ds_read_b64_tr_b16 a[140:141], v4 offset:12288
    ds_read_b64_tr_b16 a[142:143], v4 offset:14336
    v_mfma_f32_16x16x32_bf16 a[8:11], a[104:107], v[96:99], a[8:11]
    v_exp_f32 v23, v23
    v_mfma_f32_16x16x32_bf16 a[8:11], a[108:111], v[108:111], a[8:11]
    s_waitcnt lgkmcnt(11)
    v_exp_f32 v24, v24
    v_mfma_f32_16x16x32_bf16 a[12:15], a[112:115], v[64:67], 0
    v_exp_f32 v25, v25
    v_mfma_f32_16x16x32_bf16 a[12:15], a[116:119], v[76:79], a[12:15]
    s_waitcnt lgkmcnt(7)
    v_cvt_pk_bf16_f32 v249, v22, v23
    v_cvt_pk_bf16_f32 v252, v24, v25
    v_mfma_f32_16x16x32_bf16 a[12:15], a[120:123], v[88:91], a[12:15]
    s_waitcnt lgkmcnt(3)
    v_exp_f32 v26, v26
    v_mfma_f32_16x16x32_bf16 a[12:15], a[124:127], v[100:103], a[12:15]
    ds_read_b64_tr_b16 a[144:145], v5 offset:0
    ds_read_b64_tr_b16 a[146:147], v5 offset:2048
    v_mfma_f32_16x16x32_bf16 a[16:19], a[112:115], v[68:71], 0
    v_exp_f32 v27, v27
    v_mfma_f32_16x16x32_bf16 a[16:19], a[116:119], v[80:83], a[16:19]
    ds_read_b64_tr_b16 a[148:149], v5 offset:4096
    ds_read_b64_tr_b16 a[150:151], v5 offset:6144
    v_mfma_f32_16x16x32_bf16 a[16:19], a[120:123], v[92:95], a[16:19]
    ds_read_b64_tr_b16 a[152:153], v5 offset:8192
    v_cvt_pk_bf16_f32 v253, v26, v27
    v_mfma_f32_16x16x32_bf16 a[16:19], a[124:127], v[104:107], a[16:19]
    v_exp_f32 v28, v28
    v_mfma_f32_16x16x32_bf16 a[20:23], a[112:115], v[72:75], 0
    ds_read_b64_tr_b16 a[154:155], v5 offset:10240
    ds_read_b64_tr_b16 a[156:157], v5 offset:12288
    v_mfma_f32_16x16x32_bf16 a[20:23], a[116:119], v[84:87], a[20:23]
    v_exp_f32 v29, v29
    v_mfma_f32_16x16x32_bf16 a[20:23], a[120:123], v[96:99], a[20:23]
    ds_read_b64_tr_b16 a[158:159], v5 offset:14336
    v_cvt_pk_bf16_f32 v246, v28, v29
    v_mfma_f32_16x16x32_bf16 a[20:23], a[124:127], v[108:111], a[20:23]
    v_exp_f32 v30, v30
    v_mfma_f32_16x16x32_bf16 a[24:27], a[128:131], v[64:67], 0
    v_exp_f32 v31, v31
    v_mfma_f32_16x16x32_bf16 a[24:27], a[132:135], v[76:79], a[24:27]
    s_waitcnt lgkmcnt(4)
    v_exp_f32 v32, v32
    v_mfma_f32_16x16x32_bf16 a[24:27], a[136:139], v[88:91], a[24:27]
    ds_read_b64_tr_b16 a[96:97], v2 offset:16384
    v_cvt_pk_bf16_f32 v247, v30, v31
    v_mfma_f32_16x16x32_bf16 a[24:27], a[140:143], v[100:103], a[24:27]
    v_exp_f32 v33, v33
    v_mfma_f32_16x16x32_bf16 a[28:31], a[128:131], v[68:71], 0
    ds_read_b64_tr_b16 a[98:99], v2 offset:18432
    ds_read_b64_tr_b16 a[100:101], v2 offset:20480
    v_mfma_f32_16x16x32_bf16 a[28:31], a[132:135], v[80:83], a[28:31]
    ds_read_b64_tr_b16 a[102:103], v2 offset:22528
    v_cvt_pk_bf16_f32 v250, v32, v33
    v_mfma_f32_16x16x32_bf16 a[28:31], a[136:139], v[92:95], a[28:31]
    v_exp_f32 v34, v34
    v_mfma_f32_16x16x32_bf16 a[28:31], a[140:143], v[104:107], a[28:31]
    ds_read_b64_tr_b16 a[104:105], v2 offset:24576
    ds_read_b64_tr_b16 a[106:107], v2 offset:26624
    v_mfma_f32_16x16x32_bf16 a[32:35], a[128:131], v[72:75], 0
    v_exp_f32 v35, v35
    v_mfma_f32_16x16x32_bf16 a[32:35], a[132:135], v[84:87], a[32:35]
    ds_read_b64_tr_b16 a[108:109], v2 offset:28672
    ds_read_b64_tr_b16 a[110:111], v2 offset:30720
    v_mfma_f32_16x16x32_bf16 a[32:35], a[136:139], v[96:99], a[32:35]
    v_exp_f32 v36, v36
    v_mfma_f32_16x16x32_bf16 a[32:35], a[140:143], v[108:111], a[32:35]
    v_exp_f32 v37, v37
    v_mfma_f32_16x16x32_bf16 a[36:39], a[144:147], v[64:67], 0
    v_cvt_pk_bf16_f32 v251, v34, v35
    v_cvt_pk_bf16_f32 v254, v36, v37
    v_mfma_f32_16x16x32_bf16 a[36:39], a[148:151], v[76:79], a[36:39]
    s_waitcnt lgkmcnt(4)
    v_exp_f32 v38, v38
    v_mfma_f32_16x16x32_bf16 a[36:39], a[152:155], v[88:91], a[36:39]
    v_exp_f32 v39, v39
    v_mfma_f32_16x16x32_bf16 a[36:39], a[156:159], v[100:103], a[36:39]
    ds_read_b64_tr_b16 a[112:113], v3 offset:16384
    ds_read_b64_tr_b16 a[114:115], v3 offset:18432
    v_mfma_f32_16x16x32_bf16 a[40:43], a[144:147], v[68:71], 0
    ds_read_b64_tr_b16 a[116:117], v3 offset:20480
    v_cvt_pk_bf16_f32 v255, v38, v39
    v_mfma_f32_16x16x32_bf16 a[40:43], a[148:151], v[80:83], a[40:43]
    ds_read_b64_tr_b16 a[118:119], v3 offset:22528
    v_mfma_f32_16x16x32_bf16 a[40:43], a[152:155], v[92:95], a[40:43]
    ds_read_b64_tr_b16 a[120:121], v3 offset:24576
    v_mfma_f32_16x16x32_bf16 a[40:43], a[156:159], v[104:107], a[40:43]
    ds_read_b64_tr_b16 a[122:123], v3 offset:26624
    v_mfma_f32_16x16x32_bf16 a[44:47], a[144:147], v[72:75], 0
    ds_read_b64_tr_b16 a[124:125], v3 offset:28672
    v_mfma_f32_16x16x32_bf16 a[44:47], a[148:151], v[84:87], a[44:47]
    ds_read_b64_tr_b16 a[126:127], v3 offset:30720
    v_mfma_f32_16x16x32_bf16 a[44:47], a[152:155], v[96:99], a[44:47]
    v_mfma_f32_16x16x32_bf16 a[44:47], a[156:159], v[108:111], a[44:47]
    v_mfma_f32_16x16x32_bf16 a[0:3], a[96:99], v[112:115], a[0:3]
    v_mfma_f32_16x16x32_bf16 a[0:3], a[100:103], v[124:127], a[0:3]
    s_waitcnt lgkmcnt(4)
    v_mfma_f32_16x16x32_bf16 a[0:3], a[104:107], v[136:139], a[0:3]
    ds_read_b64_tr_b16 a[128:129], v4 offset:16384
    v_mfma_f32_16x16x32_bf16 a[0:3], a[108:111], v[148:151], a[0:3]
    ds_read_b64_tr_b16 a[130:131], v4 offset:18432
    v_mfma_f32_16x16x32_bf16 a[4:7], a[96:99], v[116:119], a[4:7]
    ds_read_b64_tr_b16 a[132:133], v4 offset:20480
    v_mfma_f32_16x16x32_bf16 a[4:7], a[100:103], v[128:131], a[4:7]
    ds_read_b64_tr_b16 a[134:135], v4 offset:22528
    v_mfma_f32_16x16x32_bf16 a[4:7], a[104:107], v[140:143], a[4:7]
    ds_read_b64_tr_b16 a[136:137], v4 offset:24576
    v_mfma_f32_16x16x32_bf16 a[4:7], a[108:111], v[152:155], a[4:7]
    ds_read_b64_tr_b16 a[138:139], v4 offset:26624
    v_mfma_f32_16x16x32_bf16 a[8:11], a[96:99], v[120:123], a[8:11]
L_pg4:
    s_cbranch_execz L_back
    ds_read_b64_tr_b16 a[140:141], v4 offset:28672
    v_mfma_f32_16x16x32_bf16 a[8:11], a[100:103], v[132:135], a[8:11]
    ds_read_b64_tr_b16 a[142:143], v4 offset:30720
    v_mfma_f32_16x16x32_bf16 a[8:11], a[104:107], v[144:147], a[8:11]
    v_mfma_f32_16x16x32_bf16 a[8:11], a[108:111], v[156:159], a[8:11]
    v_mfma_f32_16x16x32_bf16 a[12:15], a[112:115], v[112:115], a[12:15]
    v_mfma_f32_16x16x32_bf16 a[12:15], a[116:119], v[124:127], a[12:15]
    s_waitcnt lgkmcnt(4)
    v_mfma_f32_16x16x32_bf16 a[12:15], a[120:123], v[136:139], a[12:15]
    ds_read_b64_tr_b16 a[144:145], v5 offset:16384
    v_mfma_f32_16x16x32_bf16 a[12:15], a[124:127], v[148:151], a[12:15]
    ds_read_b64_tr_b16 a[146:147], v5 offset:18432
    v_mfma_f32_16x16x32_bf16 a[16:19], a[112:115], v[116:119], a[16:19]
    ds_read_b64_tr_b16 a[148:149], v5 offset:20480
    v_mfma_f32_16x16x32_bf16 a[16:19], a[116:119], v[128:131], a[16:19]
    ds_read_b64_tr_b16 a[150:151], v5 offset:22528
    v_mfma_f32_16x16x32_bf16 a[16:19], a[120:123], v[140:143], a[16:19]
    ds_read_b64_tr_b16 a[152:153], v5 offset:24576
    v_mfma_f32_16x16x32_bf16 a[16:19], a[124:127], v[152:155], a[16:19]
    ds_read_b64_tr_b16 a[154:155], v5 offset:26624
    v_mfma_f32_16x16x32_bf16 a[20:23], a[112:115], v[120:123], a[20:23]
    ds_read_b64_tr_b16 a[156:157], v5 offset:28672
    v_mfma_f32_16x16x32_bf16 a[20:23], a[116:119], v[132:135], a[20:23]
    ds_read_b64_tr_b16 a[158:159], v5 offset:30720
    v_mfma_f32_16x16x32_bf16 a[20:23], a[120:123], v[144:147], a[20:23]
    v_mfma_f32_16x16x32_bf16 a[20:23], a[124:127], v[156:159], a[20:23]
    v_mfma_f32_16x16x32_bf16 a[24:27], a[128:131], v[112:115], a[24:27]
    v_mfma_f32_16x16x32_bf16 a[24:27], a[132:135], v[124:127], a[24:27]
    s_waitcnt lgkmcnt(4)
    v_mfma_f32_16x16x32_bf16 a[24:27], a[136:139], v[136:139], a[24:27]
    ds_read_b64_tr_b16 a[96:97], v2 offset:32768
    v_mfma_f32_16x16x32_bf16 a[24:27], a[140:143], v[148:151], a[24:27]
    ds_read_b64_tr_b16 a[98:99], v2 offset:34816
    v_mfma_f32_16x16x32_bf16 a[28:31], a[128:131], v[116:119], a[28:31]
    ds_read_b64_tr_b16 a[100:101], v2 offset:36864
    v_mfma_f32_16x16x32_bf16 a[28:31], a[132:135], v[128:131], a[28:31]
    ds_read_b64_tr_b16 a[102:103], v2 offset:38912
    v_mfma_f32_16x16x32_bf16 a[28:31], a[136:139], v[140:143], a[28:31]
    ds_read_b64_tr_b16 a[104:105], v2 offset:40960
    v_mfma_f32_16x16x32_bf16 a[28:31], a[140:143], v[152:155], a[28:31]
    ds_read_b64_tr_b16 a[106:107], v2 offset:43008
    v_mfma_f32_16x16x32_bf16 a[32:35], a[128:131], v[120:123], a[32:35]
    ds_read_b64_tr_b16 a[108:109], v2 offset:45056
    v_mfma_f32_16x16x32_bf16 a[32:35], a[132:135], v[132:135], a[32:35]
    ds_read_b64_tr_b16 a[110:111], v2 offset:47104
    v_mfma_f32_16x16x32_bf16 a[32:35], a[136:139], v[144:147], a[32:35]
    v_mfma_f32_16x16x32_bf16 a[32:35], a[140:143], v[156:159], a[32:35]
    v_mfma_f32_16x16x32_bf16 a[36:39], a[144:147], v[112:115], a[36:39]
    v_mfma_f32_16x16x32_bf16 a[36:39], a[148:151], v[124:127], a[36:39]
    s_waitcnt lgkmcnt(4)
    v_mfma_f32_16x16x32_bf16 a[36:39], a[152:155], v[136:139], a[36:39]
    ds_read_b64_tr_b16 a[112:113], v3 offset:32768
    v_mfma_f32_16x16x32_bf16 a[36:39], a[156:159], v[148:151], a[36:39]
    ds_read_b64_tr_b16 a[114:115], v3 offset:34816
    v_mfma_f32_16x16x32_bf16 a[40:43], a[144:147], v[116:119], a[40:43]
    ds_read_b64_tr_b16 a[116:117], v3 offset:36864
    v_mfma_f32_16x16x32_bf16 a[40:43], a[148:151], v[128:131], a[40:43]
    s_waitcnt vmcnt(12)
    ds_read_b64_tr_b16 a[118:119], v3 offset:38912
    v_mfma_f32_16x16x32_bf16 a[40:43], a[152:155], v[140:143], a[40:43]
    s_barrier
    ds_read_b64_tr_b16 a[120:121], v3 offset:40960
    v_mfma_f32_16x16x32_bf16 a[40:43], a[156:159], v[152:155], a[40:43]
    s_add_u32 s27, s24, 65792
    ds_read_b64_tr_b16 a[122:123], v3 offset:43008
    v_mfma_f32_16x16x32_bf16 a[44:47], a[144:147], v[120:123], a[44:47]
    s_add_u32 m0, s23, 81920
    ds_read_b64_tr_b16 a[124:125], v3 offset:45056
    v_mov_b32 v56, v14
    v_mfma_f32_16x16x32_bf16 a[44:47], a[148:151], v[132:135], a[44:47]
    buffer_load_dwordx4 v1, s[12:15], s27 offen offset:0 nt lds
    ds_read_b64_tr_b16 a[126:127], v3 offset:47104
    v_mfma_f32_16x16x32_bf16 a[44:47], a[152:155], v[144:147], a[44:47]
    v_mov_b32 v57, v15
    v_mov_b32 v58, v48
    v_mfma_f32_16x16x32_bf16 a[44:47], a[156:159], v[156:159], a[44:47]
    s_add_u32 s28, s24, 69888
    v_permlane32_swap_b32 v14, v56
    v_mfma_f32_16x16x32_bf16 a[0:3], a[96:99], v[160:163], a[0:3]
    s_add_u32 m0, s23, 82944
    v_permlane32_swap_b32 v15, v57
    v_mfma_f32_16x16x32_bf16 a[0:3], a[100:103], v[172:175], a[0:3]
    s_waitcnt lgkmcnt(4)
    v_permlane32_swap_b32 v48, v58
    v_mfma_f32_16x16x32_bf16 a[0:3], a[104:107], v[184:187], a[0:3]
    buffer_load_dwordx4 v1, s[12:15], s28 offen offset:0 nt lds
    ds_read_b64_tr_b16 a[128:129], v4 offset:32768
    v_mfma_f32_16x16x32_bf16 a[0:3], a[108:111], v[196:199], a[0:3]
    ds_read_b64_tr_b16 a[130:131], v4 offset:34816
    v_add_f32 v14, v14, v56
    v_mfma_f32_16x16x32_bf16 a[4:7], a[96:99], v[164:167], a[4:7]
    ds_read_b64_tr_b16 a[132:133], v4 offset:36864
    v_add_f32 v15, v15, v57
    v_mfma_f32_16x16x32_bf16 a[4:7], a[100:103], v[176:179], a[4:7]
    s_add_u32 s27, s24, 73984
    ds_read_b64_tr_b16 a[134:135], v4 offset:38912
    v_add_f32 v48, v48, v58
    v_mfma_f32_16x16x32_bf16 a[4:7], a[104:107], v[188:191], a[4:7]
    s_add_u32 m0, s23, 83968
    ds_read_b64_tr_b16 a[136:137], v4 offset:40960
    v_mov_b32 v56, v14
    v_mfma_f32_16x16x32_bf16 a[4:7], a[108:111], v[200:203], a[4:7]
    buffer_load_dwordx4 v1, s[12:15], s27 offen offset:0 nt lds
    ds_read_b64_tr_b16 a[138:139], v4 offset:43008
    v_mfma_f32_16x16x32_bf16 a[8:11], a[96:99], v[168:171], a[8:11]
    ds_read_b64_tr_b16 a[140:141], v4 offset:45056
    v_mov_b32 v57, v15
    v_mfma_f32_16x16x32_bf16 a[8:11], a[100:103], v[180:183], a[8:11]
    ds_read_b64_tr_b16 a[142:143], v4 offset:47104
    v_mov_b32 v58, v48
    v_mfma_f32_16x16x32_bf16 a[8:11], a[104:107], v[192:195], a[8:11]
    s_add_u32 s28, s24, 78080
    v_permlane16_swap_b32 v14, v56
    v_mfma_f32_16x16x32_bf16 a[8:11], a[108:111], v[204:207], a[8:11]
    s_add_u32 m0, s23, 84992
    v_permlane16_swap_b32 v15, v57
    v_mfma_f32_16x16x32_bf16 a[12:15], a[112:115], v[160:163], a[12:15]
    buffer_load_dwordx4 v1, s[12:15], s28 offen offset:0 nt lds
    v_add_f32 v14, v14, v56
    v_mfma_f32_16x16x32_bf16 a[12:15], a[116:119], v[172:175], a[12:15]
    s_waitcnt lgkmcnt(4)
    v_permlane16_swap_b32 v48, v58
    v_mfma_f32_16x16x32_bf16 a[12:15], a[120:123], v[184:187], a[12:15]
    v_add_f32 v15, v15, v57
    v_add_f32 v48, v48, v58
    v_mfma_f32_16x16x32_bf16 a[12:15], a[124:127], v[196:199], a[12:15]
    v_mov_b32 v36, v49
    v_mov_b32 v37, v50
    v_mfma_f32_16x16x32_bf16 a[164:167], a[160:163], v[244:247], a[164:167]
    s_add_u32 s27, s24, 131328
    v_mov_b32 v38, v51
    v_mov_b32 v39, v52
    v_mfma_f32_16x16x32_bf16 a[16:19], a[112:115], v[164:167], a[16:19]
    s_add_u32 m0, s23, 98304
    ds_read_b64_tr_b16 a[144:145], v5 offset:32768
    v_mfma_f32_16x16x32_bf16 a[16:19], a[116:119], v[176:179], a[16:19]
    buffer_load_dwordx4 v1, s[12:15], s27 offen offset:0 nt lds
    ds_read_b64_tr_b16 a[146:147], v5 offset:34816
    v_mfma_f32_16x16x32_bf16 a[16:19], a[120:123], v[188:191], a[16:19]
    ds_read_b64_tr_b16 a[148:149], v5 offset:36864
    v_mfma_f32_16x16x32_bf16 a[16:19], a[124:127], v[200:203], a[16:19]
    ds_read_b64_tr_b16 a[150:151], v5 offset:38912
    v_mfma_f32_16x16x32_bf16 a[168:171], a[160:163], v[248:251], a[168:171]
    s_add_u32 s28, s24, 135424
    ds_read_b64_tr_b16 a[152:153], v5 offset:40960
    v_mfma_f32_16x16x32_bf16 a[20:23], a[112:115], v[168:171], a[20:23]
    s_add_u32 m0, s23, 99328
    ds_read_b64_tr_b16 a[154:155], v5 offset:43008
    v_mfma_f32_16x16x32_bf16 a[20:23], a[116:119], v[180:183], a[20:23]
    buffer_load_dwordx4 v1, s[12:15], s28 offen offset:0 nt lds
    ds_read_b64_tr_b16 a[156:157], v5 offset:45056
    v_mfma_f32_16x16x32_bf16 a[20:23], a[120:123], v[192:195], a[20:23]
    ds_read_b64_tr_b16 a[158:159], v5 offset:47104
    v_mfma_f32_16x16x32_bf16 a[20:23], a[124:127], v[204:207], a[20:23]
    s_add_u32 s27, s24, 139520
    v_mfma_f32_16x16x32_bf16 a[172:175], a[160:163], v[252:255], a[172:175]
    s_add_u32 m0, s23, 100352
    v_mfma_f32_16x16x32_bf16 a[24:27], a[128:131], v[160:163], a[24:27]
    s_waitcnt lgkmcnt(6)
    v_mfma_f32_16x16x32_bf16 a[24:27], a[132:135], v[172:175], a[24:27]
    buffer_load_dwordx4 v1, s[12:15], s27 offen offset:0 nt lds
    v_mfma_f32_16x16x32_bf16 a[24:27], a[136:139], v[184:187], a[24:27]
    ds_read_b64_tr_b16 a[96:97], v2 offset:49152
    v_mfma_f32_16x16x32_bf16 a[24:27], a[140:143], v[196:199], a[24:27]
    ds_read_b64_tr_b16 a[98:99], v2 offset:51200
    v_mfma_f32_16x16x32_bf16 a[28:31], a[128:131], v[164:167], a[28:31]
    s_add_u32 s28, s24, 143616
    ds_read_b64_tr_b16 a[100:101], v2 offset:53248
    v_mfma_f32_16x16x32_bf16 a[28:31], a[132:135], v[176:179], a[28:31]
    s_add_u32 m0, s23, 101376
    ds_read_b64_tr_b16 a[102:103], v2 offset:55296
    v_mfma_f32_16x16x32_bf16 a[28:31], a[136:139], v[188:191], a[28:31]
    buffer_load_dwordx4 v1, s[12:15], s28 offen offset:0 nt lds
    ds_read_b64_tr_b16 a[104:105], v2 offset:57344
    v_mfma_f32_16x16x32_bf16 a[28:31], a[140:143], v[200:203], a[28:31]
    ds_read_b64_tr_b16 a[106:107], v2 offset:59392
    v_mfma_f32_16x16x32_bf16 a[32:35], a[128:131], v[168:171], a[32:35]
    ds_read_b64_tr_b16 a[108:109], v2 offset:61440
    v_accvgpr_read_b32 v53, a164
    v_mfma_f32_16x16x32_bf16 a[32:35], a[132:135], v[180:183], a[32:35]
    s_add_u32 s27, s24, 196864
    ds_read_b64_tr_b16 a[110:111], v2 offset:63488
    v_accvgpr_read_b32 v54, a168
    v_mfma_f32_16x16x32_bf16 a[32:35], a[136:139], v[192:195], a[32:35]
    s_add_u32 m0, s23, 114688
    v_accvgpr_read_b32 v55, a172
    v_add_f32 v53, v53, v14
    v_mfma_f32_16x16x32_bf16 a[32:35], a[140:143], v[204:207], a[32:35]
    s_waitcnt lgkmcnt(6)
    v_add_f32 v54, v54, v15
    v_add_f32 v55, v55, v48
    v_mfma_f32_16x16x32_bf16 a[36:39], a[144:147], v[160:163], a[36:39]
    buffer_load_dwordx4 v1, s[12:15], s27 offen offset:0 nt lds
    v_lshrrev_b32 v56, 4, v13
    v_mfma_f32_16x16x32_bf16 a[36:39], a[148:151], v[172:175], a[36:39]
    v_cmp_nle_f32 s[48:49], v53, s47
    v_cmp_nle_f32 s[50:51], v54, s47
    v_mfma_f32_16x16x32_bf16 a[36:39], a[152:155], v[184:187], a[36:39]
    ds_read_b64_tr_b16 a[112:113], v3 offset:49152
    v_cmp_nle_f32 s[52:53], v55, s47
    v_mfma_f32_16x16x32_bf16 a[36:39], a[156:159], v[196:199], a[36:39]
    s_add_u32 s28, s24, 200960
    ds_read_b64_tr_b16 a[114:115], v3 offset:51200
    v_and_b32 v57, 1, v56
    v_mfma_f32_16x16x32_bf16 a[40:43], a[144:147], v[164:167], a[40:43]
    s_add_u32 m0, s23, 115712
    ds_read_b64_tr_b16 a[116:117], v3 offset:53248
    v_add_u32 v2, 0xfffe8000, v2
    v_mfma_f32_16x16x32_bf16 a[40:43], a[148:151], v[176:179], a[40:43]
    buffer_load_dwordx4 v1, s[12:15], s28 offen offset:0 nt lds
    ds_read_b64_tr_b16 a[118:119], v3 offset:55296
    v_mfma_f32_16x16x32_bf16 a[40:43], a[152:155], v[188:191], a[40:43]
    ds_read_b64_tr_b16 a[120:121], v3 offset:57344
    v_lshrrev_b32 v58, 1, v56
    v_mfma_f32_16x16x32_bf16 a[40:43], a[156:159], v[200:203], a[40:43]
    ds_read_b64_tr_b16 a[122:123], v3 offset:59392
    v_lshl_add_u32 v57, v57, 1, v58
    v_mfma_f32_16x16x32_bf16 a[44:47], a[144:147], v[168:171], a[44:47]
    s_add_u32 s27, s24, 205056
    ds_read_b64_tr_b16 a[124:125], v3 offset:61440
    v_sub_u32 v57, v57, v56
    v_mfma_f32_16x16x32_bf16 a[44:47], a[148:151], v[180:183], a[44:47]
    s_add_u32 m0, s23, 116736
    ds_read_b64_tr_b16 a[126:127], v3 offset:63488
    v_lshl_add_u32 v6, v57, 4, v6
    v_mfma_f32_16x16x32_bf16 a[44:47], a[152:155], v[192:195], a[44:47]
    buffer_load_dwordx4 v1, s[12:15], s27 offen offset:0 nt lds
    v_mfma_f32_16x16x32_bf16 a[44:47], a[156:159], v[204:207], a[44:47]
    v_rcp_f32 v7, v53
    v_mfma_f32_16x16x32_bf16 a[0:3], a[96:99], v[208:211], a[0:3]
    s_waitcnt lgkmcnt(6)
    v_rcp_f32 v8, v54
    v_mfma_f32_16x16x32_bf16 a[0:3], a[100:103], v[220:223], a[0:3]
    s_add_u32 s28, s24, 209152
    v_rcp_f32 v9, v55
    v_mfma_f32_16x16x32_bf16 a[0:3], a[104:107], v[232:235], a[0:3]
    s_add_u32 m0, s23, 117760
    ds_read_b64_tr_b16 a[128:129], v4 offset:49152
    v_add_u32 v3, 0xfffe8000, v3
    v_mfma_f32_16x16x32_bf16 a[0:3], a[108:111], v[244:247], a[0:3]
    buffer_load_dwordx4 v1, s[12:15], s28 offen offset:0 nt lds
    ds_read_b64_tr_b16 a[130:131], v4 offset:51200
    v_mfma_f32_16x16x32_bf16 a[4:7], a[96:99], v[212:215], a[4:7]
    s_or_b64 s[48:49], s[48:49], s[50:51]
    ds_read_b64_tr_b16 a[132:133], v4 offset:53248
    v_mfma_f32_16x16x32_bf16 a[4:7], a[100:103], v[224:227], a[4:7]
    s_or_b64 s[48:49], s[48:49], s[52:53]
    ds_read_b64_tr_b16 a[134:135], v4 offset:55296
    v_mfma_f32_16x16x32_bf16 a[4:7], a[104:107], v[236:239], a[4:7]
    s_cmp_lg_u64 s[48:49], 0
    s_cselect_b32 s32, 1, 0
    ds_read_b64_tr_b16 a[136:137], v4 offset:57344
    v_mfma_f32_16x16x32_bf16 a[4:7], a[108:111], v[248:251], a[4:7]
    ds_read_b64_tr_b16 a[138:139], v4 offset:59392
    v_mfma_f32_16x16x32_bf16 a[8:11], a[96:99], v[216:219], a[8:11]
    ds_read_b64_tr_b16 a[140:141], v4 offset:61440
    v_mfma_f32_16x16x32_bf16 a[8:11], a[100:103], v[228:231], a[8:11]
    ds_read_b64_tr_b16 a[142:143], v4 offset:63488
    v_mfma_f32_16x16x32_bf16 a[8:11], a[104:107], v[240:243], a[8:11]
    v_mfma_f32_16x16x32_bf16 a[8:11], a[108:111], v[252:255], a[8:11]
    v_mfma_f32_16x16x32_bf16 a[12:15], a[112:115], v[208:211], a[12:15]
    s_waitcnt lgkmcnt(6)
    v_add_u32 v4, 0xfffe8000, v4
    v_mfma_f32_16x16x32_bf16 a[12:15], a[116:119], v[220:223], a[12:15]
    v_mfma_f32_16x16x32_bf16 a[12:15], a[120:123], v[232:235], a[12:15]
    ds_read_b64_tr_b16 a[144:145], v5 offset:49152
    v_mfma_f32_16x16x32_bf16 a[12:15], a[124:127], v[244:247], a[12:15]
    ds_read_b64_tr_b16 a[146:147], v5 offset:51200
    v_mfma_f32_16x16x32_bf16 a[16:19], a[112:115], v[212:215], a[16:19]
    ds_read_b64_tr_b16 a[148:149], v5 offset:53248
    v_mfma_f32_16x16x32_bf16 a[16:19], a[116:119], v[224:227], a[16:19]
    ds_read_b64_tr_b16 a[150:151], v5 offset:55296
    v_mfma_f32_16x16x32_bf16 a[16:19], a[120:123], v[236:239], a[16:19]
    ds_read_b64_tr_b16 a[152:153], v5 offset:57344
    v_mfma_f32_16x16x32_bf16 a[16:19], a[124:127], v[248:251], a[16:19]
    ds_read_b64_tr_b16 a[154:155], v5 offset:59392
    v_mfma_f32_16x16x32_bf16 a[20:23], a[112:115], v[216:219], a[20:23]
    ds_read_b64_tr_b16 a[156:157], v5 offset:61440
    v_mfma_f32_16x16x32_bf16 a[20:23], a[116:119], v[228:231], a[20:23]
    ds_read_b64_tr_b16 a[158:159], v5 offset:63488
    v_mfma_f32_16x16x32_bf16 a[20:23], a[120:123], v[240:243], a[20:23]
    v_mfma_f32_16x16x32_bf16 a[20:23], a[124:127], v[252:255], a[20:23]
    v_mfma_f32_16x16x32_bf16 a[24:27], a[128:131], v[208:211], a[24:27]
    s_waitcnt lgkmcnt(6)
    v_add_u32 v5, 0xfffe8000, v5
    v_mfma_f32_16x16x32_bf16 a[24:27], a[132:135], v[220:223], a[24:27]
    v_mfma_f32_16x16x32_bf16 a[24:27], a[136:139], v[232:235], a[24:27]
    ds_read_b64_tr_b16 a[96:97], v2 offset:0
    v_mfma_f32_16x16x32_bf16 a[24:27], a[140:143], v[244:247], a[24:27]
    ds_read_b64_tr_b16 a[98:99], v2 offset:2048
    v_mfma_f32_16x16x32_bf16 a[28:31], a[128:131], v[212:215], a[28:31]
    ds_read_b64_tr_b16 a[100:101], v2 offset:4096
    v_mfma_f32_16x16x32_bf16 a[28:31], a[132:135], v[224:227], a[28:31]
    ds_read_b64_tr_b16 a[102:103], v2 offset:6144
    v_mfma_f32_16x16x32_bf16 a[28:31], a[136:139], v[236:239], a[28:31]
    ds_read_b64_tr_b16 a[104:105], v2 offset:8192
    v_mfma_f32_16x16x32_bf16 a[28:31], a[140:143], v[248:251], a[28:31]
    ds_read_b64_tr_b16 a[106:107], v2 offset:10240
    v_mfma_f32_16x16x32_bf16 a[32:35], a[128:131], v[216:219], a[32:35]
    ds_read_b64_tr_b16 a[108:109], v2 offset:12288
    v_mfma_f32_16x16x32_bf16 a[32:35], a[132:135], v[228:231], a[32:35]
    ds_read_b64_tr_b16 a[110:111], v2 offset:14336
    v_mfma_f32_16x16x32_bf16 a[32:35], a[136:139], v[240:243], a[32:35]
    v_mfma_f32_16x16x32_bf16 a[32:35], a[140:143], v[252:255], a[32:35]
    v_mfma_f32_16x16x32_bf16 a[36:39], a[144:147], v[208:211], a[36:39]
    s_waitcnt lgkmcnt(6)
    v_mfma_f32_16x16x32_bf16 a[36:39], a[148:151], v[220:223], a[36:39]
    v_mfma_f32_16x16x32_bf16 a[36:39], a[152:155], v[232:235], a[36:39]
    ds_read_b64_tr_b16 a[112:113], v3 offset:0
    v_mfma_f32_16x16x32_bf16 a[36:39], a[156:159], v[244:247], a[36:39]
    ds_read_b64_tr_b16 a[114:115], v3 offset:2048
    v_mfma_f32_16x16x32_bf16 a[40:43], a[144:147], v[212:215], a[40:43]
    ds_read_b64_tr_b16 a[116:117], v3 offset:4096
    v_mfma_f32_16x16x32_bf16 a[40:43], a[148:151], v[224:227], a[40:43]
    s_waitcnt vmcnt(16)
    ds_read_b64_tr_b16 a[118:119], v3 offset:6144
    v_mfma_f32_16x16x32_bf16 a[40:43], a[152:155], v[236:239], a[40:43]
    s_barrier
    ds_read_b64_tr_b16 a[120:121], v3 offset:8192
    v_mfma_f32_16x16x32_bf16 a[40:43], a[156:159], v[248:251], a[40:43]
    s_add_u32 s27, s24, 384
    ds_read_b64_tr_b16 a[122:123], v3 offset:10240
    v_accvgpr_read_b32 v16, a0
    v_mfma_f32_16x16x32_bf16 a[44:47], a[144:147], v[216:219], a[44:47]
    s_add_u32 m0, s23, 131072
    ds_read_b64_tr_b16 a[124:125], v3 offset:12288
    v_accvgpr_read_b32 v17, a1
    v_mfma_f32_16x16x32_bf16 a[44:47], a[148:151], v[228:231], a[44:47]
    buffer_load_dwordx4 v1, s[12:15], s27 offen offset:0 nt lds
    ds_read_b64_tr_b16 a[126:127], v3 offset:14336
    v_mfma_f32_16x16x32_bf16 a[44:47], a[152:155], v[240:243], a[44:47]
    v_accvgpr_read_b32 v18, a2
    v_accvgpr_read_b32 v19, a3
    v_mfma_f32_16x16x32_bf16 a[44:47], a[156:159], v[252:255], a[44:47]
    s_add_u32 s28, s24, 4480
    v_accvgpr_read_b32 v20, a12
    v_accvgpr_read_b32 v21, a13
    v_mfma_f32_16x16x32_bf16 a[48:51], a[96:99], v[64:67], 0
    s_waitcnt lgkmcnt(6)
    v_accvgpr_read_b32 v22, a14
    v_accvgpr_read_b32 v23, a15
    v_mfma_f32_16x16x32_bf16 a[48:51], a[100:103], v[76:79], a[48:51]
    s_add_u32 m0, s23, 132096
    v_mul_f32 v16, v16, v7
    v_mul_f32 v17, v17, v7
    v_mfma_f32_16x16x32_bf16 a[48:51], a[104:107], v[88:91], a[48:51]
    buffer_load_dwordx4 v1, s[12:15], s28 offen offset:0 nt lds
    ds_read_b64_tr_b16 a[128:129], v4 offset:0
    v_mfma_f32_16x16x32_bf16 a[48:51], a[108:111], v[100:103], a[48:51]
    ds_read_b64_tr_b16 a[130:131], v4 offset:2048
    v_mul_f32 v18, v18, v7
    v_mfma_f32_16x16x32_bf16 a[52:55], a[96:99], v[68:71], 0
    ds_read_b64_tr_b16 a[132:133], v4 offset:4096
    v_mul_f32 v19, v19, v7
    v_mfma_f32_16x16x32_bf16 a[52:55], a[100:103], v[80:83], a[52:55]
    s_add_u32 s27, s24, 8576
    ds_read_b64_tr_b16 a[134:135], v4 offset:6144
    v_mul_f32 v20, v20, v7
    v_mfma_f32_16x16x32_bf16 a[52:55], a[104:107], v[92:95], a[52:55]
    s_add_u32 m0, s23, 133120
    ds_read_b64_tr_b16 a[136:137], v4 offset:8192
    v_mul_f32 v21, v21, v7
    v_mfma_f32_16x16x32_bf16 a[52:55], a[108:111], v[104:107], a[52:55]
    buffer_load_dwordx4 v1, s[12:15], s27 offen offset:0 nt lds
    ds_read_b64_tr_b16 a[138:139], v4 offset:10240
    v_mfma_f32_16x16x32_bf16 a[56:59], a[96:99], v[72:75], 0
    ds_read_b64_tr_b16 a[140:141], v4 offset:12288
    v_mul_f32 v22, v22, v7
    v_mfma_f32_16x16x32_bf16 a[56:59], a[100:103], v[84:87], a[56:59]
    s_add_u32 s28, s24, 12672
    ds_read_b64_tr_b16 a[142:143], v4 offset:14336
    v_mul_f32 v23, v23, v7
    v_mfma_f32_16x16x32_bf16 a[56:59], a[104:107], v[96:99], a[56:59]
    s_add_u32 m0, s23, 134144
    v_cvt_pk_bf16_f32 v24, v16, v17
    v_cvt_pk_bf16_f32 v25, v18, v19
    v_mfma_f32_16x16x32_bf16 a[56:59], a[108:111], v[108:111], a[56:59]
    s_waitcnt lgkmcnt(6)
    v_cvt_pk_bf16_f32 v26, v20, v21
    v_cvt_pk_bf16_f32 v27, v22, v23
    v_mfma_f32_16x16x32_bf16 a[60:63], a[112:115], v[64:67], 0
    buffer_load_dwordx4 v1, s[12:15], s28 offen offset:0 nt lds
    v_accvgpr_read_b32 v16, a24
    v_mfma_f32_16x16x32_bf16 a[60:63], a[116:119], v[76:79], a[60:63]
    v_permlane16_swap_b32 v24, v26
    v_mfma_f32_16x16x32_bf16 a[60:63], a[120:123], v[88:91], a[60:63]
    ds_read_b64_tr_b16 a[144:145], v5 offset:0
    v_accvgpr_read_b32 v17, a25
    v_mfma_f32_16x16x32_bf16 a[60:63], a[124:127], v[100:103], a[60:63]
    ds_read_b64_tr_b16 a[146:147], v5 offset:2048
    v_accvgpr_read_b32 v18, a26
    v_mfma_f32_16x16x32_bf16 a[64:67], a[112:115], v[68:71], 0
    s_add_u32 s27, s24, 65920
    ds_read_b64_tr_b16 a[148:149], v5 offset:4096
    v_accvgpr_read_b32 v19, a27
    v_mfma_f32_16x16x32_bf16 a[64:67], a[116:119], v[80:83], a[64:67]
    s_add_u32 m0, s23, 147456
    ds_read_b64_tr_b16 a[150:151], v5 offset:6144
    v_accvgpr_read_b32 v20, a36
    v_mfma_f32_16x16x32_bf16 a[64:67], a[120:123], v[92:95], a[64:67]
    buffer_load_dwordx4 v1, s[12:15], s27 offen offset:0 nt lds
    ds_read_b64_tr_b16 a[152:153], v5 offset:8192
    v_mfma_f32_16x16x32_bf16 a[64:67], a[124:127], v[104:107], a[64:67]
    ds_read_b64_tr_b16 a[154:155], v5 offset:10240
    v_accvgpr_read_b32 v21, a37
    v_mfma_f32_16x16x32_bf16 a[68:71], a[112:115], v[72:75], 0
    ds_read_b64_tr_b16 a[156:157], v5 offset:12288
    v_accvgpr_read_b32 v22, a38
    v_mfma_f32_16x16x32_bf16 a[68:71], a[116:119], v[84:87], a[68:71]
    s_add_u32 s28, s24, 70016
    ds_read_b64_tr_b16 a[158:159], v5 offset:14336
    v_accvgpr_read_b32 v23, a39
    v_mfma_f32_16x16x32_bf16 a[68:71], a[120:123], v[96:99], a[68:71]
    s_add_u32 m0, s23, 148480
    v_permlane16_swap_b32 v25, v27
    v_mfma_f32_16x16x32_bf16 a[68:71], a[124:127], v[108:111], a[68:71]
    buffer_load_dwordx4 v1, s[12:15], s28 offen offset:0 nt lds
    v_mul_f32 v16, v16, v7
    v_mfma_f32_16x16x32_bf16 a[72:75], a[128:131], v[64:67], 0
    s_waitcnt lgkmcnt(6)
    v_mul_f32 v17, v17, v7
    v_mul_f32 v18, v18, v7
    v_mfma_f32_16x16x32_bf16 a[72:75], a[132:135], v[76:79], a[72:75]
    v_mul_f32 v19, v19, v7
    v_mul_f32 v20, v20, v7
    v_mfma_f32_16x16x32_bf16 a[72:75], a[136:139], v[88:91], a[72:75]
    s_add_u32 s27, s24, 74112
    ds_read_b64_tr_b16 a[96:97], v2 offset:16384
    v_mul_f32 v21, v21, v7
    v_mfma_f32_16x16x32_bf16 a[72:75], a[140:143], v[100:103], a[72:75]
    s_add_u32 m0, s23, 149504
    ds_read_b64_tr_b16 a[98:99], v2 offset:18432
    v_mul_f32 v22, v22, v7
    v_mfma_f32_16x16x32_bf16 a[76:79], a[128:131], v[68:71], 0
    buffer_load_dwordx4 v1, s[12:15], s27 offen offset:0 nt lds
    ds_read_b64_tr_b16 a[100:101], v2 offset:20480
    v_mfma_f32_16x16x32_bf16 a[76:79], a[132:135], v[80:83], a[76:79]
    ds_read_b64_tr_b16 a[102:103], v2 offset:22528
    v_mul_f32 v23, v23, v7
    v_mfma_f32_16x16x32_bf16 a[76:79], a[136:139], v[92:95], a[76:79]
    ds_read_b64_tr_b16 a[104:105], v2 offset:24576
    v_cvt_pk_bf16_f32 v28, v16, v17
    v_mfma_f32_16x16x32_bf16 a[76:79], a[140:143], v[104:107], a[76:79]
    s_add_u32 s28, s24, 78208
    ds_read_b64_tr_b16 a[106:107], v2 offset:26624
    v_cvt_pk_bf16_f32 v29, v18, v19
    v_mfma_f32_16x16x32_bf16 a[80:83], a[128:131], v[72:75], 0
    s_add_u32 m0, s23, 150528
    ds_read_b64_tr_b16 a[108:109], v2 offset:28672
    v_cvt_pk_bf16_f32 v30, v20, v21
    v_mfma_f32_16x16x32_bf16 a[80:83], a[132:135], v[84:87], a[80:83]
    buffer_load_dwordx4 v1, s[12:15], s28 offen offset:0 nt lds
    ds_read_b64_tr_b16 a[110:111], v2 offset:30720
    v_mfma_f32_16x16x32_bf16 a[80:83], a[136:139], v[96:99], a[80:83]
    v_permlane16_swap_b32 v28, v30
    v_mfma_f32_16x16x32_bf16 a[80:83], a[140:143], v[108:111], a[80:83]
    v_cvt_pk_bf16_f32 v31, v22, v23
    v_mfma_f32_16x16x32_bf16 a[84:87], a[144:147], v[64:67], 0
    s_waitcnt lgkmcnt(6)
    v_mfma_f32_16x16x32_bf16 a[84:87], a[148:151], v[76:79], a[84:87]
    v_permlane16_swap_b32 v29, v31
    v_mfma_f32_16x16x32_bf16 a[84:87], a[152:155], v[88:91], a[84:87]
    ds_read_b64_tr_b16 a[112:113], v3 offset:16384
    s_mov_b64 vcc, s[86:87]
    v_mfma_f32_16x16x32_bf16 a[84:87], a[156:159], v[100:103], a[84:87]
    ds_read_b64_tr_b16 a[114:115], v3 offset:18432
    v_cndmask_b32_dpp v32, v28, v24, vcc row_ror:8 row_mask:0xf bank_mask:0xf
    v_mfma_f32_16x16x32_bf16 a[88:91], a[144:147], v[68:71], 0
    ds_read_b64_tr_b16 a[116:117], v3 offset:20480
    v_cndmask_b32_dpp v33, v29, v25, vcc row_ror:8 row_mask:0xf bank_mask:0xf
    v_mfma_f32_16x16x32_bf16 a[88:91], a[148:151], v[80:83], a[88:91]
    ds_read_b64_tr_b16 a[118:119], v3 offset:22528
    v_cndmask_b32_dpp v34, v30, v26, vcc row_ror:8 row_mask:0xf bank_mask:0xf
    v_mfma_f32_16x16x32_bf16 a[88:91], a[152:155], v[92:95], a[88:91]
    ds_read_b64_tr_b16 a[120:121], v3 offset:24576
    v_cndmask_b32_dpp v35, v31, v27, vcc row_ror:8 row_mask:0xf bank_mask:0xf
    v_mfma_f32_16x16x32_bf16 a[88:91], a[156:159], v[104:107], a[88:91]
    ds_read_b64_tr_b16 a[122:123], v3 offset:26624
    s_not_b64 vcc, vcc
    v_mfma_f32_16x16x32_bf16 a[92:95], a[144:147], v[72:75], 0
    ds_read_b64_tr_b16 a[124:125], v3 offset:28672
    v_cndmask_b32_dpp v28, v24, v28, vcc row_ror:8 row_mask:0xf bank_mask:0xf
    v_mfma_f32_16x16x32_bf16 a[92:95], a[148:151], v[84:87], a[92:95]
    ds_read_b64_tr_b16 a[126:127], v3 offset:30720
    v_cndmask_b32_dpp v29, v25, v29, vcc row_ror:8 row_mask:0xf bank_mask:0xf
    v_mfma_f32_16x16x32_bf16 a[92:95], a[152:155], v[96:99], a[92:95]
    v_cndmask_b32_dpp v30, v26, v30, vcc row_ror:8 row_mask:0xf bank_mask:0xf
    v_cndmask_b32_dpp v31, v27, v31, vcc row_ror:8 row_mask:0xf bank_mask:0xf
    v_mfma_f32_16x16x32_bf16 a[92:95], a[156:159], v[108:111], a[92:95]
    v_accvgpr_write_b32 a176, v32
    v_accvgpr_write_b32 a177, v33
    v_mfma_f32_16x16x32_bf16 a[48:51], a[96:99], v[112:115], a[48:51]
    s_waitcnt lgkmcnt(6)
    v_accvgpr_write_b32 a178, v34
    v_accvgpr_write_b32 a179, v35
    v_mfma_f32_16x16x32_bf16 a[48:51], a[100:103], v[124:127], a[48:51]
    v_accvgpr_write_b32 a180, v28
    v_accvgpr_write_b32 a181, v29
    v_mfma_f32_16x16x32_bf16 a[48:51], a[104:107], v[136:139], a[48:51]
    ds_read_b64_tr_b16 a[128:129], v4 offset:16384
    v_accvgpr_write_b32 a182, v30
    v_mfma_f32_16x16x32_bf16 a[48:51], a[108:111], v[148:151], a[48:51]
    ds_read_b64_tr_b16 a[130:131], v4 offset:18432
    v_accvgpr_write_b32 a183, v31
    v_mfma_f32_16x16x32_bf16 a[52:55], a[96:99], v[116:119], a[52:55]
    ds_read_b64_tr_b16 a[132:133], v4 offset:20480
    v_mfma_f32_16x16x32_bf16 a[52:55], a[100:103], v[128:131], a[52:55]
    ds_read_b64_tr_b16 a[134:135], v4 offset:22528
    v_mfma_f32_16x16x32_bf16 a[52:55], a[104:107], v[140:143], a[52:55]
    ds_read_b64_tr_b16 a[136:137], v4 offset:24576
    v_mfma_f32_16x16x32_bf16 a[52:55], a[108:111], v[152:155], a[52:55]
    ds_read_b64_tr_b16 a[138:139], v4 offset:26624
    v_mfma_f32_16x16x32_bf16 a[56:59], a[96:99], v[120:123], a[56:59]
    ds_read_b64_tr_b16 a[140:141], v4 offset:28672
    v_accvgpr_read_b32 v16, a4
    v_mfma_f32_16x16x32_bf16 a[56:59], a[100:103], v[132:135], a[56:59]
    ds_read_b64_tr_b16 a[142:143], v4 offset:30720
    v_accvgpr_read_b32 v17, a5
    v_mfma_f32_16x16x32_bf16 a[56:59], a[104:107], v[144:147], a[56:59]
    v_accvgpr_read_b32 v18, a6
    v_accvgpr_read_b32 v19, a7
    v_mfma_f32_16x16x32_bf16 a[56:59], a[108:111], v[156:159], a[56:59]
    v_accvgpr_read_b32 v20, a16
    v_accvgpr_read_b32 v21, a17
    v_mfma_f32_16x16x32_bf16 a[60:63], a[112:115], v[112:115], a[60:63]
    s_waitcnt lgkmcnt(6)
    v_accvgpr_read_b32 v22, a18
    v_accvgpr_read_b32 v23, a19
    v_mfma_f32_16x16x32_bf16 a[60:63], a[116:119], v[124:127], a[60:63]
    v_mul_f32 v16, v16, v8
    v_mul_f32 v17, v17, v8
    v_mfma_f32_16x16x32_bf16 a[60:63], a[120:123], v[136:139], a[60:63]
    ds_read_b64_tr_b16 a[144:145], v5 offset:16384
    v_mul_f32 v18, v18, v8
    v_mfma_f32_16x16x32_bf16 a[60:63], a[124:127], v[148:151], a[60:63]
    ds_read_b64_tr_b16 a[146:147], v5 offset:18432
    v_mul_f32 v19, v19, v8
    v_mfma_f32_16x16x32_bf16 a[64:67], a[112:115], v[116:119], a[64:67]
    ds_read_b64_tr_b16 a[148:149], v5 offset:20480
    v_mul_f32 v20, v20, v8
    v_mfma_f32_16x16x32_bf16 a[64:67], a[116:119], v[128:131], a[64:67]
    ds_read_b64_tr_b16 a[150:151], v5 offset:22528
    v_mul_f32 v21, v21, v8
    v_mfma_f32_16x16x32_bf16 a[64:67], a[120:123], v[140:143], a[64:67]
    ds_read_b64_tr_b16 a[152:153], v5 offset:24576
    v_mul_f32 v22, v22, v8
    v_mfma_f32_16x16x32_bf16 a[64:67], a[124:127], v[152:155], a[64:67]
    ds_read_b64_tr_b16 a[154:155], v5 offset:26624
    v_mul_f32 v23, v23, v8
    v_mfma_f32_16x16x32_bf16 a[68:71], a[112:115], v[120:123], a[68:71]
    ds_read_b64_tr_b16 a[156:157], v5 offset:28672
    v_cvt_pk_bf16_f32 v24, v16, v17
    v_mfma_f32_16x16x32_bf16 a[68:71], a[116:119], v[132:135], a[68:71]
    ds_read_b64_tr_b16 a[158:159], v5 offset:30720
    v_cvt_pk_bf16_f32 v25, v18, v19
    v_mfma_f32_16x16x32_bf16 a[68:71], a[120:123], v[144:147], a[68:71]
L_pg5:
    s_cbranch_execz L_back
    v_cvt_pk_bf16_f32 v26, v20, v21
    v_cvt_pk_bf16_f32 v27, v22, v23
    v_mfma_f32_16x16x32_bf16 a[68:71], a[124:127], v[156:159], a[68:71]
    v_accvgpr_read_b32 v16, a28
    v_accvgpr_read_b32 v17, a29
    v_mfma_f32_16x16x32_bf16 a[72:75], a[128:131], v[112:115], a[72:75]
    s_waitcnt lgkmcnt(6)
    v_permlane16_swap_b32 v24, v26
    v_mfma_f32_16x16x32_bf16 a[72:75], a[132:135], v[124:127], a[72:75]
    v_permlane16_swap_b32 v25, v27
    v_mfma_f32_16x16x32_bf16 a[72:75], a[136:139], v[136:139], a[72:75]
    ds_read_b64_tr_b16 a[96:97], v2 offset:32768
    v_accvgpr_read_b32 v18, a30
    v_mfma_f32_16x16x32_bf16 a[72:75], a[140:143], v[148:151], a[72:75]
    ds_read_b64_tr_b16 a[98:99], v2 offset:34816
    v_accvgpr_read_b32 v19, a31
    v_mfma_f32_16x16x32_bf16 a[76:79], a[128:131], v[116:119], a[76:79]
    ds_read_b64_tr_b16 a[100:101], v2 offset:36864
    v_accvgpr_read_b32 v20, a40
    v_mfma_f32_16x16x32_bf16 a[76:79], a[132:135], v[128:131], a[76:79]
    ds_read_b64_tr_b16 a[102:103], v2 offset:38912
    v_accvgpr_read_b32 v21, a41
    v_mfma_f32_16x16x32_bf16 a[76:79], a[136:139], v[140:143], a[76:79]
    ds_read_b64_tr_b16 a[104:105], v2 offset:40960
    v_accvgpr_read_b32 v22, a42
    v_mfma_f32_16x16x32_bf16 a[76:79], a[140:143], v[152:155], a[76:79]
    ds_read_b64_tr_b16 a[106:107], v2 offset:43008
    v_accvgpr_read_b32 v23, a43
    v_mfma_f32_16x16x32_bf16 a[80:83], a[128:131], v[120:123], a[80:83]
    ds_read_b64_tr_b16 a[108:109], v2 offset:45056
    v_mul_f32 v16, v16, v8
    v_mfma_f32_16x16x32_bf16 a[80:83], a[132:135], v[132:135], a[80:83]
    ds_read_b64_tr_b16 a[110:111], v2 offset:47104
    v_mul_f32 v17, v17, v8
    v_mfma_f32_16x16x32_bf16 a[80:83], a[136:139], v[144:147], a[80:83]
    v_mul_f32 v18, v18, v8
    v_mul_f32 v19, v19, v8
    v_mfma_f32_16x16x32_bf16 a[80:83], a[140:143], v[156:159], a[80:83]
    v_mul_f32 v20, v20, v8
    v_mul_f32 v21, v21, v8
    v_mfma_f32_16x16x32_bf16 a[84:87], a[144:147], v[112:115], a[84:87]
    s_waitcnt lgkmcnt(6)
    v_mul_f32 v22, v22, v8
    v_mul_f32 v23, v23, v8
    v_mfma_f32_16x16x32_bf16 a[84:87], a[148:151], v[124:127], a[84:87]
    v_cvt_pk_bf16_f32 v28, v16, v17
    v_cvt_pk_bf16_f32 v29, v18, v19
    v_mfma_f32_16x16x32_bf16 a[84:87], a[152:155], v[136:139], a[84:87]
    ds_read_b64_tr_b16 a[112:113], v3 offset:32768
    v_cvt_pk_bf16_f32 v30, v20, v21
    v_mfma_f32_16x16x32_bf16 a[84:87], a[156:159], v[148:151], a[84:87]
    ds_read_b64_tr_b16 a[114:115], v3 offset:34816
    v_cvt_pk_bf16_f32 v31, v22, v23
    v_mfma_f32_16x16x32_bf16 a[88:91], a[144:147], v[116:119], a[88:91]
    v_permlane16_swap_b32 v28, v30
    v_mfma_f32_16x16x32_bf16 a[88:91], a[148:151], v[128:131], a[88:91]
    s_waitcnt vmcnt(16)
    ds_read_b64_tr_b16 a[116:117], v3 offset:36864
    ds_read_b64_tr_b16 a[118:119], v3 offset:38912
    v_mfma_f32_16x16x32_bf16 a[88:91], a[152:155], v[140:143], a[88:91]
    s_barrier
    v_permlane16_swap_b32 v29, v31
    v_mfma_f32_16x16x32_bf16 a[88:91], a[156:159], v[152:155], a[88:91]
    s_add_u32 s27, s24, 131456
    ds_read_b64_tr_b16 a[120:121], v3 offset:40960
    ds_read_b64_tr_b16 a[122:123], v3 offset:43008
    v_mfma_f32_16x16x32_bf16 a[92:95], a[144:147], v[120:123], a[92:95]
    s_add_u32 m0, s23, 0
    ds_read_b64_tr_b16 a[124:125], v3 offset:45056
    s_mov_b64 vcc, s[86:87]
    v_mfma_f32_16x16x32_bf16 a[92:95], a[148:151], v[132:135], a[92:95]
    buffer_load_dwordx4 v1, s[12:15], s27 offen offset:0 nt lds
    ds_read_b64_tr_b16 a[126:127], v3 offset:47104
    v_mfma_f32_16x16x32_bf16 a[92:95], a[152:155], v[144:147], a[92:95]
    v_cndmask_b32_dpp v32, v28, v24, vcc row_ror:8 row_mask:0xf bank_mask:0xf
    v_cndmask_b32_dpp v33, v29, v25, vcc row_ror:8 row_mask:0xf bank_mask:0xf
    v_mfma_f32_16x16x32_bf16 a[92:95], a[156:159], v[156:159], a[92:95]
    s_add_u32 s28, s24, 135552
    v_cndmask_b32_dpp v34, v30, v26, vcc row_ror:8 row_mask:0xf bank_mask:0xf
    v_cndmask_b32_dpp v35, v31, v27, vcc row_ror:8 row_mask:0xf bank_mask:0xf
    v_mfma_f32_16x16x32_bf16 a[48:51], a[96:99], v[160:163], a[48:51]
    s_waitcnt lgkmcnt(6)
    s_not_b64 vcc, vcc
    v_accvgpr_write_b32 a184, v32
    v_mfma_f32_16x16x32_bf16 a[48:51], a[100:103], v[172:175], a[48:51]
    s_add_u32 m0, s23, 1024
    v_cndmask_b32_dpp v28, v24, v28, vcc row_ror:8 row_mask:0xf bank_mask:0xf
    v_cndmask_b32_dpp v29, v25, v29, vcc row_ror:8 row_mask:0xf bank_mask:0xf
    v_mfma_f32_16x16x32_bf16 a[48:51], a[104:107], v[184:187], a[48:51]
    buffer_load_dwordx4 v1, s[12:15], s28 offen offset:0 nt lds
    ds_read_b64_tr_b16 a[128:129], v4 offset:32768
    v_mfma_f32_16x16x32_bf16 a[48:51], a[108:111], v[196:199], a[48:51]
    ds_read_b64_tr_b16 a[130:131], v4 offset:34816
    v_cndmask_b32_dpp v30, v26, v30, vcc row_ror:8 row_mask:0xf bank_mask:0xf
    v_mfma_f32_16x16x32_bf16 a[52:55], a[96:99], v[164:167], a[52:55]
    ds_read_b64_tr_b16 a[132:133], v4 offset:36864
    v_cndmask_b32_dpp v31, v27, v31, vcc row_ror:8 row_mask:0xf bank_mask:0xf
    v_mfma_f32_16x16x32_bf16 a[52:55], a[100:103], v[176:179], a[52:55]
    s_add_u32 s27, s24, 139648
    ds_read_b64_tr_b16 a[134:135], v4 offset:38912
    v_accvgpr_write_b32 a185, v33
    v_mfma_f32_16x16x32_bf16 a[52:55], a[104:107], v[188:191], a[52:55]
    s_add_u32 m0, s23, 2048
    ds_read_b64_tr_b16 a[136:137], v4 offset:40960
    v_accvgpr_write_b32 a186, v34
    v_mfma_f32_16x16x32_bf16 a[52:55], a[108:111], v[200:203], a[52:55]
    buffer_load_dwordx4 v1, s[12:15], s27 offen offset:0 nt lds
    ds_read_b64_tr_b16 a[138:139], v4 offset:43008
    v_mfma_f32_16x16x32_bf16 a[56:59], a[96:99], v[168:171], a[56:59]
    ds_read_b64_tr_b16 a[140:141], v4 offset:45056
    v_accvgpr_write_b32 a187, v35
    v_mfma_f32_16x16x32_bf16 a[56:59], a[100:103], v[180:183], a[56:59]
    s_add_u32 s28, s24, 143744
    ds_read_b64_tr_b16 a[142:143], v4 offset:47104
    v_accvgpr_write_b32 a188, v28
    v_mfma_f32_16x16x32_bf16 a[56:59], a[104:107], v[192:195], a[56:59]
    s_add_u32 m0, s23, 3072
    v_accvgpr_write_b32 a189, v29
    v_accvgpr_write_b32 a190, v30
    v_mfma_f32_16x16x32_bf16 a[56:59], a[108:111], v[204:207], a[56:59]
    s_waitcnt lgkmcnt(6)
    v_accvgpr_write_b32 a191, v31
    v_mfma_f32_16x16x32_bf16 a[60:63], a[112:115], v[160:163], a[60:63]
    buffer_load_dwordx4 v1, s[12:15], s28 offen offset:0 nt lds
    v_mfma_f32_16x16x32_bf16 a[60:63], a[116:119], v[172:175], a[60:63]
    v_mfma_f32_16x16x32_bf16 a[60:63], a[120:123], v[184:187], a[60:63]
    ds_read_b64_tr_b16 a[144:145], v5 offset:32768
    v_mfma_f32_16x16x32_bf16 a[60:63], a[124:127], v[196:199], a[60:63]
    ds_read_b64_tr_b16 a[146:147], v5 offset:34816
    v_mfma_f32_16x16x32_bf16 a[64:67], a[112:115], v[164:167], a[64:67]
    s_add_u32 s27, s24, 196992
    ds_read_b64_tr_b16 a[148:149], v5 offset:36864
    v_mfma_f32_16x16x32_bf16 a[64:67], a[116:119], v[176:179], a[64:67]
    s_add_u32 m0, s23, 16384
    ds_read_b64_tr_b16 a[150:151], v5 offset:38912
    v_mfma_f32_16x16x32_bf16 a[64:67], a[120:123], v[188:191], a[64:67]
    buffer_load_dwordx4 v1, s[12:15], s27 offen offset:0 nt lds
    ds_read_b64_tr_b16 a[152:153], v5 offset:40960
    v_mfma_f32_16x16x32_bf16 a[64:67], a[124:127], v[200:203], a[64:67]
    ds_read_b64_tr_b16 a[154:155], v5 offset:43008
    v_mfma_f32_16x16x32_bf16 a[68:71], a[112:115], v[168:171], a[68:71]
    ds_read_b64_tr_b16 a[156:157], v5 offset:45056
    v_mfma_f32_16x16x32_bf16 a[68:71], a[116:119], v[180:183], a[68:71]
    s_add_u32 s28, s24, 201088
    ds_read_b64_tr_b16 a[158:159], v5 offset:47104
    v_mfma_f32_16x16x32_bf16 a[68:71], a[120:123], v[192:195], a[68:71]
    s_add_u32 m0, s23, 17408
    v_mfma_f32_16x16x32_bf16 a[68:71], a[124:127], v[204:207], a[68:71]
    buffer_load_dwordx4 v1, s[12:15], s28 offen offset:0 nt lds
    v_mfma_f32_16x16x32_bf16 a[72:75], a[128:131], v[160:163], a[72:75]
    s_waitcnt lgkmcnt(6)
    v_accvgpr_read_b32 v16, a8
    v_accvgpr_read_b32 v17, a9
    v_mfma_f32_16x16x32_bf16 a[72:75], a[132:135], v[172:175], a[72:75]
    v_accvgpr_read_b32 v18, a10
    v_accvgpr_read_b32 v19, a11
    v_mfma_f32_16x16x32_bf16 a[72:75], a[136:139], v[184:187], a[72:75]
    s_add_u32 s27, s24, 205184
    ds_read_b64_tr_b16 a[96:97], v2 offset:49152
    v_accvgpr_read_b32 v20, a20
    v_mfma_f32_16x16x32_bf16 a[72:75], a[140:143], v[196:199], a[72:75]
    s_add_u32 m0, s23, 18432
    ds_read_b64_tr_b16 a[98:99], v2 offset:51200
    v_accvgpr_read_b32 v21, a21
    v_mfma_f32_16x16x32_bf16 a[76:79], a[128:131], v[164:167], a[76:79]
    buffer_load_dwordx4 v1, s[12:15], s27 offen offset:0 nt lds
    ds_read_b64_tr_b16 a[100:101], v2 offset:53248
    v_mfma_f32_16x16x32_bf16 a[76:79], a[132:135], v[176:179], a[76:79]
    ds_read_b64_tr_b16 a[102:103], v2 offset:55296
    v_accvgpr_read_b32 v22, a22
    v_mfma_f32_16x16x32_bf16 a[76:79], a[136:139], v[188:191], a[76:79]
    ds_read_b64_tr_b16 a[104:105], v2 offset:57344
    v_accvgpr_read_b32 v23, a23
    v_mfma_f32_16x16x32_bf16 a[76:79], a[140:143], v[200:203], a[76:79]
    s_add_u32 s28, s24, 209280
    ds_read_b64_tr_b16 a[106:107], v2 offset:59392
    v_mul_f32 v16, v16, v9
    v_mfma_f32_16x16x32_bf16 a[80:83], a[128:131], v[168:171], a[80:83]
    s_add_u32 m0, s23, 19456
    ds_read_b64_tr_b16 a[108:109], v2 offset:61440
    v_mul_f32 v17, v17, v9
    v_mfma_f32_16x16x32_bf16 a[80:83], a[132:135], v[180:183], a[80:83]
    buffer_load_dwordx4 v1, s[12:15], s28 offen offset:0 nt lds
    ds_read_b64_tr_b16 a[110:111], v2 offset:63488
    v_mfma_f32_16x16x32_bf16 a[80:83], a[136:139], v[192:195], a[80:83]
    v_mul_f32 v18, v18, v9
    v_mul_f32 v19, v19, v9
    v_mfma_f32_16x16x32_bf16 a[80:83], a[140:143], v[204:207], a[80:83]
    v_mul_f32 v20, v20, v9
    v_mul_f32 v21, v21, v9
    v_mfma_f32_16x16x32_bf16 a[84:87], a[144:147], v[160:163], a[84:87]
    s_waitcnt lgkmcnt(6)
    v_mul_f32 v22, v22, v9
    v_mul_f32 v23, v23, v9
    v_mfma_f32_16x16x32_bf16 a[84:87], a[148:151], v[172:175], a[84:87]
    v_cvt_pk_bf16_f32 v24, v16, v17
    v_cvt_pk_bf16_f32 v25, v18, v19
    v_mfma_f32_16x16x32_bf16 a[84:87], a[152:155], v[184:187], a[84:87]
    ds_read_b64_tr_b16 a[112:113], v3 offset:49152
    v_cvt_pk_bf16_f32 v26, v20, v21
    v_mfma_f32_16x16x32_bf16 a[84:87], a[156:159], v[196:199], a[84:87]
    ds_read_b64_tr_b16 a[114:115], v3 offset:51200
    v_cvt_pk_bf16_f32 v27, v22, v23
    v_mfma_f32_16x16x32_bf16 a[88:91], a[144:147], v[164:167], a[88:91]
    ds_read_b64_tr_b16 a[116:117], v3 offset:53248
    v_add_u32 v2, 0x10000, v2
    v_mfma_f32_16x16x32_bf16 a[88:91], a[148:151], v[176:179], a[88:91]
    ds_read_b64_tr_b16 a[118:119], v3 offset:55296
    v_accvgpr_read_b32 v16, a32
    v_mfma_f32_16x16x32_bf16 a[88:91], a[152:155], v[188:191], a[88:91]
    ds_read_b64_tr_b16 a[120:121], v3 offset:57344
    v_accvgpr_read_b32 v17, a33
    v_mfma_f32_16x16x32_bf16 a[88:91], a[156:159], v[200:203], a[88:91]
    ds_read_b64_tr_b16 a[122:123], v3 offset:59392
    v_accvgpr_read_b32 v18, a34
    v_mfma_f32_16x16x32_bf16 a[92:95], a[144:147], v[168:171], a[92:95]
    ds_read_b64_tr_b16 a[124:125], v3 offset:61440
    v_accvgpr_read_b32 v19, a35
    v_mfma_f32_16x16x32_bf16 a[92:95], a[148:151], v[180:183], a[92:95]
    ds_read_b64_tr_b16 a[126:127], v3 offset:63488
    v_accvgpr_read_b32 v20, a44
    v_mfma_f32_16x16x32_bf16 a[92:95], a[152:155], v[192:195], a[92:95]
    v_permlane16_swap_b32 v24, v26
    v_mfma_f32_16x16x32_bf16 a[92:95], a[156:159], v[204:207], a[92:95]
    v_permlane16_swap_b32 v25, v27
    v_mfma_f32_16x16x32_bf16 a[48:51], a[96:99], v[208:211], a[48:51]
    s_waitcnt lgkmcnt(6)
    v_accvgpr_read_b32 v21, a45
    v_accvgpr_read_b32 v22, a46
    v_mfma_f32_16x16x32_bf16 a[48:51], a[100:103], v[220:223], a[48:51]
    v_accvgpr_read_b32 v23, a47
    v_mul_f32 v16, v16, v9
    v_mfma_f32_16x16x32_bf16 a[48:51], a[104:107], v[232:235], a[48:51]
    ds_read_b64_tr_b16 a[128:129], v4 offset:49152
    v_mul_f32 v17, v17, v9
    v_mfma_f32_16x16x32_bf16 a[48:51], a[108:111], v[244:247], a[48:51]
    ds_read_b64_tr_b16 a[130:131], v4 offset:51200
    v_mul_f32 v18, v18, v9
    v_mfma_f32_16x16x32_bf16 a[52:55], a[96:99], v[212:215], a[52:55]
    ds_read_b64_tr_b16 a[132:133], v4 offset:53248
    v_mul_f32 v19, v19, v9
    v_mfma_f32_16x16x32_bf16 a[52:55], a[100:103], v[224:227], a[52:55]
    ds_read_b64_tr_b16 a[134:135], v4 offset:55296
    v_mul_f32 v20, v20, v9
    v_mfma_f32_16x16x32_bf16 a[52:55], a[104:107], v[236:239], a[52:55]
    ds_read_b64_tr_b16 a[136:137], v4 offset:57344
    v_mul_f32 v21, v21, v9
    v_mfma_f32_16x16x32_bf16 a[52:55], a[108:111], v[248:251], a[52:55]
    ds_read_b64_tr_b16 a[138:139], v4 offset:59392
    v_mul_f32 v22, v22, v9
    v_mfma_f32_16x16x32_bf16 a[56:59], a[96:99], v[216:219], a[56:59]
    ds_read_b64_tr_b16 a[140:141], v4 offset:61440
    v_mul_f32 v23, v23, v9
    v_mfma_f32_16x16x32_bf16 a[56:59], a[100:103], v[228:231], a[56:59]
    ds_read_b64_tr_b16 a[142:143], v4 offset:63488
    v_cvt_pk_bf16_f32 v28, v16, v17
    v_mfma_f32_16x16x32_bf16 a[56:59], a[104:107], v[240:243], a[56:59]
    v_cvt_pk_bf16_f32 v29, v18, v19
    v_cvt_pk_bf16_f32 v30, v20, v21
    v_mfma_f32_16x16x32_bf16 a[56:59], a[108:111], v[252:255], a[56:59]
    v_cvt_pk_bf16_f32 v31, v22, v23
    v_add_u32 v3, 0x10000, v3
    v_mfma_f32_16x16x32_bf16 a[60:63], a[112:115], v[208:211], a[60:63]
    s_waitcnt lgkmcnt(6)
    v_permlane16_swap_b32 v28, v30
    v_mfma_f32_16x16x32_bf16 a[60:63], a[116:119], v[220:223], a[60:63]
    v_permlane16_swap_b32 v29, v31
    v_mfma_f32_16x16x32_bf16 a[60:63], a[120:123], v[232:235], a[60:63]
    ds_read_b64_tr_b16 a[144:145], v5 offset:49152
    s_mov_b64 vcc, s[86:87]
    v_mfma_f32_16x16x32_bf16 a[60:63], a[124:127], v[244:247], a[60:63]
    ds_read_b64_tr_b16 a[146:147], v5 offset:51200
    v_cndmask_b32_dpp v32, v28, v24, vcc row_ror:8 row_mask:0xf bank_mask:0xf
    v_mfma_f32_16x16x32_bf16 a[64:67], a[112:115], v[212:215], a[64:67]
    ds_read_b64_tr_b16 a[148:149], v5 offset:53248
    v_cndmask_b32_dpp v33, v29, v25, vcc row_ror:8 row_mask:0xf bank_mask:0xf
    v_mfma_f32_16x16x32_bf16 a[64:67], a[116:119], v[224:227], a[64:67]
    ds_read_b64_tr_b16 a[150:151], v5 offset:55296
    v_cndmask_b32_dpp v34, v30, v26, vcc row_ror:8 row_mask:0xf bank_mask:0xf
    v_mfma_f32_16x16x32_bf16 a[64:67], a[120:123], v[236:239], a[64:67]
    ds_read_b64_tr_b16 a[152:153], v5 offset:57344
    v_cndmask_b32_dpp v35, v31, v27, vcc row_ror:8 row_mask:0xf bank_mask:0xf
    v_mfma_f32_16x16x32_bf16 a[64:67], a[124:127], v[248:251], a[64:67]
    ds_read_b64_tr_b16 a[154:155], v5 offset:59392
    s_not_b64 vcc, vcc
    v_mfma_f32_16x16x32_bf16 a[68:71], a[112:115], v[216:219], a[68:71]
    ds_read_b64_tr_b16 a[156:157], v5 offset:61440
    v_cndmask_b32_dpp v28, v24, v28, vcc row_ror:8 row_mask:0xf bank_mask:0xf
    v_mfma_f32_16x16x32_bf16 a[68:71], a[116:119], v[228:231], a[68:71]
    ds_read_b64_tr_b16 a[158:159], v5 offset:63488
    v_cndmask_b32_dpp v29, v25, v29, vcc row_ror:8 row_mask:0xf bank_mask:0xf
    v_mfma_f32_16x16x32_bf16 a[68:71], a[120:123], v[240:243], a[68:71]
    v_cndmask_b32_dpp v30, v26, v30, vcc row_ror:8 row_mask:0xf bank_mask:0xf
    v_cndmask_b32_dpp v31, v27, v31, vcc row_ror:8 row_mask:0xf bank_mask:0xf
    v_mfma_f32_16x16x32_bf16 a[68:71], a[124:127], v[252:255], a[68:71]
    v_accvgpr_write_b32 a192, v32
    v_accvgpr_write_b32 a193, v33
    v_mfma_f32_16x16x32_bf16 a[72:75], a[128:131], v[208:211], a[72:75]
    s_waitcnt lgkmcnt(6)
    v_accvgpr_write_b32 a194, v34
    v_accvgpr_write_b32 a195, v35
    v_mfma_f32_16x16x32_bf16 a[72:75], a[132:135], v[220:223], a[72:75]
    v_accvgpr_write_b32 a196, v28
    v_accvgpr_write_b32 a197, v29
    v_mfma_f32_16x16x32_bf16 a[72:75], a[136:139], v[232:235], a[72:75]
    ds_read_b64_tr_b16 a[96:97], v2 offset:0
    v_accvgpr_write_b32 a198, v30
    v_mfma_f32_16x16x32_bf16 a[72:75], a[140:143], v[244:247], a[72:75]
    ds_read_b64_tr_b16 a[98:99], v2 offset:2048
    v_accvgpr_write_b32 a199, v31
    v_mfma_f32_16x16x32_bf16 a[76:79], a[128:131], v[212:215], a[76:79]
    ds_read_b64_tr_b16 a[100:101], v2 offset:4096
    v_add_u32 v4, 0x10000, v4
    v_mfma_f32_16x16x32_bf16 a[76:79], a[132:135], v[224:227], a[76:79]
    ds_read_b64_tr_b16 a[102:103], v2 offset:6144
    v_add_u32 v5, 0x10000, v5
    v_mfma_f32_16x16x32_bf16 a[76:79], a[136:139], v[236:239], a[76:79]
    ds_read_b64_tr_b16 a[104:105], v2 offset:8192
    v_mfma_f32_16x16x32_bf16 a[76:79], a[140:143], v[248:251], a[76:79]
    ds_read_b64_tr_b16 a[106:107], v2 offset:10240
    v_mfma_f32_16x16x32_bf16 a[80:83], a[128:131], v[216:219], a[80:83]
    ds_read_b64_tr_b16 a[108:109], v2 offset:12288
    v_mfma_f32_16x16x32_bf16 a[80:83], a[132:135], v[228:231], a[80:83]
    ds_read_b64_tr_b16 a[110:111], v2 offset:14336
    v_mfma_f32_16x16x32_bf16 a[80:83], a[136:139], v[240:243], a[80:83]
    v_mfma_f32_16x16x32_bf16 a[80:83], a[140:143], v[252:255], a[80:83]
    v_mfma_f32_16x16x32_bf16 a[84:87], a[144:147], v[208:211], a[84:87]
    s_waitcnt lgkmcnt(6)
    v_mfma_f32_16x16x32_bf16 a[84:87], a[148:151], v[220:223], a[84:87]
    v_mfma_f32_16x16x32_bf16 a[84:87], a[152:155], v[232:235], a[84:87]
    ds_read_b64_tr_b16 a[112:113], v3 offset:0
    v_mfma_f32_16x16x32_bf16 a[84:87], a[156:159], v[244:247], a[84:87]
    ds_read_b64_tr_b16 a[114:115], v3 offset:2048
    v_mfma_f32_16x16x32_bf16 a[88:91], a[144:147], v[212:215], a[88:91]
    ds_read_b64_tr_b16 a[116:117], v3 offset:4096
    v_mfma_f32_16x16x32_bf16 a[88:91], a[148:151], v[224:227], a[88:91]
    ds_read_b64_tr_b16 a[118:119], v3 offset:6144
    v_mfma_f32_16x16x32_bf16 a[88:91], a[152:155], v[236:239], a[88:91]
    ds_read_b64_tr_b16 a[120:121], v3 offset:8192
    v_mfma_f32_16x16x32_bf16 a[88:91], a[156:159], v[248:251], a[88:91]
    ds_read_b64_tr_b16 a[122:123], v3 offset:10240
    v_accvgpr_read_b32 v16, a48
    v_mfma_f32_16x16x32_bf16 a[92:95], a[144:147], v[216:219], a[92:95]
    ds_read_b64_tr_b16 a[124:125], v3 offset:12288
    v_accvgpr_read_b32 v17, a49
    v_mfma_f32_16x16x32_bf16 a[92:95], a[148:151], v[228:231], a[92:95]
    ds_read_b64_tr_b16 a[126:127], v3 offset:14336
    v_accvgpr_read_b32 v18, a50
    v_mfma_f32_16x16x32_bf16 a[92:95], a[152:155], v[240:243], a[92:95]
    v_accvgpr_read_b32 v19, a51
    v_accvgpr_read_b32 v20, a60
    v_mfma_f32_16x16x32_bf16 a[92:95], a[156:159], v[252:255], a[92:95]
    v_accvgpr_read_b32 v21, a61
    v_accvgpr_read_b32 v22, a62
    v_mfma_f32_16x16x32_bf16 a[0:3], a[96:99], v[64:67], 0
    s_waitcnt lgkmcnt(6)
    v_accvgpr_read_b32 v23, a63
    v_mul_f32 v16, v16, v7
    v_mfma_f32_16x16x32_bf16 a[0:3], a[100:103], v[76:79], a[0:3]
    v_mul_f32 v17, v17, v7
    v_mul_f32 v18, v18, v7
    v_mfma_f32_16x16x32_bf16 a[0:3], a[104:107], v[88:91], a[0:3]
    ds_read_b64_tr_b16 a[128:129], v4 offset:0
    v_mul_f32 v19, v19, v7
    v_mfma_f32_16x16x32_bf16 a[0:3], a[108:111], v[100:103], a[0:3]
    ds_read_b64_tr_b16 a[130:131], v4 offset:2048
    v_mul_f32 v20, v20, v7
    v_mfma_f32_16x16x32_bf16 a[4:7], a[96:99], v[68:71], 0
    ds_read_b64_tr_b16 a[132:133], v4 offset:4096
    v_mul_f32 v21, v21, v7
    v_mfma_f32_16x16x32_bf16 a[4:7], a[100:103], v[80:83], a[4:7]
    ds_read_b64_tr_b16 a[134:135], v4 offset:6144
    v_mul_f32 v22, v22, v7
    v_mfma_f32_16x16x32_bf16 a[4:7], a[104:107], v[92:95], a[4:7]
    ds_read_b64_tr_b16 a[136:137], v4 offset:8192
    v_mul_f32 v23, v23, v7
    v_mfma_f32_16x16x32_bf16 a[4:7], a[108:111], v[104:107], a[4:7]
    ds_read_b64_tr_b16 a[138:139], v4 offset:10240
    v_cvt_pk_bf16_f32 v24, v16, v17
    v_mfma_f32_16x16x32_bf16 a[8:11], a[96:99], v[72:75], 0
    ds_read_b64_tr_b16 a[140:141], v4 offset:12288
    v_cvt_pk_bf16_f32 v25, v18, v19
    v_mfma_f32_16x16x32_bf16 a[8:11], a[100:103], v[84:87], a[8:11]
    ds_read_b64_tr_b16 a[142:143], v4 offset:14336
    v_cvt_pk_bf16_f32 v26, v20, v21
    v_mfma_f32_16x16x32_bf16 a[8:11], a[104:107], v[96:99], a[8:11]
    v_cvt_pk_bf16_f32 v27, v22, v23
    v_mfma_f32_16x16x32_bf16 a[8:11], a[108:111], v[108:111], a[8:11]
    v_permlane16_swap_b32 v24, v26
    v_mfma_f32_16x16x32_bf16 a[12:15], a[112:115], v[64:67], 0
    s_waitcnt lgkmcnt(6)
    v_permlane16_swap_b32 v25, v27
    v_mfma_f32_16x16x32_bf16 a[12:15], a[116:119], v[76:79], a[12:15]
    v_accvgpr_read_b32 v16, a72
    v_accvgpr_read_b32 v17, a73
    v_mfma_f32_16x16x32_bf16 a[12:15], a[120:123], v[88:91], a[12:15]
    ds_read_b64_tr_b16 a[144:145], v5 offset:0
    v_accvgpr_read_b32 v18, a74
    v_mfma_f32_16x16x32_bf16 a[12:15], a[124:127], v[100:103], a[12:15]
    ds_read_b64_tr_b16 a[146:147], v5 offset:2048
    v_accvgpr_read_b32 v19, a75
    v_mfma_f32_16x16x32_bf16 a[16:19], a[112:115], v[68:71], 0
    ds_read_b64_tr_b16 a[148:149], v5 offset:4096
    v_accvgpr_read_b32 v20, a84
    v_mfma_f32_16x16x32_bf16 a[16:19], a[116:119], v[80:83], a[16:19]
    ds_read_b64_tr_b16 a[150:151], v5 offset:6144
    v_accvgpr_read_b32 v21, a85
    v_mfma_f32_16x16x32_bf16 a[16:19], a[120:123], v[92:95], a[16:19]
    ds_read_b64_tr_b16 a[152:153], v5 offset:8192
    v_accvgpr_read_b32 v22, a86
    v_mfma_f32_16x16x32_bf16 a[16:19], a[124:127], v[104:107], a[16:19]
    ds_read_b64_tr_b16 a[154:155], v5 offset:10240
    v_accvgpr_read_b32 v23, a87
    v_mfma_f32_16x16x32_bf16 a[20:23], a[112:115], v[72:75], 0
    ds_read_b64_tr_b16 a[156:157], v5 offset:12288
    v_mul_f32 v16, v16, v7
    v_mfma_f32_16x16x32_bf16 a[20:23], a[116:119], v[84:87], a[20:23]
    ds_read_b64_tr_b16 a[158:159], v5 offset:14336
    v_mul_f32 v17, v17, v7
    v_mfma_f32_16x16x32_bf16 a[20:23], a[120:123], v[96:99], a[20:23]
    v_mul_f32 v18, v18, v7
    v_mul_f32 v19, v19, v7
    v_mfma_f32_16x16x32_bf16 a[20:23], a[124:127], v[108:111], a[20:23]
    v_mul_f32 v20, v20, v7
    v_mul_f32 v21, v21, v7
    v_mfma_f32_16x16x32_bf16 a[24:27], a[128:131], v[64:67], 0
    s_waitcnt lgkmcnt(6)
    v_mul_f32 v22, v22, v7
    v_mul_f32 v23, v23, v7
    v_mfma_f32_16x16x32_bf16 a[24:27], a[132:135], v[76:79], a[24:27]
    v_cvt_pk_bf16_f32 v28, v16, v17
    v_cvt_pk_bf16_f32 v29, v18, v19
    v_mfma_f32_16x16x32_bf16 a[24:27], a[136:139], v[88:91], a[24:27]
    ds_read_b64_tr_b16 a[96:97], v2 offset:16384
    v_cvt_pk_bf16_f32 v30, v20, v21
    v_mfma_f32_16x16x32_bf16 a[24:27], a[140:143], v[100:103], a[24:27]
    ds_read_b64_tr_b16 a[98:99], v2 offset:18432
    v_cvt_pk_bf16_f32 v31, v22, v23
    v_mfma_f32_16x16x32_bf16 a[28:31], a[128:131], v[68:71], 0
    v_permlane16_swap_b32 v28, v30
    v_mfma_f32_16x16x32_bf16 a[28:31], a[132:135], v[80:83], a[28:31]
    ds_read_b64_tr_b16 a[100:101], v2 offset:20480
    ds_read_b64_tr_b16 a[102:103], v2 offset:22528
    v_mfma_f32_16x16x32_bf16 a[28:31], a[136:139], v[92:95], a[28:31]
    v_permlane16_swap_b32 v29, v31
    v_mfma_f32_16x16x32_bf16 a[28:31], a[140:143], v[104:107], a[28:31]
    ds_read_b64_tr_b16 a[104:105], v2 offset:24576
    ds_read_b64_tr_b16 a[106:107], v2 offset:26624
    v_mfma_f32_16x16x32_bf16 a[32:35], a[128:131], v[72:75], 0
    ds_read_b64_tr_b16 a[108:109], v2 offset:28672
    s_mov_b64 vcc, s[86:87]
    v_mfma_f32_16x16x32_bf16 a[32:35], a[132:135], v[84:87], a[32:35]
    ds_read_b64_tr_b16 a[110:111], v2 offset:30720
    v_cndmask_b32_dpp v32, v28, v24, vcc row_ror:8 row_mask:0xf bank_mask:0xf
    v_mfma_f32_16x16x32_bf16 a[32:35], a[136:139], v[96:99], a[32:35]
    v_cndmask_b32_dpp v33, v29, v25, vcc row_ror:8 row_mask:0xf bank_mask:0xf
    v_cndmask_b32_dpp v34, v30, v26, vcc row_ror:8 row_mask:0xf bank_mask:0xf
    v_mfma_f32_16x16x32_bf16 a[32:35], a[140:143], v[108:111], a[32:35]
    v_cndmask_b32_dpp v35, v31, v27, vcc row_ror:8 row_mask:0xf bank_mask:0xf
    v_mfma_f32_16x16x32_bf16 a[36:39], a[144:147], v[64:67], 0
    s_waitcnt lgkmcnt(6)
    buffer_store_dwordx4 v[32:35], v6, s[16:19], 0 offen offset:128 nt
    s_not_b64 vcc, vcc
    v_mfma_f32_16x16x32_bf16 a[36:39], a[148:151], v[76:79], a[36:39]
    v_cndmask_b32_dpp v28, v24, v28, vcc row_ror:8 row_mask:0xf bank_mask:0xf
    v_cndmask_b32_dpp v29, v25, v29, vcc row_ror:8 row_mask:0xf bank_mask:0xf
    v_mfma_f32_16x16x32_bf16 a[36:39], a[152:155], v[88:91], a[36:39]
    ds_read_b64_tr_b16 a[112:113], v3 offset:16384
    v_cndmask_b32_dpp v30, v26, v30, vcc row_ror:8 row_mask:0xf bank_mask:0xf
    v_mfma_f32_16x16x32_bf16 a[36:39], a[156:159], v[100:103], a[36:39]
    ds_read_b64_tr_b16 a[114:115], v3 offset:18432
    v_cndmask_b32_dpp v31, v27, v31, vcc row_ror:8 row_mask:0xf bank_mask:0xf
    v_mfma_f32_16x16x32_bf16 a[40:43], a[144:147], v[68:71], 0
    buffer_store_dwordx4 v[28:31], v6, s[16:19], s80 offen offset:128 nt
    ds_read_b64_tr_b16 a[116:117], v3 offset:20480
    v_mfma_f32_16x16x32_bf16 a[40:43], a[148:151], v[80:83], a[40:43]
    ds_read_b64_tr_b16 a[118:119], v3 offset:22528
    v_mfma_f32_16x16x32_bf16 a[40:43], a[152:155], v[92:95], a[40:43]
    ds_read_b64_tr_b16 a[120:121], v3 offset:24576
    v_mfma_f32_16x16x32_bf16 a[40:43], a[156:159], v[104:107], a[40:43]
    ds_read_b64_tr_b16 a[122:123], v3 offset:26624
    v_mfma_f32_16x16x32_bf16 a[44:47], a[144:147], v[72:75], 0
    ds_read_b64_tr_b16 a[124:125], v3 offset:28672
    v_mfma_f32_16x16x32_bf16 a[44:47], a[148:151], v[84:87], a[44:47]
    ds_read_b64_tr_b16 a[126:127], v3 offset:30720
    v_mfma_f32_16x16x32_bf16 a[44:47], a[152:155], v[96:99], a[44:47]
    v_mfma_f32_16x16x32_bf16 a[44:47], a[156:159], v[108:111], a[44:47]
    v_mfma_f32_16x16x32_bf16 a[0:3], a[96:99], v[112:115], a[0:3]
    s_waitcnt lgkmcnt(6)
    v_mfma_f32_16x16x32_bf16 a[0:3], a[100:103], v[124:127], a[0:3]
    v_mfma_f32_16x16x32_bf16 a[0:3], a[104:107], v[136:139], a[0:3]
    ds_read_b64_tr_b16 a[128:129], v4 offset:16384
    v_mfma_f32_16x16x32_bf16 a[0:3], a[108:111], v[148:151], a[0:3]
    ds_read_b64_tr_b16 a[130:131], v4 offset:18432
    v_mfma_f32_16x16x32_bf16 a[4:7], a[96:99], v[116:119], a[4:7]
    ds_read_b64_tr_b16 a[132:133], v4 offset:20480
    v_mfma_f32_16x16x32_bf16 a[4:7], a[100:103], v[128:131], a[4:7]
    ds_read_b64_tr_b16 a[134:135], v4 offset:22528
    v_mfma_f32_16x16x32_bf16 a[4:7], a[104:107], v[140:143], a[4:7]
    ds_read_b64_tr_b16 a[136:137], v4 offset:24576
    v_mfma_f32_16x16x32_bf16 a[4:7], a[108:111], v[152:155], a[4:7]
    ds_read_b64_tr_b16 a[138:139], v4 offset:26624
    v_mfma_f32_16x16x32_bf16 a[8:11], a[96:99], v[120:123], a[8:11]
    ds_read_b64_tr_b16 a[140:141], v4 offset:28672
    v_accvgpr_read_b32 v16, a52
    v_mfma_f32_16x16x32_bf16 a[8:11], a[100:103], v[132:135], a[8:11]
    ds_read_b64_tr_b16 a[142:143], v4 offset:30720
    v_accvgpr_read_b32 v17, a53
    v_mfma_f32_16x16x32_bf16 a[8:11], a[104:107], v[144:147], a[8:11]
    v_accvgpr_read_b32 v18, a54
    v_accvgpr_read_b32 v19, a55
    v_mfma_f32_16x16x32_bf16 a[8:11], a[108:111], v[156:159], a[8:11]
    v_accvgpr_read_b32 v20, a64
    v_accvgpr_read_b32 v21, a65
    v_mfma_f32_16x16x32_bf16 a[12:15], a[112:115], v[112:115], a[12:15]
    s_waitcnt lgkmcnt(6)
    v_accvgpr_read_b32 v22, a66
    v_accvgpr_read_b32 v23, a67
    v_mfma_f32_16x16x32_bf16 a[12:15], a[116:119], v[124:127], a[12:15]
    v_mul_f32 v16, v16, v8
    v_mul_f32 v17, v17, v8
    v_mfma_f32_16x16x32_bf16 a[12:15], a[120:123], v[136:139], a[12:15]
    ds_read_b64_tr_b16 a[144:145], v5 offset:16384
    v_mul_f32 v18, v18, v8
    v_mfma_f32_16x16x32_bf16 a[12:15], a[124:127], v[148:151], a[12:15]
    ds_read_b64_tr_b16 a[146:147], v5 offset:18432
    v_mul_f32 v19, v19, v8
    v_mfma_f32_16x16x32_bf16 a[16:19], a[112:115], v[116:119], a[16:19]
    ds_read_b64_tr_b16 a[148:149], v5 offset:20480
    v_mul_f32 v20, v20, v8
    v_mfma_f32_16x16x32_bf16 a[16:19], a[116:119], v[128:131], a[16:19]
    ds_read_b64_tr_b16 a[150:151], v5 offset:22528
    v_mul_f32 v21, v21, v8
    v_mfma_f32_16x16x32_bf16 a[16:19], a[120:123], v[140:143], a[16:19]
    ds_read_b64_tr_b16 a[152:153], v5 offset:24576
    v_mul_f32 v22, v22, v8
    v_mfma_f32_16x16x32_bf16 a[16:19], a[124:127], v[152:155], a[16:19]
    ds_read_b64_tr_b16 a[154:155], v5 offset:26624
    v_mul_f32 v23, v23, v8
    v_mfma_f32_16x16x32_bf16 a[20:23], a[112:115], v[120:123], a[20:23]
    ds_read_b64_tr_b16 a[156:157], v5 offset:28672
    v_cvt_pk_bf16_f32 v24, v16, v17
    v_mfma_f32_16x16x32_bf16 a[20:23], a[116:119], v[132:135], a[20:23]
    ds_read_b64_tr_b16 a[158:159], v5 offset:30720
    v_cvt_pk_bf16_f32 v25, v18, v19
    v_mfma_f32_16x16x32_bf16 a[20:23], a[120:123], v[144:147], a[20:23]
    v_cvt_pk_bf16_f32 v26, v20, v21
    v_cvt_pk_bf16_f32 v27, v22, v23
    v_mfma_f32_16x16x32_bf16 a[20:23], a[124:127], v[156:159], a[20:23]
    s_waitcnt vmcnt(18)
    v_accvgpr_read_b32 v16, a76
    v_accvgpr_read_b32 v17, a77
    v_mfma_f32_16x16x32_bf16 a[24:27], a[128:131], v[112:115], a[24:27]
    s_waitcnt lgkmcnt(6)
    v_permlane16_swap_b32 v24, v26
    v_mfma_f32_16x16x32_bf16 a[24:27], a[132:135], v[124:127], a[24:27]
    s_barrier
    v_permlane16_swap_b32 v25, v27
    v_mfma_f32_16x16x32_bf16 a[24:27], a[136:139], v[136:139], a[24:27]
L_pg6:
    s_cbranch_execz L_back
    ds_read_b64_tr_b16 a[96:97], v2 offset:32768
    v_accvgpr_read_b32 v18, a78
    v_mfma_f32_16x16x32_bf16 a[24:27], a[140:143], v[148:151], a[24:27]
    ds_read_b64_tr_b16 a[98:99], v2 offset:34816
    v_accvgpr_read_b32 v19, a79
    v_mfma_f32_16x16x32_bf16 a[28:31], a[128:131], v[116:119], a[28:31]
    ds_read_b64_tr_b16 a[100:101], v2 offset:36864
    v_accvgpr_read_b32 v20, a88
    v_mfma_f32_16x16x32_bf16 a[28:31], a[132:135], v[128:131], a[28:31]
    ds_read_b64_tr_b16 a[102:103], v2 offset:38912
    v_accvgpr_read_b32 v21, a89
    v_mfma_f32_16x16x32_bf16 a[28:31], a[136:139], v[140:143], a[28:31]
    ds_read_b64_tr_b16 a[104:105], v2 offset:40960
    v_accvgpr_read_b32 v22, a90
    v_mfma_f32_16x16x32_bf16 a[28:31], a[140:143], v[152:155], a[28:31]
    ds_read_b64_tr_b16 a[106:107], v2 offset:43008
    v_accvgpr_read_b32 v23, a91
    v_mfma_f32_16x16x32_bf16 a[32:35], a[128:131], v[120:123], a[32:35]
    ds_read_b64_tr_b16 a[108:109], v2 offset:45056
    v_mul_f32 v16, v16, v8
    v_mfma_f32_16x16x32_bf16 a[32:35], a[132:135], v[132:135], a[32:35]
    ds_read_b64_tr_b16 a[110:111], v2 offset:47104
    v_mul_f32 v17, v17, v8
    v_mfma_f32_16x16x32_bf16 a[32:35], a[136:139], v[144:147], a[32:35]
    v_mul_f32 v18, v18, v8
    v_mul_f32 v19, v19, v8
    v_mfma_f32_16x16x32_bf16 a[32:35], a[140:143], v[156:159], a[32:35]
    v_mul_f32 v20, v20, v8
    v_mul_f32 v21, v21, v8
    v_mfma_f32_16x16x32_bf16 a[36:39], a[144:147], v[112:115], a[36:39]
    s_waitcnt lgkmcnt(6)
    v_mul_f32 v22, v22, v8
    v_mul_f32 v23, v23, v8
    v_mfma_f32_16x16x32_bf16 a[36:39], a[148:151], v[124:127], a[36:39]
    v_cvt_pk_bf16_f32 v28, v16, v17
    v_cvt_pk_bf16_f32 v29, v18, v19
    v_mfma_f32_16x16x32_bf16 a[36:39], a[152:155], v[136:139], a[36:39]
    ds_read_b64_tr_b16 a[112:113], v3 offset:32768
    v_cvt_pk_bf16_f32 v30, v20, v21
    v_mfma_f32_16x16x32_bf16 a[36:39], a[156:159], v[148:151], a[36:39]
    ds_read_b64_tr_b16 a[114:115], v3 offset:34816
    v_cvt_pk_bf16_f32 v31, v22, v23
    v_mfma_f32_16x16x32_bf16 a[40:43], a[144:147], v[116:119], a[40:43]
    v_permlane16_swap_b32 v28, v30
    v_mfma_f32_16x16x32_bf16 a[40:43], a[148:151], v[128:131], a[40:43]
    ds_read_b64_tr_b16 a[116:117], v3 offset:36864
    ds_read_b64_tr_b16 a[118:119], v3 offset:38912
    v_mfma_f32_16x16x32_bf16 a[40:43], a[152:155], v[140:143], a[40:43]
    v_permlane16_swap_b32 v29, v31
    v_mfma_f32_16x16x32_bf16 a[40:43], a[156:159], v[152:155], a[40:43]
    ds_read_b64_tr_b16 a[120:121], v3 offset:40960
    ds_read_b64_tr_b16 a[122:123], v3 offset:43008
    v_mfma_f32_16x16x32_bf16 a[44:47], a[144:147], v[120:123], a[44:47]
    ds_read_b64_tr_b16 a[124:125], v3 offset:45056
    s_mov_b64 vcc, s[86:87]
    v_mfma_f32_16x16x32_bf16 a[44:47], a[148:151], v[132:135], a[44:47]
    ds_read_b64_tr_b16 a[126:127], v3 offset:47104
    v_cndmask_b32_dpp v32, v28, v24, vcc row_ror:8 row_mask:0xf bank_mask:0xf
    v_mfma_f32_16x16x32_bf16 a[44:47], a[152:155], v[144:147], a[44:47]
    v_cndmask_b32_dpp v33, v29, v25, vcc row_ror:8 row_mask:0xf bank_mask:0xf
    v_cndmask_b32_dpp v34, v30, v26, vcc row_ror:8 row_mask:0xf bank_mask:0xf
    v_mfma_f32_16x16x32_bf16 a[44:47], a[156:159], v[156:159], a[44:47]
    v_cndmask_b32_dpp v35, v31, v27, vcc row_ror:8 row_mask:0xf bank_mask:0xf
    v_mfma_f32_16x16x32_bf16 a[0:3], a[96:99], v[160:163], a[0:3]
    s_waitcnt lgkmcnt(6)
    buffer_store_dwordx4 a[176:179], v6, s[16:19], 0 offen offset:0 nt
    s_not_b64 vcc, vcc
    v_mfma_f32_16x16x32_bf16 a[0:3], a[100:103], v[172:175], a[0:3]
    buffer_store_dwordx4 v[32:35], v6, s[16:19], s81 offen offset:128 nt
    v_cndmask_b32_dpp v28, v24, v28, vcc row_ror:8 row_mask:0xf bank_mask:0xf
    v_cndmask_b32_dpp v29, v25, v29, vcc row_ror:8 row_mask:0xf bank_mask:0xf
    v_cndmask_b32_dpp v30, v26, v30, vcc row_ror:8 row_mask:0xf bank_mask:0xf
    v_mfma_f32_16x16x32_bf16 a[0:3], a[104:107], v[184:187], a[0:3]
    ds_read_b64_tr_b16 a[128:129], v4 offset:32768
    v_cndmask_b32_dpp v31, v27, v31, vcc row_ror:8 row_mask:0xf bank_mask:0xf
    v_mfma_f32_16x16x32_bf16 a[0:3], a[108:111], v[196:199], a[0:3]
    buffer_store_dwordx4 v[28:31], v6, s[16:19], s82 offen offset:128 nt
    ds_read_b64_tr_b16 a[130:131], v4 offset:34816
    v_mfma_f32_16x16x32_bf16 a[4:7], a[96:99], v[164:167], a[4:7]
    ds_read_b64_tr_b16 a[132:133], v4 offset:36864
    v_mfma_f32_16x16x32_bf16 a[4:7], a[100:103], v[176:179], a[4:7]
    ds_read_b64_tr_b16 a[134:135], v4 offset:38912
    v_mfma_f32_16x16x32_bf16 a[4:7], a[104:107], v[188:191], a[4:7]
    ds_read_b64_tr_b16 a[136:137], v4 offset:40960
    v_mfma_f32_16x16x32_bf16 a[4:7], a[108:111], v[200:203], a[4:7]
    ds_read_b64_tr_b16 a[138:139], v4 offset:43008
    v_mfma_f32_16x16x32_bf16 a[8:11], a[96:99], v[168:171], a[8:11]
    ds_read_b64_tr_b16 a[140:141], v4 offset:45056
    v_mfma_f32_16x16x32_bf16 a[8:11], a[100:103], v[180:183], a[8:11]
    ds_read_b64_tr_b16 a[142:143], v4 offset:47104
    v_mfma_f32_16x16x32_bf16 a[8:11], a[104:107], v[192:195], a[8:11]
    v_mfma_f32_16x16x32_bf16 a[8:11], a[108:111], v[204:207], a[8:11]
    v_mfma_f32_16x16x32_bf16 a[12:15], a[112:115], v[160:163], a[12:15]
    s_waitcnt lgkmcnt(6)
    v_mfma_f32_16x16x32_bf16 a[12:15], a[116:119], v[172:175], a[12:15]
    v_mfma_f32_16x16x32_bf16 a[12:15], a[120:123], v[184:187], a[12:15]
    ds_read_b64_tr_b16 a[144:145], v5 offset:32768
    v_mfma_f32_16x16x32_bf16 a[12:15], a[124:127], v[196:199], a[12:15]
    ds_read_b64_tr_b16 a[146:147], v5 offset:34816
    v_mfma_f32_16x16x32_bf16 a[16:19], a[112:115], v[164:167], a[16:19]
    ds_read_b64_tr_b16 a[148:149], v5 offset:36864
    v_mfma_f32_16x16x32_bf16 a[16:19], a[116:119], v[176:179], a[16:19]
    ds_read_b64_tr_b16 a[150:151], v5 offset:38912
    v_mfma_f32_16x16x32_bf16 a[16:19], a[120:123], v[188:191], a[16:19]
    ds_read_b64_tr_b16 a[152:153], v5 offset:40960
    v_mfma_f32_16x16x32_bf16 a[16:19], a[124:127], v[200:203], a[16:19]
    ds_read_b64_tr_b16 a[154:155], v5 offset:43008
    v_mfma_f32_16x16x32_bf16 a[20:23], a[112:115], v[168:171], a[20:23]
    ds_read_b64_tr_b16 a[156:157], v5 offset:45056
    v_mfma_f32_16x16x32_bf16 a[20:23], a[116:119], v[180:183], a[20:23]
    ds_read_b64_tr_b16 a[158:159], v5 offset:47104
    v_mfma_f32_16x16x32_bf16 a[20:23], a[120:123], v[192:195], a[20:23]
    v_mfma_f32_16x16x32_bf16 a[20:23], a[124:127], v[204:207], a[20:23]
    v_mfma_f32_16x16x32_bf16 a[24:27], a[128:131], v[160:163], a[24:27]
    s_waitcnt lgkmcnt(6)
    v_accvgpr_read_b32 v16, a56
    v_accvgpr_read_b32 v17, a57
    v_mfma_f32_16x16x32_bf16 a[24:27], a[132:135], v[172:175], a[24:27]
    v_accvgpr_read_b32 v18, a58
    v_accvgpr_read_b32 v19, a59
    v_mfma_f32_16x16x32_bf16 a[24:27], a[136:139], v[184:187], a[24:27]
    ds_read_b64_tr_b16 a[96:97], v2 offset:49152
    v_accvgpr_read_b32 v20, a68
    v_mfma_f32_16x16x32_bf16 a[24:27], a[140:143], v[196:199], a[24:27]
    ds_read_b64_tr_b16 a[98:99], v2 offset:51200
    v_accvgpr_read_b32 v21, a69
    v_mfma_f32_16x16x32_bf16 a[28:31], a[128:131], v[164:167], a[28:31]
    ds_read_b64_tr_b16 a[100:101], v2 offset:53248
    v_accvgpr_read_b32 v22, a70
    v_mfma_f32_16x16x32_bf16 a[28:31], a[132:135], v[176:179], a[28:31]
    ds_read_b64_tr_b16 a[102:103], v2 offset:55296
    v_accvgpr_read_b32 v23, a71
    v_mfma_f32_16x16x32_bf16 a[28:31], a[136:139], v[188:191], a[28:31]
    ds_read_b64_tr_b16 a[104:105], v2 offset:57344
    v_mul_f32 v16, v16, v9
    v_mfma_f32_16x16x32_bf16 a[28:31], a[140:143], v[200:203], a[28:31]
    ds_read_b64_tr_b16 a[106:107], v2 offset:59392
    v_mul_f32 v17, v17, v9
    v_mfma_f32_16x16x32_bf16 a[32:35], a[128:131], v[168:171], a[32:35]
    ds_read_b64_tr_b16 a[108:109], v2 offset:61440
    v_mul_f32 v18, v18, v9
    v_mfma_f32_16x16x32_bf16 a[32:35], a[132:135], v[180:183], a[32:35]
    ds_read_b64_tr_b16 a[110:111], v2 offset:63488
    v_mul_f32 v19, v19, v9
    v_mfma_f32_16x16x32_bf16 a[32:35], a[136:139], v[192:195], a[32:35]
    v_mul_f32 v20, v20, v9
    v_mul_f32 v21, v21, v9
    v_mfma_f32_16x16x32_bf16 a[32:35], a[140:143], v[204:207], a[32:35]
    v_mul_f32 v22, v22, v9
    v_mul_f32 v23, v23, v9
    v_mfma_f32_16x16x32_bf16 a[36:39], a[144:147], v[160:163], a[36:39]
    s_waitcnt lgkmcnt(6)
    v_add_u32 v2, 0x10000, v2
    v_cvt_pk_bf16_f32 v24, v16, v17
    v_mfma_f32_16x16x32_bf16 a[36:39], a[148:151], v[172:175], a[36:39]
    v_cvt_pk_bf16_f32 v25, v18, v19
    v_cvt_pk_bf16_f32 v26, v20, v21
    v_mfma_f32_16x16x32_bf16 a[36:39], a[152:155], v[184:187], a[36:39]
    ds_read_b64_tr_b16 a[112:113], v3 offset:49152
    v_cvt_pk_bf16_f32 v27, v22, v23
    v_mfma_f32_16x16x32_bf16 a[36:39], a[156:159], v[196:199], a[36:39]
    ds_read_b64_tr_b16 a[114:115], v3 offset:51200
    v_accvgpr_read_b32 v16, a80
    v_mfma_f32_16x16x32_bf16 a[40:43], a[144:147], v[164:167], a[40:43]
    buffer_store_dwordx4 a[180:183], v6, s[16:19], s80 offen offset:0 nt
    ds_read_b64_tr_b16 a[116:117], v3 offset:53248
    v_permlane16_swap_b32 v24, v26
    v_mfma_f32_16x16x32_bf16 a[40:43], a[148:151], v[176:179], a[40:43]
    ds_read_b64_tr_b16 a[118:119], v3 offset:55296
    v_accvgpr_read_b32 v17, a81
    v_mfma_f32_16x16x32_bf16 a[40:43], a[152:155], v[188:191], a[40:43]
    ds_read_b64_tr_b16 a[120:121], v3 offset:57344
    v_accvgpr_read_b32 v18, a82
    v_mfma_f32_16x16x32_bf16 a[40:43], a[156:159], v[200:203], a[40:43]
    ds_read_b64_tr_b16 a[122:123], v3 offset:59392
    v_accvgpr_read_b32 v19, a83
    v_mfma_f32_16x16x32_bf16 a[44:47], a[144:147], v[168:171], a[44:47]
    ds_read_b64_tr_b16 a[124:125], v3 offset:61440
    v_accvgpr_read_b32 v20, a92
    v_mfma_f32_16x16x32_bf16 a[44:47], a[148:151], v[180:183], a[44:47]
    ds_read_b64_tr_b16 a[126:127], v3 offset:63488
    v_accvgpr_read_b32 v21, a93
    v_mfma_f32_16x16x32_bf16 a[44:47], a[152:155], v[192:195], a[44:47]
    v_permlane16_swap_b32 v25, v27
    v_mfma_f32_16x16x32_bf16 a[44:47], a[156:159], v[204:207], a[44:47]
    v_accvgpr_read_b32 v22, a94
    v_accvgpr_read_b32 v23, a95
    v_mfma_f32_16x16x32_bf16 a[0:3], a[96:99], v[208:211], a[0:3]
    s_waitcnt lgkmcnt(6)
    v_mul_f32 v16, v16, v9
    v_mul_f32 v17, v17, v9
    v_mfma_f32_16x16x32_bf16 a[0:3], a[100:103], v[220:223], a[0:3]
    v_mul_f32 v18, v18, v9
    v_mul_f32 v19, v19, v9
    v_mfma_f32_16x16x32_bf16 a[0:3], a[104:107], v[232:235], a[0:3]
    ds_read_b64_tr_b16 a[128:129], v4 offset:49152
    v_mul_f32 v20, v20, v9
    v_mfma_f32_16x16x32_bf16 a[0:3], a[108:111], v[244:247], a[0:3]
    ds_read_b64_tr_b16 a[130:131], v4 offset:51200
    v_mul_f32 v21, v21, v9
    v_mfma_f32_16x16x32_bf16 a[4:7], a[96:99], v[212:215], a[4:7]
    ds_read_b64_tr_b16 a[132:133], v4 offset:53248
    v_mul_f32 v22, v22, v9
    v_mfma_f32_16x16x32_bf16 a[4:7], a[100:103], v[224:227], a[4:7]
    ds_read_b64_tr_b16 a[134:135], v4 offset:55296
    v_mul_f32 v23, v23, v9
    v_mfma_f32_16x16x32_bf16 a[4:7], a[104:107], v[236:239], a[4:7]
    ds_read_b64_tr_b16 a[136:137], v4 offset:57344
    v_add_u32 v3, 0x10000, v3
    v_mfma_f32_16x16x32_bf16 a[4:7], a[108:111], v[248:251], a[4:7]
    ds_read_b64_tr_b16 a[138:139], v4 offset:59392
    v_cvt_pk_bf16_f32 v28, v16, v17
    v_mfma_f32_16x16x32_bf16 a[8:11], a[96:99], v[216:219], a[8:11]
    ds_read_b64_tr_b16 a[140:141], v4 offset:61440
    v_cvt_pk_bf16_f32 v29, v18, v19
    v_mfma_f32_16x16x32_bf16 a[8:11], a[100:103], v[228:231], a[8:11]
    ds_read_b64_tr_b16 a[142:143], v4 offset:63488
    v_cvt_pk_bf16_f32 v30, v20, v21
    v_mfma_f32_16x16x32_bf16 a[8:11], a[104:107], v[240:243], a[8:11]
    v_cvt_pk_bf16_f32 v31, v22, v23
    v_mfma_f32_16x16x32_bf16 a[8:11], a[108:111], v[252:255], a[8:11]
    v_permlane16_swap_b32 v28, v30
    v_mfma_f32_16x16x32_bf16 a[12:15], a[112:115], v[208:211], a[12:15]
    s_waitcnt lgkmcnt(6)
    v_permlane16_swap_b32 v29, v31
    v_mfma_f32_16x16x32_bf16 a[12:15], a[116:119], v[220:223], a[12:15]
    s_mov_b64 vcc, s[86:87]
    v_add_u32 v4, 0x10000, v4
    v_mfma_f32_16x16x32_bf16 a[12:15], a[120:123], v[232:235], a[12:15]
    ds_read_b64_tr_b16 a[144:145], v5 offset:49152
    v_cndmask_b32_dpp v32, v28, v24, vcc row_ror:8 row_mask:0xf bank_mask:0xf
    v_mfma_f32_16x16x32_bf16 a[12:15], a[124:127], v[244:247], a[12:15]
    ds_read_b64_tr_b16 a[146:147], v5 offset:51200
    v_cndmask_b32_dpp v33, v29, v25, vcc row_ror:8 row_mask:0xf bank_mask:0xf
    v_mfma_f32_16x16x32_bf16 a[16:19], a[112:115], v[212:215], a[16:19]
    ds_read_b64_tr_b16 a[148:149], v5 offset:53248
    v_cndmask_b32_dpp v34, v30, v26, vcc row_ror:8 row_mask:0xf bank_mask:0xf
    v_mfma_f32_16x16x32_bf16 a[16:19], a[116:119], v[224:227], a[16:19]
    ds_read_b64_tr_b16 a[150:151], v5 offset:55296
    v_cndmask_b32_dpp v35, v31, v27, vcc row_ror:8 row_mask:0xf bank_mask:0xf
    v_mfma_f32_16x16x32_bf16 a[16:19], a[120:123], v[236:239], a[16:19]
    buffer_store_dwordx4 v[32:35], v6, s[16:19], s83 offen offset:128 nt
    ds_read_b64_tr_b16 a[152:153], v5 offset:57344
    s_not_b64 vcc, vcc
    v_mfma_f32_16x16x32_bf16 a[16:19], a[124:127], v[248:251], a[16:19]
    ds_read_b64_tr_b16 a[154:155], v5 offset:59392
    v_cndmask_b32_dpp v28, v24, v28, vcc row_ror:8 row_mask:0xf bank_mask:0xf
    v_mfma_f32_16x16x32_bf16 a[20:23], a[112:115], v[216:219], a[20:23]
    ds_read_b64_tr_b16 a[156:157], v5 offset:61440
    v_cndmask_b32_dpp v29, v25, v29, vcc row_ror:8 row_mask:0xf bank_mask:0xf
    v_mfma_f32_16x16x32_bf16 a[20:23], a[116:119], v[228:231], a[20:23]
    ds_read_b64_tr_b16 a[158:159], v5 offset:63488
    v_cndmask_b32_dpp v30, v26, v30, vcc row_ror:8 row_mask:0xf bank_mask:0xf
    v_mfma_f32_16x16x32_bf16 a[20:23], a[120:123], v[240:243], a[20:23]
    v_cndmask_b32_dpp v31, v27, v31, vcc row_ror:8 row_mask:0xf bank_mask:0xf
    v_mfma_f32_16x16x32_bf16 a[20:23], a[124:127], v[252:255], a[20:23]
    s_waitcnt vmcnt(15)
    buffer_store_dwordx4 v[28:31], v6, s[16:19], s84 offen offset:128 nt
    v_mfma_f32_16x16x32_bf16 a[24:27], a[128:131], v[208:211], a[24:27]
    s_waitcnt lgkmcnt(6)
    v_add_u32 v5, 0x10000, v5
    v_mfma_f32_16x16x32_bf16 a[24:27], a[132:135], v[220:223], a[24:27]
    s_barrier
    v_mfma_f32_16x16x32_bf16 a[24:27], a[136:139], v[232:235], a[24:27]
    ds_read_b64_tr_b16 a[96:97], v2 offset:0
    v_mfma_f32_16x16x32_bf16 a[24:27], a[140:143], v[244:247], a[24:27]
    ds_read_b64_tr_b16 a[98:99], v2 offset:2048
    v_mfma_f32_16x16x32_bf16 a[28:31], a[128:131], v[212:215], a[28:31]
    ds_read_b64_tr_b16 a[100:101], v2 offset:4096
    v_mfma_f32_16x16x32_bf16 a[28:31], a[132:135], v[224:227], a[28:31]
    ds_read_b64_tr_b16 a[102:103], v2 offset:6144
    v_mfma_f32_16x16x32_bf16 a[28:31], a[136:139], v[236:239], a[28:31]
    ds_read_b64_tr_b16 a[104:105], v2 offset:8192
    v_mfma_f32_16x16x32_bf16 a[28:31], a[140:143], v[248:251], a[28:31]
    ds_read_b64_tr_b16 a[106:107], v2 offset:10240
    v_mfma_f32_16x16x32_bf16 a[32:35], a[128:131], v[216:219], a[32:35]
    buffer_store_dwordx4 a[184:187], v6, s[16:19], s81 offen offset:0 nt
    ds_read_b64_tr_b16 a[108:109], v2 offset:12288
    v_mfma_f32_16x16x32_bf16 a[32:35], a[132:135], v[228:231], a[32:35]
    ds_read_b64_tr_b16 a[110:111], v2 offset:14336
    v_mfma_f32_16x16x32_bf16 a[32:35], a[136:139], v[240:243], a[32:35]
    v_mov_b32 v53, s32
    v_mov_b32 v54, s23
    v_mfma_f32_16x16x32_bf16 a[32:35], a[140:143], v[252:255], a[32:35]
    ds_write_b32 v54, v53 offset:32768
    v_mfma_f32_16x16x32_bf16 a[36:39], a[144:147], v[208:211], a[36:39]
    s_waitcnt lgkmcnt(6)
    v_and_b32 v55, 3, v13
    v_mfma_f32_16x16x32_bf16 a[36:39], a[148:151], v[220:223], a[36:39]
    v_lshlrev_b32 v55, 12, v55
    v_mfma_f32_16x16x32_bf16 a[36:39], a[152:155], v[232:235], a[36:39]
    ds_read_b64_tr_b16 a[112:113], v3 offset:0
    v_mfma_f32_16x16x32_bf16 a[36:39], a[156:159], v[244:247], a[36:39]
    ds_read_b64_tr_b16 a[114:115], v3 offset:2048
    v_mfma_f32_16x16x32_bf16 a[40:43], a[144:147], v[212:215], a[40:43]
    ds_read_b64_tr_b16 a[116:117], v3 offset:4096
    v_mfma_f32_16x16x32_bf16 a[40:43], a[148:151], v[224:227], a[40:43]
    ds_read_b64_tr_b16 a[118:119], v3 offset:6144
    v_mfma_f32_16x16x32_bf16 a[40:43], a[152:155], v[236:239], a[40:43]
    ds_read_b64_tr_b16 a[120:121], v3 offset:8192
    v_mfma_f32_16x16x32_bf16 a[40:43], a[156:159], v[248:251], a[40:43]
    ds_read_b64_tr_b16 a[122:123], v3 offset:10240
    v_accvgpr_read_b32 v16, a0
    v_mfma_f32_16x16x32_bf16 a[44:47], a[144:147], v[216:219], a[44:47]
    ds_read_b64_tr_b16 a[124:125], v3 offset:12288
    v_accvgpr_read_b32 v17, a1
    v_mfma_f32_16x16x32_bf16 a[44:47], a[148:151], v[228:231], a[44:47]
    ds_read_b64_tr_b16 a[126:127], v3 offset:14336
    v_accvgpr_read_b32 v18, a2
    v_mfma_f32_16x16x32_bf16 a[44:47], a[152:155], v[240:243], a[44:47]
    v_accvgpr_read_b32 v19, a3
    v_accvgpr_read_b32 v20, a12
    v_mfma_f32_16x16x32_bf16 a[44:47], a[156:159], v[252:255], a[44:47]
    v_accvgpr_read_b32 v21, a13
    v_accvgpr_read_b32 v22, a14
    v_mfma_f32_16x16x32_bf16 a[48:51], a[96:99], v[64:67], 0
    s_waitcnt lgkmcnt(6)
    v_accvgpr_read_b32 v23, a15
    v_mul_f32 v16, v16, v7
    v_mfma_f32_16x16x32_bf16 a[48:51], a[100:103], v[76:79], a[48:51]
    v_mul_f32 v17, v17, v7
    v_mul_f32 v18, v18, v7
    v_mfma_f32_16x16x32_bf16 a[48:51], a[104:107], v[88:91], a[48:51]
    ds_read_b64_tr_b16 a[128:129], v2 offset:16384
    v_mul_f32 v19, v19, v7
    v_mfma_f32_16x16x32_bf16 a[48:51], a[108:111], v[100:103], a[48:51]
    ds_read_b64_tr_b16 a[130:131], v2 offset:18432
    v_mul_f32 v20, v20, v7
    v_mfma_f32_16x16x32_bf16 a[52:55], a[96:99], v[68:71], 0
    ds_read_b64_tr_b16 a[132:133], v2 offset:20480
    v_mul_f32 v21, v21, v7
    v_mfma_f32_16x16x32_bf16 a[52:55], a[100:103], v[80:83], a[52:55]
    ds_read_b64_tr_b16 a[134:135], v2 offset:22528
    v_mul_f32 v22, v22, v7
    v_mfma_f32_16x16x32_bf16 a[52:55], a[104:107], v[92:95], a[52:55]
    ds_read_b64_tr_b16 a[136:137], v2 offset:24576
    v_mul_f32 v23, v23, v7
    v_mfma_f32_16x16x32_bf16 a[52:55], a[108:111], v[104:107], a[52:55]
    ds_read_b64_tr_b16 a[138:139], v2 offset:26624
    v_cvt_pk_bf16_f32 v24, v16, v17
    v_mfma_f32_16x16x32_bf16 a[56:59], a[96:99], v[72:75], 0
    ds_read_b64_tr_b16 a[140:141], v2 offset:28672
    v_cvt_pk_bf16_f32 v25, v18, v19
    v_mfma_f32_16x16x32_bf16 a[56:59], a[100:103], v[84:87], a[56:59]
    ds_read_b64_tr_b16 a[142:143], v2 offset:30720
    v_cvt_pk_bf16_f32 v26, v20, v21
    v_mfma_f32_16x16x32_bf16 a[56:59], a[104:107], v[96:99], a[56:59]
    v_cvt_pk_bf16_f32 v27, v22, v23
    v_mfma_f32_16x16x32_bf16 a[56:59], a[108:111], v[108:111], a[56:59]
    v_permlane16_swap_b32 v24, v26
    v_mfma_f32_16x16x32_bf16 a[60:63], a[112:115], v[64:67], 0
    s_waitcnt lgkmcnt(6)
    v_permlane16_swap_b32 v25, v27
    v_mfma_f32_16x16x32_bf16 a[60:63], a[116:119], v[76:79], a[60:63]
    v_accvgpr_read_b32 v16, a24
    v_accvgpr_read_b32 v17, a25
    v_mfma_f32_16x16x32_bf16 a[60:63], a[120:123], v[88:91], a[60:63]
    ds_read_b64_tr_b16 a[144:145], v3 offset:16384
    v_accvgpr_read_b32 v18, a26
    v_mfma_f32_16x16x32_bf16 a[60:63], a[124:127], v[100:103], a[60:63]
    ds_read_b64_tr_b16 a[146:147], v3 offset:18432
    v_accvgpr_read_b32 v19, a27
    v_mfma_f32_16x16x32_bf16 a[64:67], a[112:115], v[68:71], 0
    ds_read_b64_tr_b16 a[148:149], v3 offset:20480
    v_accvgpr_read_b32 v20, a36
    v_mfma_f32_16x16x32_bf16 a[64:67], a[116:119], v[80:83], a[64:67]
    ds_read_b64_tr_b16 a[150:151], v3 offset:22528
    v_accvgpr_read_b32 v21, a37
    v_mfma_f32_16x16x32_bf16 a[64:67], a[120:123], v[92:95], a[64:67]
    ds_read_b64_tr_b16 a[152:153], v3 offset:24576
    v_accvgpr_read_b32 v22, a38
    v_mfma_f32_16x16x32_bf16 a[64:67], a[124:127], v[104:107], a[64:67]
    ds_read_b64_tr_b16 a[154:155], v3 offset:26624
    v_accvgpr_read_b32 v23, a39
    v_mfma_f32_16x16x32_bf16 a[68:71], a[112:115], v[72:75], 0
    ds_read_b64_tr_b16 a[156:157], v3 offset:28672
    v_mul_f32 v16, v16, v7
    v_mfma_f32_16x16x32_bf16 a[68:71], a[116:119], v[84:87], a[68:71]
    ds_read_b64_tr_b16 a[158:159], v3 offset:30720
    v_mul_f32 v17, v17, v7
    v_mfma_f32_16x16x32_bf16 a[68:71], a[120:123], v[96:99], a[68:71]
    v_mul_f32 v18, v18, v7
    v_mul_f32 v19, v19, v7
    v_mfma_f32_16x16x32_bf16 a[68:71], a[124:127], v[108:111], a[68:71]
    s_waitcnt vmcnt(13)
    v_mul_f32 v20, v20, v7
    v_mul_f32 v21, v21, v7
    v_mfma_f32_16x16x32_bf16 a[48:51], a[128:131], v[112:115], a[48:51]
    s_waitcnt lgkmcnt(6)
    buffer_store_dwordx4 a[188:191], v6, s[16:19], s82 offen offset:0 nt
    v_mul_f32 v22, v22, v7
    v_mul_f32 v23, v23, v7
    v_cvt_pk_bf16_f32 v28, v16, v17
    v_mfma_f32_16x16x32_bf16 a[48:51], a[132:135], v[124:127], a[48:51]
    s_barrier
    v_cvt_pk_bf16_f32 v29, v18, v19
    v_cvt_pk_bf16_f32 v30, v20, v21
    v_mfma_f32_16x16x32_bf16 a[48:51], a[136:139], v[136:139], a[48:51]
    ds_read_b64_tr_b16 a[96:97], v36 offset:0
    v_cvt_pk_bf16_f32 v31, v22, v23
    v_mfma_f32_16x16x32_bf16 a[48:51], a[140:143], v[148:151], a[48:51]
    v_permlane16_swap_b32 v28, v30
    v_mfma_f32_16x16x32_bf16 a[52:55], a[128:131], v[116:119], a[52:55]
    ds_read_b64_tr_b16 a[98:99], v36 offset:2048
    ds_read_b64_tr_b16 a[100:101], v36 offset:4096
    v_mfma_f32_16x16x32_bf16 a[52:55], a[132:135], v[128:131], a[52:55]
    v_permlane16_swap_b32 v29, v31
    v_mfma_f32_16x16x32_bf16 a[52:55], a[136:139], v[140:143], a[52:55]
    ds_read_b64_tr_b16 a[102:103], v36 offset:6144
    ds_read_b64_tr_b16 a[104:105], v36 offset:8192
    v_mfma_f32_16x16x32_bf16 a[52:55], a[140:143], v[152:155], a[52:55]
    ds_read_b64_tr_b16 a[106:107], v36 offset:10240
    s_mov_b64 vcc, s[86:87]
    v_mfma_f32_16x16x32_bf16 a[56:59], a[128:131], v[120:123], a[56:59]
    ds_read_b64_tr_b16 a[108:109], v36 offset:12288
    v_cndmask_b32_dpp v32, v28, v24, vcc row_ror:8 row_mask:0xf bank_mask:0xf
    v_mfma_f32_16x16x32_bf16 a[56:59], a[132:135], v[132:135], a[56:59]
    ds_read_b64_tr_b16 a[110:111], v36 offset:14336
    v_cndmask_b32_dpp v33, v29, v25, vcc row_ror:8 row_mask:0xf bank_mask:0xf
    v_mfma_f32_16x16x32_bf16 a[56:59], a[136:139], v[144:147], a[56:59]
    v_cndmask_b32_dpp v34, v30, v26, vcc row_ror:8 row_mask:0xf bank_mask:0xf
    v_cndmask_b32_dpp v35, v31, v27, vcc row_ror:8 row_mask:0xf bank_mask:0xf
    v_mfma_f32_16x16x32_bf16 a[56:59], a[140:143], v[156:159], a[56:59]
    buffer_store_dwordx4 v[32:35], v6, s[16:19], 0 offen offset:256 nt
    s_not_b64 vcc, vcc
    v_mfma_f32_16x16x32_bf16 a[60:63], a[144:147], v[112:115], a[60:63]
    s_waitcnt lgkmcnt(6)
    v_cndmask_b32_dpp v28, v24, v28, vcc row_ror:8 row_mask:0xf bank_mask:0xf
    v_cndmask_b32_dpp v29, v25, v29, vcc row_ror:8 row_mask:0xf bank_mask:0xf
    v_mfma_f32_16x16x32_bf16 a[60:63], a[148:151], v[124:127], a[60:63]
    v_cndmask_b32_dpp v30, v26, v30, vcc row_ror:8 row_mask:0xf bank_mask:0xf
    v_cndmask_b32_dpp v31, v27, v31, vcc row_ror:8 row_mask:0xf bank_mask:0xf
    v_mfma_f32_16x16x32_bf16 a[60:63], a[152:155], v[136:139], a[60:63]
    buffer_store_dwordx4 v[28:31], v6, s[16:19], s80 offen offset:256 nt
    ds_read_b64_tr_b16 a[112:113], v37 offset:0
    v_accvgpr_read_b32 v16, a4
    v_accvgpr_read_b32 v17, a5
    v_mfma_f32_16x16x32_bf16 a[60:63], a[156:159], v[148:151], a[60:63]
    ds_read_b64_tr_b16 a[114:115], v37 offset:2048
    v_accvgpr_read_b32 v18, a6
    v_mfma_f32_16x16x32_bf16 a[64:67], a[144:147], v[116:119], a[64:67]
    ds_read_b64_tr_b16 a[116:117], v37 offset:4096
    v_accvgpr_read_b32 v19, a7
    v_mfma_f32_16x16x32_bf16 a[64:67], a[148:151], v[128:131], a[64:67]
    ds_read_b64_tr_b16 a[118:119], v37 offset:6144
    v_accvgpr_read_b32 v20, a16
    v_mfma_f32_16x16x32_bf16 a[64:67], a[152:155], v[140:143], a[64:67]
    ds_read_b64_tr_b16 a[120:121], v37 offset:8192
    v_accvgpr_read_b32 v21, a17
    v_mfma_f32_16x16x32_bf16 a[64:67], a[156:159], v[152:155], a[64:67]
    ds_read_b64_tr_b16 a[122:123], v37 offset:10240
    v_accvgpr_read_b32 v22, a18
    v_mfma_f32_16x16x32_bf16 a[68:71], a[144:147], v[120:123], a[68:71]
    ds_read_b64_tr_b16 a[124:125], v37 offset:12288
    v_accvgpr_read_b32 v23, a19
    v_mfma_f32_16x16x32_bf16 a[68:71], a[148:151], v[132:135], a[68:71]
    ds_read_b64_tr_b16 a[126:127], v37 offset:14336
    v_mul_f32 v16, v16, v8
    v_mfma_f32_16x16x32_bf16 a[68:71], a[152:155], v[144:147], a[68:71]
    v_mul_f32 v17, v17, v8
    v_mul_f32 v18, v18, v8
    v_mfma_f32_16x16x32_bf16 a[68:71], a[156:159], v[156:159], a[68:71]
    s_waitcnt vmcnt(12)
    v_mul_f32 v19, v19, v8
    v_mul_f32 v20, v20, v8
    v_mfma_f32_16x16x32_bf16 a[48:51], a[96:99], v[160:163], a[48:51]
    s_waitcnt lgkmcnt(6)
    v_mul_f32 v21, v21, v8
    v_mul_f32 v22, v22, v8
    v_mfma_f32_16x16x32_bf16 a[48:51], a[100:103], v[172:175], a[48:51]
    s_barrier
    v_mul_f32 v23, v23, v8
    v_cvt_pk_bf16_f32 v24, v16, v17
    v_mfma_f32_16x16x32_bf16 a[48:51], a[104:107], v[184:187], a[48:51]
    ds_read_b64_tr_b16 a[128:129], v36 offset:16384
    v_cvt_pk_bf16_f32 v25, v18, v19
    v_mfma_f32_16x16x32_bf16 a[48:51], a[108:111], v[196:199], a[48:51]
    ds_read_b64_tr_b16 a[130:131], v36 offset:18432
    v_cvt_pk_bf16_f32 v26, v20, v21
    v_mfma_f32_16x16x32_bf16 a[52:55], a[96:99], v[164:167], a[52:55]
    ds_read_b64_tr_b16 a[132:133], v36 offset:20480
    v_cvt_pk_bf16_f32 v27, v22, v23
    v_mfma_f32_16x16x32_bf16 a[52:55], a[100:103], v[176:179], a[52:55]
    ds_read_b64_tr_b16 a[134:135], v36 offset:22528
    v_accvgpr_read_b32 v16, a28
    v_mfma_f32_16x16x32_bf16 a[52:55], a[104:107], v[188:191], a[52:55]
    ds_read_b64_tr_b16 a[136:137], v36 offset:24576
    v_accvgpr_read_b32 v17, a29
    v_mfma_f32_16x16x32_bf16 a[52:55], a[108:111], v[200:203], a[52:55]
    ds_read_b64_tr_b16 a[138:139], v36 offset:26624
    v_accvgpr_read_b32 v18, a30
    v_mfma_f32_16x16x32_bf16 a[56:59], a[96:99], v[168:171], a[56:59]
    ds_read_b64_tr_b16 a[140:141], v36 offset:28672
    v_accvgpr_read_b32 v19, a31
    v_mfma_f32_16x16x32_bf16 a[56:59], a[100:103], v[180:183], a[56:59]
    ds_read_b64_tr_b16 a[142:143], v36 offset:30720
    v_accvgpr_read_b32 v20, a40
    v_mfma_f32_16x16x32_bf16 a[56:59], a[104:107], v[192:195], a[56:59]
    v_permlane16_swap_b32 v24, v26
    v_mfma_f32_16x16x32_bf16 a[56:59], a[108:111], v[204:207], a[56:59]
    v_permlane16_swap_b32 v25, v27
    v_mfma_f32_16x16x32_bf16 a[60:63], a[112:115], v[160:163], a[60:63]
    s_waitcnt lgkmcnt(6)
    v_accvgpr_read_b32 v21, a41
    v_accvgpr_read_b32 v22, a42
    v_mfma_f32_16x16x32_bf16 a[60:63], a[116:119], v[172:175], a[60:63]
    v_accvgpr_read_b32 v23, a43
    v_mul_f32 v16, v16, v8
    v_mfma_f32_16x16x32_bf16 a[60:63], a[120:123], v[184:187], a[60:63]
    ds_read_b64_tr_b16 a[144:145], v37 offset:16384
    v_mul_f32 v17, v17, v8
    v_mfma_f32_16x16x32_bf16 a[60:63], a[124:127], v[196:199], a[60:63]
    ds_read_b64_tr_b16 a[146:147], v37 offset:18432
    v_mul_f32 v18, v18, v8
    v_mfma_f32_16x16x32_bf16 a[64:67], a[112:115], v[164:167], a[64:67]
    buffer_store_dwordx4 a[192:195], v6, s[16:19], s83 offen offset:0 nt
    ds_read_b64_tr_b16 a[148:149], v37 offset:20480
    v_mul_f32 v19, v19, v8
    v_mul_f32 v20, v20, v8
    v_mfma_f32_16x16x32_bf16 a[64:67], a[116:119], v[176:179], a[64:67]
    ds_read_b64_tr_b16 a[150:151], v37 offset:22528
    v_mul_f32 v21, v21, v8
    v_mfma_f32_16x16x32_bf16 a[64:67], a[120:123], v[188:191], a[64:67]
    ds_read_b64_tr_b16 a[152:153], v37 offset:24576
    v_mul_f32 v22, v22, v8
    v_mfma_f32_16x16x32_bf16 a[64:67], a[124:127], v[200:203], a[64:67]
    ds_read_b64_tr_b16 a[154:155], v37 offset:26624
    v_mul_f32 v23, v23, v8
    v_mfma_f32_16x16x32_bf16 a[68:71], a[112:115], v[168:171], a[68:71]
    ds_read_b64_tr_b16 a[156:157], v37 offset:28672
    v_cvt_pk_bf16_f32 v28, v16, v17
    v_mfma_f32_16x16x32_bf16 a[68:71], a[116:119], v[180:183], a[68:71]
    ds_read_b64_tr_b16 a[158:159], v37 offset:30720
    v_cvt_pk_bf16_f32 v29, v18, v19
    v_mfma_f32_16x16x32_bf16 a[68:71], a[120:123], v[192:195], a[68:71]
    v_cvt_pk_bf16_f32 v30, v20, v21
    v_cvt_pk_bf16_f32 v31, v22, v23
    v_mfma_f32_16x16x32_bf16 a[68:71], a[124:127], v[204:207], a[68:71]
    v_mfma_f32_16x16x32_bf16 a[48:51], a[128:131], v[208:211], a[48:51]
    s_waitcnt lgkmcnt(6)
    v_permlane16_swap_b32 v28, v30
    v_mfma_f32_16x16x32_bf16 a[48:51], a[132:135], v[220:223], a[48:51]
    v_permlane16_swap_b32 v29, v31
    v_mfma_f32_16x16x32_bf16 a[48:51], a[136:139], v[232:235], a[48:51]
    ds_read_b64_tr_b16 a[96:97], v4 offset:0
    s_mov_b64 vcc, s[86:87]
    v_mfma_f32_16x16x32_bf16 a[48:51], a[140:143], v[244:247], a[48:51]
    ds_read_b64_tr_b16 a[98:99], v4 offset:2048
    v_cndmask_b32_dpp v32, v28, v24, vcc row_ror:8 row_mask:0xf bank_mask:0xf
    v_mfma_f32_16x16x32_bf16 a[52:55], a[128:131], v[212:215], a[52:55]
    ds_read_b64_tr_b16 a[100:101], v4 offset:4096
    v_cndmask_b32_dpp v33, v29, v25, vcc row_ror:8 row_mask:0xf bank_mask:0xf
    v_mfma_f32_16x16x32_bf16 a[52:55], a[132:135], v[224:227], a[52:55]
    ds_read_b64_tr_b16 a[102:103], v4 offset:6144
    v_cndmask_b32_dpp v34, v30, v26, vcc row_ror:8 row_mask:0xf bank_mask:0xf
    v_mfma_f32_16x16x32_bf16 a[52:55], a[136:139], v[236:239], a[52:55]
    ds_read_b64_tr_b16 a[104:105], v4 offset:8192
    v_cndmask_b32_dpp v35, v31, v27, vcc row_ror:8 row_mask:0xf bank_mask:0xf
    v_mfma_f32_16x16x32_bf16 a[52:55], a[140:143], v[248:251], a[52:55]
L_pg7:
    s_cbranch_execz L_back
    buffer_store_dwordx4 v[32:35], v6, s[16:19], s81 offen offset:256 nt
    ds_read_b64_tr_b16 a[106:107], v4 offset:10240
    s_not_b64 vcc, vcc
    v_mfma_f32_16x16x32_bf16 a[56:59], a[128:131], v[216:219], a[56:59]
    ds_read_b64_tr_b16 a[108:109], v4 offset:12288
    v_cndmask_b32_dpp v28, v24, v28, vcc row_ror:8 row_mask:0xf bank_mask:0xf
    v_cndmask_b32_dpp v29, v25, v29, vcc row_ror:8 row_mask:0xf bank_mask:0xf
    v_mfma_f32_16x16x32_bf16 a[56:59], a[132:135], v[228:231], a[56:59]
    ds_read_b64_tr_b16 a[110:111], v4 offset:14336
    v_cndmask_b32_dpp v30, v26, v30, vcc row_ror:8 row_mask:0xf bank_mask:0xf
    v_cndmask_b32_dpp v31, v27, v31, vcc row_ror:8 row_mask:0xf bank_mask:0xf
    v_mfma_f32_16x16x32_bf16 a[56:59], a[136:139], v[240:243], a[56:59]
    buffer_store_dwordx4 v[28:31], v6, s[16:19], s82 offen offset:256 nt
    v_mfma_f32_16x16x32_bf16 a[56:59], a[140:143], v[252:255], a[56:59]
    v_mfma_f32_16x16x32_bf16 a[60:63], a[144:147], v[208:211], a[60:63]
    s_waitcnt lgkmcnt(6)
    v_accvgpr_read_b32 v16, a8
    v_accvgpr_read_b32 v17, a9
    v_accvgpr_read_b32 v18, a10
    v_mfma_f32_16x16x32_bf16 a[60:63], a[148:151], v[220:223], a[60:63]
    v_accvgpr_read_b32 v19, a11
    v_accvgpr_read_b32 v20, a20
    v_accvgpr_read_b32 v21, a21
    v_mfma_f32_16x16x32_bf16 a[60:63], a[152:155], v[232:235], a[60:63]
    ds_read_b64_tr_b16 a[112:113], v5 offset:0
    v_accvgpr_read_b32 v22, a22
    v_accvgpr_read_b32 v23, a23
    v_mfma_f32_16x16x32_bf16 a[60:63], a[156:159], v[244:247], a[60:63]
    ds_read_b64_tr_b16 a[114:115], v5 offset:2048
    v_mul_f32 v16, v16, v9
    v_mul_f32 v17, v17, v9
    v_mfma_f32_16x16x32_bf16 a[64:67], a[144:147], v[212:215], a[64:67]
    ds_read_b64_tr_b16 a[116:117], v5 offset:4096
    v_mul_f32 v18, v18, v9
    v_mul_f32 v19, v19, v9
    v_mfma_f32_16x16x32_bf16 a[64:67], a[148:151], v[224:227], a[64:67]
    ds_read_b64_tr_b16 a[118:119], v5 offset:6144
    v_mul_f32 v20, v20, v9
    v_mul_f32 v21, v21, v9
    v_mfma_f32_16x16x32_bf16 a[64:67], a[152:155], v[236:239], a[64:67]
    ds_read_b64_tr_b16 a[120:121], v5 offset:8192
    v_mul_f32 v22, v22, v9
    v_mul_f32 v23, v23, v9
    v_mfma_f32_16x16x32_bf16 a[64:67], a[156:159], v[248:251], a[64:67]
    ds_read_b64_tr_b16 a[122:123], v5 offset:10240
    v_cvt_pk_bf16_f32 v24, v16, v17
    v_cvt_pk_bf16_f32 v25, v18, v19
    v_mfma_f32_16x16x32_bf16 a[68:71], a[144:147], v[216:219], a[68:71]
    ds_read_b64_tr_b16 a[124:125], v5 offset:12288
    v_cvt_pk_bf16_f32 v26, v20, v21
    v_cvt_pk_bf16_f32 v27, v22, v23
    v_mfma_f32_16x16x32_bf16 a[68:71], a[148:151], v[228:231], a[68:71]
    ds_read_b64_tr_b16 a[126:127], v5 offset:14336
    v_accvgpr_read_b32 v16, a32
    v_accvgpr_read_b32 v17, a33
    v_mfma_f32_16x16x32_bf16 a[68:71], a[152:155], v[240:243], a[68:71]
    v_permlane16_swap_b32 v24, v26
    v_accvgpr_read_b32 v18, a34
    v_mfma_f32_16x16x32_bf16 a[68:71], a[156:159], v[252:255], a[68:71]
    v_permlane16_swap_b32 v25, v27
    v_accvgpr_read_b32 v19, a35
    v_mfma_f32_16x16x32_bf16 a[72:75], a[96:99], v[64:67], 0
    s_waitcnt lgkmcnt(6)
    v_accvgpr_read_b32 v20, a44
    v_accvgpr_read_b32 v21, a45
    v_accvgpr_read_b32 v22, a46
    v_mfma_f32_16x16x32_bf16 a[72:75], a[100:103], v[76:79], a[72:75]
    v_accvgpr_read_b32 v23, a47
    v_mul_f32 v16, v16, v9
    v_mul_f32 v17, v17, v9
    v_mfma_f32_16x16x32_bf16 a[72:75], a[104:107], v[88:91], a[72:75]
    ds_read_b64_tr_b16 a[128:129], v4 offset:16384
    v_mul_f32 v18, v18, v9
    v_mul_f32 v19, v19, v9
    v_mfma_f32_16x16x32_bf16 a[72:75], a[108:111], v[100:103], a[72:75]
    ds_read_b64_tr_b16 a[130:131], v4 offset:18432
    v_mul_f32 v20, v20, v9
    v_mul_f32 v21, v21, v9
    v_mfma_f32_16x16x32_bf16 a[76:79], a[96:99], v[68:71], 0
    ds_read_b64_tr_b16 a[132:133], v4 offset:20480
    v_mul_f32 v22, v22, v9
    v_mul_f32 v23, v23, v9
    v_mfma_f32_16x16x32_bf16 a[76:79], a[100:103], v[80:83], a[76:79]
    ds_read_b64_tr_b16 a[134:135], v4 offset:22528
    v_cvt_pk_bf16_f32 v28, v16, v17
    v_cvt_pk_bf16_f32 v29, v18, v19
    v_mfma_f32_16x16x32_bf16 a[76:79], a[104:107], v[92:95], a[76:79]
    ds_read_b64_tr_b16 a[136:137], v4 offset:24576
    v_cvt_pk_bf16_f32 v30, v20, v21
    v_cvt_pk_bf16_f32 v31, v22, v23
    v_mfma_f32_16x16x32_bf16 a[76:79], a[108:111], v[104:107], a[76:79]
    ds_read_b64_tr_b16 a[138:139], v4 offset:26624
    v_accvgpr_read_b32 v16, a48
    v_accvgpr_read_b32 v17, a49
    v_mfma_f32_16x16x32_bf16 a[80:83], a[96:99], v[72:75], 0
    buffer_store_dwordx4 a[196:199], v6, s[16:19], s84 offen offset:0 nt
    ds_read_b64_tr_b16 a[140:141], v4 offset:28672
    v_permlane16_swap_b32 v28, v30
    v_mfma_f32_16x16x32_bf16 a[80:83], a[100:103], v[84:87], a[80:83]
    ds_read_b64_tr_b16 a[142:143], v4 offset:30720
    v_accvgpr_read_b32 v18, a50
    v_mfma_f32_16x16x32_bf16 a[80:83], a[104:107], v[96:99], a[80:83]
    v_permlane16_swap_b32 v29, v31
    v_mfma_f32_16x16x32_bf16 a[80:83], a[108:111], v[108:111], a[80:83]
    v_accvgpr_read_b32 v19, a51
    s_mov_b64 vcc, s[86:87]
    v_accvgpr_read_b32 v20, a60
    v_mfma_f32_16x16x32_bf16 a[84:87], a[112:115], v[64:67], 0
    s_waitcnt lgkmcnt(6)
    v_cndmask_b32_dpp v32, v28, v24, vcc row_ror:8 row_mask:0xf bank_mask:0xf
    v_accvgpr_read_b32 v21, a61
    v_cndmask_b32_dpp v33, v29, v25, vcc row_ror:8 row_mask:0xf bank_mask:0xf
    v_mfma_f32_16x16x32_bf16 a[84:87], a[116:119], v[76:79], a[84:87]
    v_cndmask_b32_dpp v34, v30, v26, vcc row_ror:8 row_mask:0xf bank_mask:0xf
    v_accvgpr_read_b32 v22, a62
    v_accvgpr_read_b32 v23, a63
    v_mfma_f32_16x16x32_bf16 a[84:87], a[120:123], v[88:91], a[84:87]
    ds_read_b64_tr_b16 a[144:145], v5 offset:16384
    v_cndmask_b32_dpp v35, v31, v27, vcc row_ror:8 row_mask:0xf bank_mask:0xf
    v_mul_f32 v16, v16, v7
    v_mfma_f32_16x16x32_bf16 a[84:87], a[124:127], v[100:103], a[84:87]
    buffer_store_dwordx4 v[32:35], v6, s[16:19], s83 offen offset:256 nt
    ds_read_b64_tr_b16 a[146:147], v5 offset:18432
    s_not_b64 vcc, vcc
    v_mul_f32 v17, v17, v7
    v_mfma_f32_16x16x32_bf16 a[88:91], a[112:115], v[68:71], 0
    ds_read_b64_tr_b16 a[148:149], v5 offset:20480
    v_cndmask_b32_dpp v28, v24, v28, vcc row_ror:8 row_mask:0xf bank_mask:0xf
    v_mfma_f32_16x16x32_bf16 a[88:91], a[116:119], v[80:83], a[88:91]
    ds_read_b64_tr_b16 a[150:151], v5 offset:22528
    v_cndmask_b32_dpp v29, v25, v29, vcc row_ror:8 row_mask:0xf bank_mask:0xf
    v_mfma_f32_16x16x32_bf16 a[88:91], a[120:123], v[92:95], a[88:91]
    ds_read_b64_tr_b16 a[152:153], v5 offset:24576
    v_mul_f32 v18, v18, v7
    v_mfma_f32_16x16x32_bf16 a[88:91], a[124:127], v[104:107], a[88:91]
    ds_read_b64_tr_b16 a[154:155], v5 offset:26624
    v_mul_f32 v19, v19, v7
    v_mfma_f32_16x16x32_bf16 a[92:95], a[112:115], v[72:75], 0
    ds_read_b64_tr_b16 a[156:157], v5 offset:28672
    v_cndmask_b32_dpp v30, v26, v30, vcc row_ror:8 row_mask:0xf bank_mask:0xf
    v_mfma_f32_16x16x32_bf16 a[92:95], a[116:119], v[84:87], a[92:95]
    ds_read_b64_tr_b16 a[158:159], v5 offset:30720
    v_cndmask_b32_dpp v31, v27, v31, vcc row_ror:8 row_mask:0xf bank_mask:0xf
    v_mfma_f32_16x16x32_bf16 a[92:95], a[120:123], v[96:99], a[92:95]
    buffer_store_dwordx4 v[28:31], v6, s[16:19], s84 offen offset:256 nt
    ds_read_b64_tr_b16 a[96:97], v38 offset:0
    v_mul_f32 v20, v20, v7
    v_mul_f32 v21, v21, v7
    v_mfma_f32_16x16x32_bf16 a[92:95], a[124:127], v[108:111], a[92:95]
    ds_read_b64_tr_b16 a[98:99], v38 offset:2048
    v_mul_f32 v22, v22, v7
    v_mfma_f32_16x16x32_bf16 a[72:75], a[128:131], v[112:115], a[72:75]
    s_waitcnt lgkmcnt(8)
    ds_read_b64_tr_b16 a[100:101], v38 offset:4096
    v_mul_f32 v23, v23, v7
    v_mfma_f32_16x16x32_bf16 a[72:75], a[132:135], v[124:127], a[72:75]
    ds_read_b64_tr_b16 a[102:103], v38 offset:6144
    v_cvt_pk_bf16_f32 v41, v16, v17
    v_mfma_f32_16x16x32_bf16 a[72:75], a[136:139], v[136:139], a[72:75]
    ds_read_b64_tr_b16 a[104:105], v38 offset:8192
    v_cvt_pk_bf16_f32 v42, v18, v19
    v_mfma_f32_16x16x32_bf16 a[72:75], a[140:143], v[148:151], a[72:75]
    ds_read_b64_tr_b16 a[106:107], v38 offset:10240
    v_cvt_pk_bf16_f32 v43, v20, v21
    v_mfma_f32_16x16x32_bf16 a[76:79], a[128:131], v[116:119], a[76:79]
    ds_read_b64_tr_b16 a[108:109], v38 offset:12288
    v_cvt_pk_bf16_f32 v44, v22, v23
    v_mfma_f32_16x16x32_bf16 a[76:79], a[132:135], v[128:131], a[76:79]
    ds_read_b64_tr_b16 a[110:111], v38 offset:14336
    v_accvgpr_read_b32 v16, a52
    v_mfma_f32_16x16x32_bf16 a[76:79], a[136:139], v[140:143], a[76:79]
    v_permlane16_swap_b32 v41, v43
    v_mfma_f32_16x16x32_bf16 a[76:79], a[140:143], v[152:155], a[76:79]
    v_permlane16_swap_b32 v42, v44
    v_mfma_f32_16x16x32_bf16 a[80:83], a[128:131], v[120:123], a[80:83]
    ds_read_b64_tr_b16 a[112:113], v38 offset:16384
    v_accvgpr_read_b32 v17, a53
    v_mfma_f32_16x16x32_bf16 a[80:83], a[132:135], v[132:135], a[80:83]
    ds_read_b64_tr_b16 a[114:115], v38 offset:18432
    v_accvgpr_read_b32 v18, a54
    v_mfma_f32_16x16x32_bf16 a[80:83], a[136:139], v[144:147], a[80:83]
    ds_read_b64_tr_b16 a[116:117], v38 offset:20480
    v_accvgpr_read_b32 v19, a55
    v_mfma_f32_16x16x32_bf16 a[80:83], a[140:143], v[156:159], a[80:83]
    ds_read_b64_tr_b16 a[118:119], v38 offset:22528
    v_accvgpr_read_b32 v20, a64
    v_mfma_f32_16x16x32_bf16 a[84:87], a[144:147], v[112:115], a[84:87]
    s_waitcnt lgkmcnt(6)
    ds_read_b64_tr_b16 a[120:121], v38 offset:24576
    v_accvgpr_read_b32 v21, a65
    v_mfma_f32_16x16x32_bf16 a[84:87], a[148:151], v[124:127], a[84:87]
    ds_read_b64_tr_b16 a[122:123], v38 offset:26624
    v_accvgpr_read_b32 v22, a66
    v_mfma_f32_16x16x32_bf16 a[84:87], a[152:155], v[136:139], a[84:87]
    ds_read_b64_tr_b16 a[124:125], v38 offset:28672
    v_accvgpr_read_b32 v23, a67
    v_mfma_f32_16x16x32_bf16 a[84:87], a[156:159], v[148:151], a[84:87]
    ds_read_b64_tr_b16 a[126:127], v38 offset:30720
    v_mul_f32 v16, v16, v8
    v_mfma_f32_16x16x32_bf16 a[88:91], a[144:147], v[116:119], a[88:91]
    ds_read_b64_tr_b16 a[128:129], v39 offset:0
    v_mul_f32 v17, v17, v8
    v_mfma_f32_16x16x32_bf16 a[88:91], a[148:151], v[128:131], a[88:91]
    ds_read_b64_tr_b16 a[130:131], v39 offset:2048
    v_mul_f32 v18, v18, v8
    v_mfma_f32_16x16x32_bf16 a[88:91], a[152:155], v[140:143], a[88:91]
    ds_read_b64_tr_b16 a[132:133], v39 offset:4096
    v_mul_f32 v19, v19, v8
    v_mfma_f32_16x16x32_bf16 a[88:91], a[156:159], v[152:155], a[88:91]
    ds_read_b64_tr_b16 a[134:135], v39 offset:6144
    v_mul_f32 v20, v20, v8
    v_mfma_f32_16x16x32_bf16 a[92:95], a[144:147], v[120:123], a[92:95]
    ds_read_b64_tr_b16 a[136:137], v39 offset:8192
    v_mul_f32 v21, v21, v8
    v_mfma_f32_16x16x32_bf16 a[92:95], a[148:151], v[132:135], a[92:95]
    ds_read_b64_tr_b16 a[138:139], v39 offset:10240
    v_mul_f32 v22, v22, v8
    v_mfma_f32_16x16x32_bf16 a[92:95], a[152:155], v[144:147], a[92:95]
    ds_read_b64_tr_b16 a[140:141], v39 offset:12288
    v_mul_f32 v23, v23, v8
    v_mfma_f32_16x16x32_bf16 a[92:95], a[156:159], v[156:159], a[92:95]
    ds_read_b64_tr_b16 a[142:143], v39 offset:14336
    v_cvt_pk_bf16_f32 v45, v16, v17
    v_mfma_f32_16x16x32_bf16 a[72:75], a[96:99], v[160:163], a[72:75]
    ds_read_b64_tr_b16 a[144:145], v39 offset:16384
    v_cvt_pk_bf16_f32 v46, v18, v19
    v_mfma_f32_16x16x32_bf16 a[72:75], a[100:103], v[172:175], a[72:75]
    ds_read_b64_tr_b16 a[146:147], v39 offset:18432
    v_cvt_pk_bf16_f32 v47, v20, v21
    v_mfma_f32_16x16x32_bf16 a[72:75], a[104:107], v[184:187], a[72:75]
    s_waitcnt lgkmcnt(8)
    ds_read_b64_tr_b16 a[148:149], v39 offset:20480
    v_cvt_pk_bf16_f32 v48, v22, v23
    v_mfma_f32_16x16x32_bf16 a[72:75], a[108:111], v[196:199], a[72:75]
    ds_read_b64_tr_b16 a[150:151], v39 offset:22528
    v_accvgpr_read_b32 v16, a56
    v_mfma_f32_16x16x32_bf16 a[72:75], a[112:115], v[208:211], a[72:75]
    ds_read_b64_tr_b16 a[152:153], v39 offset:24576
    v_accvgpr_read_b32 v17, a57
    v_mfma_f32_16x16x32_bf16 a[72:75], a[116:119], v[220:223], a[72:75]
    ds_read_b64_tr_b16 a[154:155], v39 offset:26624
    v_accvgpr_read_b32 v18, a58
    v_mfma_f32_16x16x32_bf16 a[72:75], a[120:123], v[232:235], a[72:75]
    ds_read_b64_tr_b16 a[156:157], v39 offset:28672
    v_accvgpr_read_b32 v19, a59
    v_mfma_f32_16x16x32_bf16 a[72:75], a[124:127], v[244:247], a[72:75]
    ds_read_b64_tr_b16 a[158:159], v39 offset:30720
    v_accvgpr_read_b32 v20, a68
    v_mfma_f32_16x16x32_bf16 a[84:87], a[128:131], v[160:163], a[84:87]
    s_waitcnt lgkmcnt(8)
    v_permlane16_swap_b32 v45, v47
    v_mfma_f32_16x16x32_bf16 a[84:87], a[132:135], v[172:175], a[84:87]
    v_permlane16_swap_b32 v46, v48
    v_mfma_f32_16x16x32_bf16 a[84:87], a[136:139], v[184:187], a[84:87]
    v_accvgpr_read_b32 v21, a69
    v_accvgpr_read_b32 v22, a70
    v_mfma_f32_16x16x32_bf16 a[84:87], a[140:143], v[196:199], a[84:87]
    s_waitcnt lgkmcnt(4)
    v_accvgpr_read_b32 v23, a71
    v_mul_f32 v16, v16, v9
    v_mfma_f32_16x16x32_bf16 a[84:87], a[144:147], v[208:211], a[84:87]
    v_mul_f32 v17, v17, v9
    v_mul_f32 v18, v18, v9
    v_mfma_f32_16x16x32_bf16 a[84:87], a[148:151], v[220:223], a[84:87]
    s_waitcnt lgkmcnt(2)
    v_mul_f32 v19, v19, v9
    v_mul_f32 v20, v20, v9
    v_mfma_f32_16x16x32_bf16 a[84:87], a[152:155], v[232:235], a[84:87]
    s_waitcnt lgkmcnt(0)
    ds_read_b32 v53, v55 offset:32768
    v_mul_f32 v21, v21, v9
    v_mfma_f32_16x16x32_bf16 a[84:87], a[156:159], v[244:247], a[84:87]
    v_mul_f32 v22, v22, v9
    v_mul_f32 v23, v23, v9
    v_mfma_f32_16x16x32_bf16 a[76:79], a[96:99], v[164:167], a[76:79]
    v_cvt_pk_bf16_f32 v49, v16, v17
    v_cvt_pk_bf16_f32 v50, v18, v19
    v_mfma_f32_16x16x32_bf16 a[76:79], a[100:103], v[176:179], a[76:79]
    v_cvt_pk_bf16_f32 v51, v20, v21
    v_cvt_pk_bf16_f32 v52, v22, v23
    v_mfma_f32_16x16x32_bf16 a[76:79], a[104:107], v[188:191], a[76:79]
    v_accvgpr_read_b32 v64, a72
    v_accvgpr_read_b32 v65, a73
    v_mfma_f32_16x16x32_bf16 a[76:79], a[108:111], v[200:203], a[76:79]
    v_permlane16_swap_b32 v49, v51
    v_mfma_f32_16x16x32_bf16 a[76:79], a[112:115], v[212:215], a[76:79]
    v_permlane16_swap_b32 v50, v52
    v_mfma_f32_16x16x32_bf16 a[76:79], a[116:119], v[224:227], a[76:79]
    v_accvgpr_read_b32 v66, a74
    v_accvgpr_read_b32 v67, a75
    v_mfma_f32_16x16x32_bf16 a[76:79], a[120:123], v[236:239], a[76:79]
    v_accvgpr_read_b32 v68, a84
    v_accvgpr_read_b32 v69, a85
    v_mfma_f32_16x16x32_bf16 a[76:79], a[124:127], v[248:251], a[76:79]
    v_accvgpr_read_b32 v70, a86
    v_accvgpr_read_b32 v71, a87
    v_mfma_f32_16x16x32_bf16 a[88:91], a[128:131], v[164:167], a[88:91]
    s_waitcnt lgkmcnt(0)
    v_mul_f32 v64, v64, v7
    v_mul_f32 v65, v65, v7
    v_mfma_f32_16x16x32_bf16 a[88:91], a[132:135], v[176:179], a[88:91]
    v_mul_f32 v66, v66, v7
    v_mul_f32 v67, v67, v7
    v_mfma_f32_16x16x32_bf16 a[88:91], a[136:139], v[188:191], a[88:91]
    v_cmp_ne_u32 s[96:97], 0, v53
    v_mul_f32 v68, v68, v7
    v_mfma_f32_16x16x32_bf16 a[88:91], a[140:143], v[200:203], a[88:91]
    v_mul_f32 v69, v69, v7
    v_mul_f32 v70, v70, v7
    v_mfma_f32_16x16x32_bf16 a[88:91], a[144:147], v[212:215], a[88:91]
    v_mul_f32 v71, v71, v7
    v_cvt_pk_bf16_f32 v72, v64, v65
    v_mfma_f32_16x16x32_bf16 a[88:91], a[148:151], v[224:227], a[88:91]
    v_cvt_pk_bf16_f32 v73, v66, v67
    v_cvt_pk_bf16_f32 v74, v68, v69
    v_mfma_f32_16x16x32_bf16 a[88:91], a[152:155], v[236:239], a[88:91]
    v_cvt_pk_bf16_f32 v75, v70, v71
    v_accvgpr_read_b32 v80, a76
    v_mfma_f32_16x16x32_bf16 a[88:91], a[156:159], v[248:251], a[88:91]
    v_permlane16_swap_b32 v72, v74
    v_mfma_f32_16x16x32_bf16 a[80:83], a[96:99], v[168:171], a[80:83]
    v_permlane16_swap_b32 v73, v75
    v_mfma_f32_16x16x32_bf16 a[80:83], a[100:103], v[180:183], a[80:83]
    s_mov_b64 vcc, s[86:87]
    v_accvgpr_read_b32 v81, a77
    v_mfma_f32_16x16x32_bf16 a[80:83], a[104:107], v[192:195], a[80:83]
    v_cndmask_b32_dpp v76, v72, v41, vcc row_ror:8 row_mask:0xf bank_mask:0xf
    v_cndmask_b32_dpp v77, v73, v42, vcc row_ror:8 row_mask:0xf bank_mask:0xf
    v_mfma_f32_16x16x32_bf16 a[80:83], a[108:111], v[204:207], a[80:83]
    v_cndmask_b32_dpp v78, v74, v43, vcc row_ror:8 row_mask:0xf bank_mask:0xf
    v_cndmask_b32_dpp v79, v75, v44, vcc row_ror:8 row_mask:0xf bank_mask:0xf
    v_mfma_f32_16x16x32_bf16 a[80:83], a[112:115], v[216:219], a[80:83]
    buffer_store_dwordx4 v[76:79], v6, s[16:19], 0 offen offset:384 nt
    s_not_b64 vcc, vcc
    v_accvgpr_read_b32 v82, a78
    v_accvgpr_read_b32 v83, a79
    v_mfma_f32_16x16x32_bf16 a[80:83], a[116:119], v[228:231], a[80:83]
    v_cndmask_b32_dpp v72, v41, v72, vcc row_ror:8 row_mask:0xf bank_mask:0xf
    v_cndmask_b32_dpp v73, v42, v73, vcc row_ror:8 row_mask:0xf bank_mask:0xf
    v_mfma_f32_16x16x32_bf16 a[80:83], a[120:123], v[240:243], a[80:83]
    v_cndmask_b32_dpp v74, v43, v74, vcc row_ror:8 row_mask:0xf bank_mask:0xf
    v_cndmask_b32_dpp v75, v44, v75, vcc row_ror:8 row_mask:0xf bank_mask:0xf
    v_mfma_f32_16x16x32_bf16 a[80:83], a[124:127], v[252:255], a[80:83]
    buffer_store_dwordx4 v[72:75], v6, s[16:19], s80 offen offset:384 nt
    v_accvgpr_read_b32 v84, a88
    v_accvgpr_read_b32 v85, a89
    v_accvgpr_read_b32 v86, a90
    v_mfma_f32_16x16x32_bf16 a[92:95], a[128:131], v[168:171], a[92:95]
    v_accvgpr_read_b32 v87, a91
    v_mul_f32 v80, v80, v8
    v_mfma_f32_16x16x32_bf16 a[92:95], a[132:135], v[180:183], a[92:95]
    v_mul_f32 v81, v81, v8
    v_mul_f32 v82, v82, v8
    v_mfma_f32_16x16x32_bf16 a[92:95], a[136:139], v[192:195], a[92:95]
    v_mul_f32 v83, v83, v8
    v_mul_f32 v84, v84, v8
    v_mfma_f32_16x16x32_bf16 a[92:95], a[140:143], v[204:207], a[92:95]
    v_mul_f32 v85, v85, v8
    v_mul_f32 v86, v86, v8
    v_mfma_f32_16x16x32_bf16 a[92:95], a[144:147], v[216:219], a[92:95]
    v_mul_f32 v87, v87, v8
    v_cvt_pk_bf16_f32 v88, v80, v81
    v_mfma_f32_16x16x32_bf16 a[92:95], a[148:151], v[228:231], a[92:95]
    v_cvt_pk_bf16_f32 v89, v82, v83
    v_cvt_pk_bf16_f32 v90, v84, v85
    v_mfma_f32_16x16x32_bf16 a[92:95], a[152:155], v[240:243], a[92:95]
    v_cvt_pk_bf16_f32 v91, v86, v87
    v_accvgpr_read_b32 v96, a80
    v_mfma_f32_16x16x32_bf16 a[92:95], a[156:159], v[252:255], a[92:95]
    v_permlane16_swap_b32 v88, v90
    v_permlane16_swap_b32 v89, v91
    s_mov_b64 vcc, s[86:87]
    v_accvgpr_read_b32 v97, a81
    v_cndmask_b32_dpp v92, v88, v45, vcc row_ror:8 row_mask:0xf bank_mask:0xf
    v_cndmask_b32_dpp v93, v89, v46, vcc row_ror:8 row_mask:0xf bank_mask:0xf
    v_cndmask_b32_dpp v94, v90, v47, vcc row_ror:8 row_mask:0xf bank_mask:0xf
    v_cndmask_b32_dpp v95, v91, v48, vcc row_ror:8 row_mask:0xf bank_mask:0xf
    buffer_store_dwordx4 v[92:95], v6, s[16:19], s81 offen offset:384 nt
    s_not_b64 vcc, vcc
    v_accvgpr_read_b32 v98, a82
    v_accvgpr_read_b32 v99, a83
    v_cndmask_b32_dpp v88, v45, v88, vcc row_ror:8 row_mask:0xf bank_mask:0xf
    v_cndmask_b32_dpp v89, v46, v89, vcc row_ror:8 row_mask:0xf bank_mask:0xf
    v_cndmask_b32_dpp v90, v47, v90, vcc row_ror:8 row_mask:0xf bank_mask:0xf
    v_cndmask_b32_dpp v91, v48, v91, vcc row_ror:8 row_mask:0xf bank_mask:0xf
    buffer_store_dwordx4 v[88:91], v6, s[16:19], s82 offen offset:384 nt
    v_accvgpr_read_b32 v100, a92
    v_accvgpr_read_b32 v101, a93
    v_accvgpr_read_b32 v102, a94
    v_accvgpr_read_b32 v103, a95
    v_mul_f32 v96, v96, v9
    v_mul_f32 v97, v97, v9
    v_mul_f32 v98, v98, v9
    v_mul_f32 v99, v99, v9
    v_mul_f32 v100, v100, v9
    v_mul_f32 v101, v101, v9
    v_mul_f32 v102, v102, v9
    v_mul_f32 v103, v103, v9
    v_cvt_pk_bf16_f32 v104, v96, v97
    v_cvt_pk_bf16_f32 v105, v98, v99
    v_cvt_pk_bf16_f32 v106, v100, v101
    v_cvt_pk_bf16_f32 v107, v102, v103
    s_nop 0
    v_permlane16_swap_b32 v104, v106
    v_permlane16_swap_b32 v105, v107
    s_mov_b64 vcc, s[86:87]
    v_cndmask_b32_dpp v108, v104, v49, vcc row_ror:8 row_mask:0xf bank_mask:0xf
    v_cndmask_b32_dpp v109, v105, v50, vcc row_ror:8 row_mask:0xf bank_mask:0xf
    v_cndmask_b32_dpp v110, v106, v51, vcc row_ror:8 row_mask:0xf bank_mask:0xf
    v_cndmask_b32_dpp v111, v107, v52, vcc row_ror:8 row_mask:0xf bank_mask:0xf
    buffer_store_dwordx4 v[108:111], v6, s[16:19], s83 offen offset:384 nt
    s_not_b64 vcc, vcc
    v_cndmask_b32_dpp v104, v49, v104, vcc row_ror:8 row_mask:0xf bank_mask:0xf
    v_cndmask_b32_dpp v105, v50, v105, vcc row_ror:8 row_mask:0xf bank_mask:0xf
    v_cndmask_b32_dpp v106, v51, v106, vcc row_ror:8 row_mask:0xf bank_mask:0xf
    v_cndmask_b32_dpp v107, v52, v107, vcc row_ror:8 row_mask:0xf bank_mask:0xf
    buffer_store_dwordx4 v[104:107], v6, s[16:19], s84 offen offset:384 nt
    s_cmp_lg_u64 s[96:97], 0
    s_cbranch_scc0 L_end
    s_cmp_lg_u32 s22, 0
    s_cbranch_scc1 L_end
L_codeend:
    s_waitcnt vmcnt(0)
    s_barrier
    v_and_b32 v13, 63, v0
    v_lshrrev_b32 v41, 3, v13
    v_and_b32 v42, 6, v41
    v_and_b32 v43, 7, v13
    v_xor_b32 v43, v43, v42
    v_lshlrev_b32 v43, 4, v43
    v_lshl_add_u32 v1, v41, 9, v43
    v_and_b32 v41, 15, v13
    v_lshrrev_b32 v42, 4, v13
    v_lshrrev_b32 v43, 3, v41
    v_lshlrev_b32 v43, 12, v43
    v_and_b32 v44, 7, v41
    v_lshl_add_u32 v43, v44, 7, v43
    v_and_b32 v44, 6, v41
    v_xor_b32 v44, v44, v42
    v_lshl_add_u32 v2, v44, 4, v43
    v_xor_b32 v44, 4, v44
    v_lshl_add_u32 v3, v44, 4, v43
    v_and_b32 v41, 15, v13
    v_lshrrev_b32 v42, 4, v13
    s_mul_i32 s35, s20, 48
    v_add_u32 v43, s35, v41
    v_lshlrev_b32 v43, 9, v43
    v_lshl_add_u32 v6, v42, 4, v43
    buffer_load_dwordx4 v[64:67], v6, s[4:7], 0 offen offset:0
    buffer_load_dwordx4 v[68:71], v6, s[4:7], 0 offen offset:64
    buffer_load_dwordx4 v[72:75], v6, s[4:7], 0 offen offset:128
    buffer_load_dwordx4 v[76:79], v6, s[4:7], 0 offen offset:192
    buffer_load_dwordx4 v[80:83], v6, s[4:7], 0 offen offset:256
    buffer_load_dwordx4 v[84:87], v6, s[4:7], 0 offen offset:320
    buffer_load_dwordx4 v[88:91], v6, s[4:7], 0 offen offset:384
    buffer_load_dwordx4 v[92:95], v6, s[4:7], 0 offen offset:448
    buffer_load_dwordx4 v[96:99], v6, s[4:7], s44 offen offset:0
    buffer_load_dwordx4 v[100:103], v6, s[4:7], s44 offen offset:64
    buffer_load_dwordx4 v[104:107], v6, s[4:7], s44 offen offset:128
    buffer_load_dwordx4 v[108:111], v6, s[4:7], s44 offen offset:192
    buffer_load_dwordx4 v[112:115], v6, s[4:7], s44 offen offset:256
    buffer_load_dwordx4 v[116:119], v6, s[4:7], s44 offen offset:320
    buffer_load_dwordx4 v[120:123], v6, s[4:7], s44 offen offset:384
    buffer_load_dwordx4 v[124:127], v6, s[4:7], s44 offen offset:448
    buffer_load_dwordx4 v[128:131], v6, s[4:7], s45 offen offset:0
    buffer_load_dwordx4 v[132:135], v6, s[4:7], s45 offen offset:64
    buffer_load_dwordx4 v[136:139], v6, s[4:7], s45 offen offset:128
    buffer_load_dwordx4 v[140:143], v6, s[4:7], s45 offen offset:192
    buffer_load_dwordx4 v[144:147], v6, s[4:7], s45 offen offset:256
    buffer_load_dwordx4 v[148:151], v6, s[4:7], s45 offen offset:320
    buffer_load_dwordx4 v[152:155], v6, s[4:7], s45 offen offset:384
    buffer_load_dwordx4 v[156:159], v6, s[4:7], s45 offen offset:448
    s_waitcnt vmcnt(0)
    v_lshlrev_b32 v42, 16, v64
    v_and_b32 v43, 0xffff0000, v64
    v_pk_mul_f32 v[42:43], v[42:43], s[88:89]
    v_cvt_pk_bf16_f32 v64, v42, v43
    v_lshlrev_b32 v44, 16, v65
    v_and_b32 v45, 0xffff0000, v65
    v_pk_mul_f32 v[44:45], v[44:45], s[88:89]
    v_cvt_pk_bf16_f32 v65, v44, v45
    v_lshlrev_b32 v42, 16, v66
    v_and_b32 v43, 0xffff0000, v66
    v_pk_mul_f32 v[42:43], v[42:43], s[88:89]
    v_cvt_pk_bf16_f32 v66, v42, v43
    v_lshlrev_b32 v44, 16, v67
    v_and_b32 v45, 0xffff0000, v67
    v_pk_mul_f32 v[44:45], v[44:45], s[88:89]
    v_cvt_pk_bf16_f32 v67, v44, v45
    v_accvgpr_write_b32 a0, v64
    v_accvgpr_write_b32 a1, v65
    v_accvgpr_write_b32 a2, v66
    v_accvgpr_write_b32 a3, v67
    v_lshlrev_b32 v42, 16, v68
    v_and_b32 v43, 0xffff0000, v68
    v_pk_mul_f32 v[42:43], v[42:43], s[88:89]
    v_cvt_pk_bf16_f32 v68, v42, v43
    v_lshlrev_b32 v44, 16, v69
    v_and_b32 v45, 0xffff0000, v69
    v_pk_mul_f32 v[44:45], v[44:45], s[88:89]
    v_cvt_pk_bf16_f32 v69, v44, v45
    v_lshlrev_b32 v42, 16, v70
    v_and_b32 v43, 0xffff0000, v70
    v_pk_mul_f32 v[42:43], v[42:43], s[88:89]
    v_cvt_pk_bf16_f32 v70, v42, v43
    v_lshlrev_b32 v44, 16, v71
    v_and_b32 v45, 0xffff0000, v71
    v_pk_mul_f32 v[44:45], v[44:45], s[88:89]
    v_cvt_pk_bf16_f32 v71, v44, v45
    v_accvgpr_write_b32 a4, v68
    v_accvgpr_write_b32 a5, v69
    v_accvgpr_write_b32 a6, v70
    v_accvgpr_write_b32 a7, v71
    v_lshlrev_b32 v42, 16, v72
    v_and_b32 v43, 0xffff0000, v72
    v_pk_mul_f32 v[42:43], v[42:43], s[88:89]
    v_cvt_pk_bf16_f32 v72, v42, v43
    v_lshlrev_b32 v44, 16, v73
    v_and_b32 v45, 0xffff0000, v73
    v_pk_mul_f32 v[44:45], v[44:45], s[88:89]
    v_cvt_pk_bf16_f32 v73, v44, v45
    v_lshlrev_b32 v42, 16, v74
    v_and_b32 v43, 0xffff0000, v74
    v_pk_mul_f32 v[42:43], v[42:43], s[88:89]
    v_cvt_pk_bf16_f32 v74, v42, v43
    v_lshlrev_b32 v44, 16, v75
    v_and_b32 v45, 0xffff0000, v75
    v_pk_mul_f32 v[44:45], v[44:45], s[88:89]
    v_cvt_pk_bf16_f32 v75, v44, v45
    v_accvgpr_write_b32 a8, v72
    v_accvgpr_write_b32 a9, v73
    v_accvgpr_write_b32 a10, v74
    v_accvgpr_write_b32 a11, v75
    v_lshlrev_b32 v42, 16, v76
    v_and_b32 v43, 0xffff0000, v76
    v_pk_mul_f32 v[42:43], v[42:43], s[88:89]
    v_cvt_pk_bf16_f32 v76, v42, v43
    v_lshlrev_b32 v44, 16, v77
    v_and_b32 v45, 0xffff0000, v77
    v_pk_mul_f32 v[44:45], v[44:45], s[88:89]
    v_cvt_pk_bf16_f32 v77, v44, v45
    v_lshlrev_b32 v42, 16, v78
    v_and_b32 v43, 0xffff0000, v78
    v_pk_mul_f32 v[42:43], v[42:43], s[88:89]
    v_cvt_pk_bf16_f32 v78, v42, v43
    v_lshlrev_b32 v44, 16, v79
    v_and_b32 v45, 0xffff0000, v79
    v_pk_mul_f32 v[44:45], v[44:45], s[88:89]
    v_cvt_pk_bf16_f32 v79, v44, v45
    v_accvgpr_write_b32 a12, v76
    v_accvgpr_write_b32 a13, v77
    v_accvgpr_write_b32 a14, v78
    v_accvgpr_write_b32 a15, v79
    v_lshlrev_b32 v42, 16, v80
    v_and_b32 v43, 0xffff0000, v80
    v_pk_mul_f32 v[42:43], v[42:43], s[88:89]
    v_cvt_pk_bf16_f32 v80, v42, v43
    v_lshlrev_b32 v44, 16, v81
    v_and_b32 v45, 0xffff0000, v81
    v_pk_mul_f32 v[44:45], v[44:45], s[88:89]
    v_cvt_pk_bf16_f32 v81, v44, v45
    v_lshlrev_b32 v42, 16, v82
    v_and_b32 v43, 0xffff0000, v82
    v_pk_mul_f32 v[42:43], v[42:43], s[88:89]
    v_cvt_pk_bf16_f32 v82, v42, v43
    v_lshlrev_b32 v44, 16, v83
    v_and_b32 v45, 0xffff0000, v83
    v_pk_mul_f32 v[44:45], v[44:45], s[88:89]
    v_cvt_pk_bf16_f32 v83, v44, v45
    v_accvgpr_write_b32 a16, v80
    v_accvgpr_write_b32 a17, v81
    v_accvgpr_write_b32 a18, v82
    v_accvgpr_write_b32 a19, v83
    v_lshlrev_b32 v42, 16, v84
    v_and_b32 v43, 0xffff0000, v84
    v_pk_mul_f32 v[42:43], v[42:43], s[88:89]
    v_cvt_pk_bf16_f32 v84, v42, v43
    v_lshlrev_b32 v44, 16, v85
    v_and_b32 v45, 0xffff0000, v85
    v_pk_mul_f32 v[44:45], v[44:45], s[88:89]
    v_cvt_pk_bf16_f32 v85, v44, v45
    v_lshlrev_b32 v42, 16, v86
    v_and_b32 v43, 0xffff0000, v86
    v_pk_mul_f32 v[42:43], v[42:43], s[88:89]
    v_cvt_pk_bf16_f32 v86, v42, v43
    v_lshlrev_b32 v44, 16, v87
    v_and_b32 v45, 0xffff0000, v87
    v_pk_mul_f32 v[44:45], v[44:45], s[88:89]
    v_cvt_pk_bf16_f32 v87, v44, v45
    v_accvgpr_write_b32 a20, v84
    v_accvgpr_write_b32 a21, v85
    v_accvgpr_write_b32 a22, v86
    v_accvgpr_write_b32 a23, v87
    v_lshlrev_b32 v42, 16, v88
    v_and_b32 v43, 0xffff0000, v88
    v_pk_mul_f32 v[42:43], v[42:43], s[88:89]
    v_cvt_pk_bf16_f32 v88, v42, v43
    v_lshlrev_b32 v44, 16, v89
    v_and_b32 v45, 0xffff0000, v89
    v_pk_mul_f32 v[44:45], v[44:45], s[88:89]
    v_cvt_pk_bf16_f32 v89, v44, v45
    v_lshlrev_b32 v42, 16, v90
    v_and_b32 v43, 0xffff0000, v90
    v_pk_mul_f32 v[42:43], v[42:43], s[88:89]
    v_cvt_pk_bf16_f32 v90, v42, v43
    v_lshlrev_b32 v44, 16, v91
    v_and_b32 v45, 0xffff0000, v91
    v_pk_mul_f32 v[44:45], v[44:45], s[88:89]
    v_cvt_pk_bf16_f32 v91, v44, v45
    v_accvgpr_write_b32 a24, v88
    v_accvgpr_write_b32 a25, v89
    v_accvgpr_write_b32 a26, v90
    v_accvgpr_write_b32 a27, v91
    v_lshlrev_b32 v42, 16, v92
    v_and_b32 v43, 0xffff0000, v92
    v_pk_mul_f32 v[42:43], v[42:43], s[88:89]
    v_cvt_pk_bf16_f32 v92, v42, v43
    v_lshlrev_b32 v44, 16, v93
    v_and_b32 v45, 0xffff0000, v93
    v_pk_mul_f32 v[44:45], v[44:45], s[88:89]
    v_cvt_pk_bf16_f32 v93, v44, v45
    v_lshlrev_b32 v42, 16, v94
    v_and_b32 v43, 0xffff0000, v94
    v_pk_mul_f32 v[42:43], v[42:43], s[88:89]
    v_cvt_pk_bf16_f32 v94, v42, v43
    v_lshlrev_b32 v44, 16, v95
    v_and_b32 v45, 0xffff0000, v95
    v_pk_mul_f32 v[44:45], v[44:45], s[88:89]
    v_cvt_pk_bf16_f32 v95, v44, v45
    v_accvgpr_write_b32 a28, v92
    v_accvgpr_write_b32 a29, v93
    v_accvgpr_write_b32 a30, v94
    v_accvgpr_write_b32 a31, v95
    v_lshlrev_b32 v42, 16, v96
    v_and_b32 v43, 0xffff0000, v96
    v_pk_mul_f32 v[42:43], v[42:43], s[88:89]
    v_cvt_pk_bf16_f32 v96, v42, v43
    v_lshlrev_b32 v44, 16, v97
    v_and_b32 v45, 0xffff0000, v97
    v_pk_mul_f32 v[44:45], v[44:45], s[88:89]
    v_cvt_pk_bf16_f32 v97, v44, v45
    v_lshlrev_b32 v42, 16, v98
    v_and_b32 v43, 0xffff0000, v98
    v_pk_mul_f32 v[42:43], v[42:43], s[88:89]
    v_cvt_pk_bf16_f32 v98, v42, v43
    v_lshlrev_b32 v44, 16, v99
    v_and_b32 v45, 0xffff0000, v99
    v_pk_mul_f32 v[44:45], v[44:45], s[88:89]
    v_cvt_pk_bf16_f32 v99, v44, v45
    v_accvgpr_write_b32 a32, v96
    v_accvgpr_write_b32 a33, v97
    v_accvgpr_write_b32 a34, v98
    v_accvgpr_write_b32 a35, v99
    v_lshlrev_b32 v42, 16, v100
    v_and_b32 v43, 0xffff0000, v100
    v_pk_mul_f32 v[42:43], v[42:43], s[88:89]
    v_cvt_pk_bf16_f32 v100, v42, v43
    v_lshlrev_b32 v44, 16, v101
    v_and_b32 v45, 0xffff0000, v101
    v_pk_mul_f32 v[44:45], v[44:45], s[88:89]
    v_cvt_pk_bf16_f32 v101, v44, v45
    v_lshlrev_b32 v42, 16, v102
    v_and_b32 v43, 0xffff0000, v102
    v_pk_mul_f32 v[42:43], v[42:43], s[88:89]
    v_cvt_pk_bf16_f32 v102, v42, v43
    v_lshlrev_b32 v44, 16, v103
    v_and_b32 v45, 0xffff0000, v103
    v_pk_mul_f32 v[44:45], v[44:45], s[88:89]
    v_cvt_pk_bf16_f32 v103, v44, v45
    v_accvgpr_write_b32 a36, v100
    v_accvgpr_write_b32 a37, v101
    v_accvgpr_write_b32 a38, v102
    v_accvgpr_write_b32 a39, v103
    v_lshlrev_b32 v42, 16, v104
    v_and_b32 v43, 0xffff0000, v104
    v_pk_mul_f32 v[42:43], v[42:43], s[88:89]
    v_cvt_pk_bf16_f32 v104, v42, v43
    v_lshlrev_b32 v44, 16, v105
    v_and_b32 v45, 0xffff0000, v105
    v_pk_mul_f32 v[44:45], v[44:45], s[88:89]
    v_cvt_pk_bf16_f32 v105, v44, v45
    v_lshlrev_b32 v42, 16, v106
    v_and_b32 v43, 0xffff0000, v106
    v_pk_mul_f32 v[42:43], v[42:43], s[88:89]
    v_cvt_pk_bf16_f32 v106, v42, v43
    v_lshlrev_b32 v44, 16, v107
    v_and_b32 v45, 0xffff0000, v107
    v_pk_mul_f32 v[44:45], v[44:45], s[88:89]
    v_cvt_pk_bf16_f32 v107, v44, v45
    v_accvgpr_write_b32 a40, v104
    v_accvgpr_write_b32 a41, v105
    v_accvgpr_write_b32 a42, v106
    v_accvgpr_write_b32 a43, v107
    v_lshlrev_b32 v42, 16, v108
    v_and_b32 v43, 0xffff0000, v108
    v_pk_mul_f32 v[42:43], v[42:43], s[88:89]
    v_cvt_pk_bf16_f32 v108, v42, v43
    v_lshlrev_b32 v44, 16, v109
    v_and_b32 v45, 0xffff0000, v109
    v_pk_mul_f32 v[44:45], v[44:45], s[88:89]
    v_cvt_pk_bf16_f32 v109, v44, v45
    v_lshlrev_b32 v42, 16, v110
    v_and_b32 v43, 0xffff0000, v110
    v_pk_mul_f32 v[42:43], v[42:43], s[88:89]
    v_cvt_pk_bf16_f32 v110, v42, v43
    v_lshlrev_b32 v44, 16, v111
    v_and_b32 v45, 0xffff0000, v111
    v_pk_mul_f32 v[44:45], v[44:45], s[88:89]
    v_cvt_pk_bf16_f32 v111, v44, v45
    v_accvgpr_write_b32 a44, v108
    v_accvgpr_write_b32 a45, v109
    v_accvgpr_write_b32 a46, v110
    v_accvgpr_write_b32 a47, v111
    v_lshlrev_b32 v42, 16, v112
    v_and_b32 v43, 0xffff0000, v112
    v_pk_mul_f32 v[42:43], v[42:43], s[88:89]
    v_cvt_pk_bf16_f32 v112, v42, v43
    v_lshlrev_b32 v44, 16, v113
    v_and_b32 v45, 0xffff0000, v113
    v_pk_mul_f32 v[44:45], v[44:45], s[88:89]
    v_cvt_pk_bf16_f32 v113, v44, v45
    v_lshlrev_b32 v42, 16, v114
    v_and_b32 v43, 0xffff0000, v114
    v_pk_mul_f32 v[42:43], v[42:43], s[88:89]
    v_cvt_pk_bf16_f32 v114, v42, v43
    v_lshlrev_b32 v44, 16, v115
    v_and_b32 v45, 0xffff0000, v115
    v_pk_mul_f32 v[44:45], v[44:45], s[88:89]
    v_cvt_pk_bf16_f32 v115, v44, v45
    v_accvgpr_write_b32 a48, v112
    v_accvgpr_write_b32 a49, v113
    v_accvgpr_write_b32 a50, v114
    v_accvgpr_write_b32 a51, v115
    v_lshlrev_b32 v42, 16, v116
    v_and_b32 v43, 0xffff0000, v116
    v_pk_mul_f32 v[42:43], v[42:43], s[88:89]
    v_cvt_pk_bf16_f32 v116, v42, v43
    v_lshlrev_b32 v44, 16, v117
    v_and_b32 v45, 0xffff0000, v117
    v_pk_mul_f32 v[44:45], v[44:45], s[88:89]
    v_cvt_pk_bf16_f32 v117, v44, v45
    v_lshlrev_b32 v42, 16, v118
    v_and_b32 v43, 0xffff0000, v118
    v_pk_mul_f32 v[42:43], v[42:43], s[88:89]
    v_cvt_pk_bf16_f32 v118, v42, v43
    v_lshlrev_b32 v44, 16, v119
    v_and_b32 v45, 0xffff0000, v119
    v_pk_mul_f32 v[44:45], v[44:45], s[88:89]
    v_cvt_pk_bf16_f32 v119, v44, v45
    v_accvgpr_write_b32 a52, v116
    v_accvgpr_write_b32 a53, v117
    v_accvgpr_write_b32 a54, v118
    v_accvgpr_write_b32 a55, v119
    v_lshlrev_b32 v42, 16, v120
    v_and_b32 v43, 0xffff0000, v120
    v_pk_mul_f32 v[42:43], v[42:43], s[88:89]
    v_cvt_pk_bf16_f32 v120, v42, v43
    v_lshlrev_b32 v44, 16, v121
    v_and_b32 v45, 0xffff0000, v121
    v_pk_mul_f32 v[44:45], v[44:45], s[88:89]
    v_cvt_pk_bf16_f32 v121, v44, v45
    v_lshlrev_b32 v42, 16, v122
    v_and_b32 v43, 0xffff0000, v122
    v_pk_mul_f32 v[42:43], v[42:43], s[88:89]
    v_cvt_pk_bf16_f32 v122, v42, v43
    v_lshlrev_b32 v44, 16, v123
    v_and_b32 v45, 0xffff0000, v123
    v_pk_mul_f32 v[44:45], v[44:45], s[88:89]
    v_cvt_pk_bf16_f32 v123, v44, v45
    v_accvgpr_write_b32 a56, v120
    v_accvgpr_write_b32 a57, v121
    v_accvgpr_write_b32 a58, v122
    v_accvgpr_write_b32 a59, v123
    v_lshlrev_b32 v42, 16, v124
    v_and_b32 v43, 0xffff0000, v124
    v_pk_mul_f32 v[42:43], v[42:43], s[88:89]
    v_cvt_pk_bf16_f32 v124, v42, v43
    v_lshlrev_b32 v44, 16, v125
    v_and_b32 v45, 0xffff0000, v125
    v_pk_mul_f32 v[44:45], v[44:45], s[88:89]
    v_cvt_pk_bf16_f32 v125, v44, v45
    v_lshlrev_b32 v42, 16, v126
    v_and_b32 v43, 0xffff0000, v126
    v_pk_mul_f32 v[42:43], v[42:43], s[88:89]
    v_cvt_pk_bf16_f32 v126, v42, v43
    v_lshlrev_b32 v44, 16, v127
    v_and_b32 v45, 0xffff0000, v127
    v_pk_mul_f32 v[44:45], v[44:45], s[88:89]
    v_cvt_pk_bf16_f32 v127, v44, v45
    v_accvgpr_write_b32 a60, v124
    v_accvgpr_write_b32 a61, v125
    v_accvgpr_write_b32 a62, v126
    v_accvgpr_write_b32 a63, v127
    v_lshlrev_b32 v42, 16, v128
    v_and_b32 v43, 0xffff0000, v128
    v_pk_mul_f32 v[42:43], v[42:43], s[88:89]
    v_cvt_pk_bf16_f32 v128, v42, v43
    v_lshlrev_b32 v44, 16, v129
    v_and_b32 v45, 0xffff0000, v129
    v_pk_mul_f32 v[44:45], v[44:45], s[88:89]
    v_cvt_pk_bf16_f32 v129, v44, v45
    v_lshlrev_b32 v42, 16, v130
    v_and_b32 v43, 0xffff0000, v130
    v_pk_mul_f32 v[42:43], v[42:43], s[88:89]
    v_cvt_pk_bf16_f32 v130, v42, v43
    v_lshlrev_b32 v44, 16, v131
    v_and_b32 v45, 0xffff0000, v131
    v_pk_mul_f32 v[44:45], v[44:45], s[88:89]
    v_cvt_pk_bf16_f32 v131, v44, v45
    v_accvgpr_write_b32 a64, v128
    v_accvgpr_write_b32 a65, v129
    v_accvgpr_write_b32 a66, v130
    v_accvgpr_write_b32 a67, v131
    v_lshlrev_b32 v42, 16, v132
    v_and_b32 v43, 0xffff0000, v132
    v_pk_mul_f32 v[42:43], v[42:43], s[88:89]
    v_cvt_pk_bf16_f32 v132, v42, v43
    v_lshlrev_b32 v44, 16, v133
    v_and_b32 v45, 0xffff0000, v133
    v_pk_mul_f32 v[44:45], v[44:45], s[88:89]
    v_cvt_pk_bf16_f32 v133, v44, v45
    v_lshlrev_b32 v42, 16, v134
    v_and_b32 v43, 0xffff0000, v134
    v_pk_mul_f32 v[42:43], v[42:43], s[88:89]
    v_cvt_pk_bf16_f32 v134, v42, v43
    v_lshlrev_b32 v44, 16, v135
    v_and_b32 v45, 0xffff0000, v135
    v_pk_mul_f32 v[44:45], v[44:45], s[88:89]
    v_cvt_pk_bf16_f32 v135, v44, v45
    v_accvgpr_write_b32 a68, v132
    v_accvgpr_write_b32 a69, v133
    v_accvgpr_write_b32 a70, v134
    v_accvgpr_write_b32 a71, v135
    v_lshlrev_b32 v42, 16, v136
    v_and_b32 v43, 0xffff0000, v136
    v_pk_mul_f32 v[42:43], v[42:43], s[88:89]
    v_cvt_pk_bf16_f32 v136, v42, v43
    v_lshlrev_b32 v44, 16, v137
    v_and_b32 v45, 0xffff0000, v137
    v_pk_mul_f32 v[44:45], v[44:45], s[88:89]
    v_cvt_pk_bf16_f32 v137, v44, v45
    v_lshlrev_b32 v42, 16, v138
    v_and_b32 v43, 0xffff0000, v138
    v_pk_mul_f32 v[42:43], v[42:43], s[88:89]
    v_cvt_pk_bf16_f32 v138, v42, v43
    v_lshlrev_b32 v44, 16, v139
    v_and_b32 v45, 0xffff0000, v139
    v_pk_mul_f32 v[44:45], v[44:45], s[88:89]
    v_cvt_pk_bf16_f32 v139, v44, v45
    v_accvgpr_write_b32 a72, v136
    v_accvgpr_write_b32 a73, v137
    v_accvgpr_write_b32 a74, v138
    v_accvgpr_write_b32 a75, v139
    v_lshlrev_b32 v42, 16, v140
    v_and_b32 v43, 0xffff0000, v140
    v_pk_mul_f32 v[42:43], v[42:43], s[88:89]
    v_cvt_pk_bf16_f32 v140, v42, v43
    v_lshlrev_b32 v44, 16, v141
    v_and_b32 v45, 0xffff0000, v141
    v_pk_mul_f32 v[44:45], v[44:45], s[88:89]
    v_cvt_pk_bf16_f32 v141, v44, v45
    v_lshlrev_b32 v42, 16, v142
    v_and_b32 v43, 0xffff0000, v142
    v_pk_mul_f32 v[42:43], v[42:43], s[88:89]
    v_cvt_pk_bf16_f32 v142, v42, v43
    v_lshlrev_b32 v44, 16, v143
    v_and_b32 v45, 0xffff0000, v143
    v_pk_mul_f32 v[44:45], v[44:45], s[88:89]
    v_cvt_pk_bf16_f32 v143, v44, v45
    v_accvgpr_write_b32 a76, v140
    v_accvgpr_write_b32 a77, v141
    v_accvgpr_write_b32 a78, v142
    v_accvgpr_write_b32 a79, v143
    v_lshlrev_b32 v42, 16, v144
    v_and_b32 v43, 0xffff0000, v144
    v_pk_mul_f32 v[42:43], v[42:43], s[88:89]
    v_cvt_pk_bf16_f32 v144, v42, v43
    v_lshlrev_b32 v44, 16, v145
    v_and_b32 v45, 0xffff0000, v145
    v_pk_mul_f32 v[44:45], v[44:45], s[88:89]
    v_cvt_pk_bf16_f32 v145, v44, v45
    v_lshlrev_b32 v42, 16, v146
    v_and_b32 v43, 0xffff0000, v146
    v_pk_mul_f32 v[42:43], v[42:43], s[88:89]
    v_cvt_pk_bf16_f32 v146, v42, v43
    v_lshlrev_b32 v44, 16, v147
    v_and_b32 v45, 0xffff0000, v147
    v_pk_mul_f32 v[44:45], v[44:45], s[88:89]
    v_cvt_pk_bf16_f32 v147, v44, v45
    v_accvgpr_write_b32 a80, v144
    v_accvgpr_write_b32 a81, v145
    v_accvgpr_write_b32 a82, v146
    v_accvgpr_write_b32 a83, v147
    v_lshlrev_b32 v42, 16, v148
    v_and_b32 v43, 0xffff0000, v148
    v_pk_mul_f32 v[42:43], v[42:43], s[88:89]
    v_cvt_pk_bf16_f32 v148, v42, v43
    v_lshlrev_b32 v44, 16, v149
    v_and_b32 v45, 0xffff0000, v149
    v_pk_mul_f32 v[44:45], v[44:45], s[88:89]
    v_cvt_pk_bf16_f32 v149, v44, v45
    v_lshlrev_b32 v42, 16, v150
    v_and_b32 v43, 0xffff0000, v150
    v_pk_mul_f32 v[42:43], v[42:43], s[88:89]
    v_cvt_pk_bf16_f32 v150, v42, v43
    v_lshlrev_b32 v44, 16, v151
    v_and_b32 v45, 0xffff0000, v151
    v_pk_mul_f32 v[44:45], v[44:45], s[88:89]
    v_cvt_pk_bf16_f32 v151, v44, v45
    v_accvgpr_write_b32 a84, v148
    v_accvgpr_write_b32 a85, v149
    v_accvgpr_write_b32 a86, v150
    v_accvgpr_write_b32 a87, v151
    v_lshlrev_b32 v42, 16, v152
    v_and_b32 v43, 0xffff0000, v152
    v_pk_mul_f32 v[42:43], v[42:43], s[88:89]
    v_cvt_pk_bf16_f32 v152, v42, v43
    v_lshlrev_b32 v44, 16, v153
    v_and_b32 v45, 0xffff0000, v153
    v_pk_mul_f32 v[44:45], v[44:45], s[88:89]
    v_cvt_pk_bf16_f32 v153, v44, v45
    v_lshlrev_b32 v42, 16, v154
    v_and_b32 v43, 0xffff0000, v154
    v_pk_mul_f32 v[42:43], v[42:43], s[88:89]
    v_cvt_pk_bf16_f32 v154, v42, v43
    v_lshlrev_b32 v44, 16, v155
    v_and_b32 v45, 0xffff0000, v155
    v_pk_mul_f32 v[44:45], v[44:45], s[88:89]
    v_cvt_pk_bf16_f32 v155, v44, v45
    v_accvgpr_write_b32 a88, v152
    v_accvgpr_write_b32 a89, v153
    v_accvgpr_write_b32 a90, v154
    v_accvgpr_write_b32 a91, v155
    v_lshlrev_b32 v42, 16, v156
    v_and_b32 v43, 0xffff0000, v156
    v_pk_mul_f32 v[42:43], v[42:43], s[88:89]
    v_cvt_pk_bf16_f32 v156, v42, v43
    v_lshlrev_b32 v44, 16, v157
    v_and_b32 v45, 0xffff0000, v157
    v_pk_mul_f32 v[44:45], v[44:45], s[88:89]
    v_cvt_pk_bf16_f32 v157, v44, v45
    v_lshlrev_b32 v42, 16, v158
    v_and_b32 v43, 0xffff0000, v158
    v_pk_mul_f32 v[42:43], v[42:43], s[88:89]
    v_cvt_pk_bf16_f32 v158, v42, v43
    v_lshlrev_b32 v44, 16, v159
    v_and_b32 v45, 0xffff0000, v159
    v_pk_mul_f32 v[44:45], v[44:45], s[88:89]
    v_cvt_pk_bf16_f32 v159, v44, v45
    v_accvgpr_write_b32 a92, v156
    v_accvgpr_write_b32 a93, v157
    v_accvgpr_write_b32 a94, v158
    v_accvgpr_write_b32 a95, v159
    v_mov_b32 v10, 0xff800000
    v_mov_b32 v11, 0xff800000
    v_mov_b32 v12, 0xff800000
    s_mov_b32 s26, s23
    s_mov_b32 s35, 16
L_slow:
    s_add_u32 m0, s23, 0
    s_nop 0
    buffer_load_dwordx4 v1, s[8:11], s26 offen offset:0 nt lds
    s_add_u32 m0, s23, 896
    s_nop 0
    buffer_load_dwordx4 v1, s[8:11], s26 offen offset:128 nt lds
    s_add_u32 m0, s23, 1792
    s_nop 0
    buffer_load_dwordx4 v1, s[8:11], s26 offen offset:256 nt lds
    s_add_u32 m0, s23, 2688
    s_nop 0
    buffer_load_dwordx4 v1, s[8:11], s26 offen offset:384 nt lds
    s_waitcnt vmcnt(0)
    s_barrier
    ds_read_b128 a[96:99], v2 offset:0
    s_waitcnt lgkmcnt(0)
    v_mfma_f32_16x16x32_bf16 v[16:19], a[96:99], a[0:3], 0
    v_mfma_f32_16x16x32_bf16 v[20:23], a[96:99], a[32:35], 0
    v_mfma_f32_16x16x32_bf16 v[24:27], a[96:99], a[64:67], 0
    ds_read_b128 a[96:99], v3 offset:0
    s_waitcnt lgkmcnt(0)
    v_mfma_f32_16x16x32_bf16 v[16:19], a[96:99], a[4:7], v[16:19]
    v_mfma_f32_16x16x32_bf16 v[20:23], a[96:99], a[36:39], v[20:23]
    v_mfma_f32_16x16x32_bf16 v[24:27], a[96:99], a[68:71], v[24:27]
    ds_read_b128 a[96:99], v2 offset:1024
    s_waitcnt lgkmcnt(0)
    v_mfma_f32_16x16x32_bf16 v[16:19], a[96:99], a[8:11], v[16:19]
    v_mfma_f32_16x16x32_bf16 v[20:23], a[96:99], a[40:43], v[20:23]
    v_mfma_f32_16x16x32_bf16 v[24:27], a[96:99], a[72:75], v[24:27]
    ds_read_b128 a[96:99], v3 offset:1024
    s_waitcnt lgkmcnt(0)
    v_mfma_f32_16x16x32_bf16 v[16:19], a[96:99], a[12:15], v[16:19]
    v_mfma_f32_16x16x32_bf16 v[20:23], a[96:99], a[44:47], v[20:23]
    v_mfma_f32_16x16x32_bf16 v[24:27], a[96:99], a[76:79], v[24:27]
    ds_read_b128 a[96:99], v2 offset:2048
    s_waitcnt lgkmcnt(0)
    v_mfma_f32_16x16x32_bf16 v[16:19], a[96:99], a[16:19], v[16:19]
    v_mfma_f32_16x16x32_bf16 v[20:23], a[96:99], a[48:51], v[20:23]
    v_mfma_f32_16x16x32_bf16 v[24:27], a[96:99], a[80:83], v[24:27]
    ds_read_b128 a[96:99], v3 offset:2048
    s_waitcnt lgkmcnt(0)
    v_mfma_f32_16x16x32_bf16 v[16:19], a[96:99], a[20:23], v[16:19]
    v_mfma_f32_16x16x32_bf16 v[20:23], a[96:99], a[52:55], v[20:23]
    v_mfma_f32_16x16x32_bf16 v[24:27], a[96:99], a[84:87], v[24:27]
    ds_read_b128 a[96:99], v2 offset:3072
    s_waitcnt lgkmcnt(0)
    v_mfma_f32_16x16x32_bf16 v[16:19], a[96:99], a[24:27], v[16:19]
    v_mfma_f32_16x16x32_bf16 v[20:23], a[96:99], a[56:59], v[20:23]
    v_mfma_f32_16x16x32_bf16 v[24:27], a[96:99], a[88:91], v[24:27]
    ds_read_b128 a[96:99], v3 offset:3072
    s_waitcnt lgkmcnt(0)
    v_mfma_f32_16x16x32_bf16 v[16:19], a[96:99], a[28:31], v[16:19]
    v_mfma_f32_16x16x32_bf16 v[20:23], a[96:99], a[60:63], v[20:23]
    v_mfma_f32_16x16x32_bf16 v[24:27], a[96:99], a[92:95], v[24:27]
    s_nop 0
    s_nop 4
    v_max3_f32 v10, v10, v16, v17
    v_max3_f32 v10, v10, v18, v19
    v_max3_f32 v11, v11, v20, v21
    v_max3_f32 v11, v11, v22, v23
    v_max3_f32 v12, v12, v24, v25
    v_max3_f32 v12, v12, v26, v27
    ds_read_b128 a[96:99], v2 offset:8192
    s_waitcnt lgkmcnt(0)
    v_mfma_f32_16x16x32_bf16 v[16:19], a[96:99], a[0:3], 0
    v_mfma_f32_16x16x32_bf16 v[20:23], a[96:99], a[32:35], 0
    v_mfma_f32_16x16x32_bf16 v[24:27], a[96:99], a[64:67], 0
    ds_read_b128 a[96:99], v3 offset:8192
    s_waitcnt lgkmcnt(0)
    v_mfma_f32_16x16x32_bf16 v[16:19], a[96:99], a[4:7], v[16:19]
    v_mfma_f32_16x16x32_bf16 v[20:23], a[96:99], a[36:39], v[20:23]
    v_mfma_f32_16x16x32_bf16 v[24:27], a[96:99], a[68:71], v[24:27]
    ds_read_b128 a[96:99], v2 offset:9216
    s_waitcnt lgkmcnt(0)
    v_mfma_f32_16x16x32_bf16 v[16:19], a[96:99], a[8:11], v[16:19]
    v_mfma_f32_16x16x32_bf16 v[20:23], a[96:99], a[40:43], v[20:23]
    v_mfma_f32_16x16x32_bf16 v[24:27], a[96:99], a[72:75], v[24:27]
    ds_read_b128 a[96:99], v3 offset:9216
    s_waitcnt lgkmcnt(0)
    v_mfma_f32_16x16x32_bf16 v[16:19], a[96:99], a[12:15], v[16:19]
    v_mfma_f32_16x16x32_bf16 v[20:23], a[96:99], a[44:47], v[20:23]
    v_mfma_f32_16x16x32_bf16 v[24:27], a[96:99], a[76:79], v[24:27]
    ds_read_b128 a[96:99], v2 offset:10240
    s_waitcnt lgkmcnt(0)
    v_mfma_f32_16x16x32_bf16 v[16:19], a[96:99], a[16:19], v[16:19]
    v_mfma_f32_16x16x32_bf16 v[20:23], a[96:99], a[48:51], v[20:23]
    v_mfma_f32_16x16x32_bf16 v[24:27], a[96:99], a[80:83], v[24:27]
    ds_read_b128 a[96:99], v3 offset:10240
    s_waitcnt lgkmcnt(0)
    v_mfma_f32_16x16x32_bf16 v[16:19], a[96:99], a[20:23], v[16:19]
    v_mfma_f32_16x16x32_bf16 v[20:23], a[96:99], a[52:55], v[20:23]
    v_mfma_f32_16x16x32_bf16 v[24:27], a[96:99], a[84:87], v[24:27]
    ds_read_b128 a[96:99], v2 offset:11264
    s_waitcnt lgkmcnt(0)
    v_mfma_f32_16x16x32_bf16 v[16:19], a[96:99], a[24:27], v[16:19]
    v_mfma_f32_16x16x32_bf16 v[20:23], a[96:99], a[56:59], v[20:23]
    v_mfma_f32_16x16x32_bf16 v[24:27], a[96:99], a[88:91], v[24:27]
    ds_read_b128 a[96:99], v3 offset:11264
    s_waitcnt lgkmcnt(0)
    v_mfma_f32_16x16x32_bf16 v[16:19], a[96:99], a[28:31], v[16:19]
    v_mfma_f32_16x16x32_bf16 v[20:23], a[96:99], a[60:63], v[20:23]
    v_mfma_f32_16x16x32_bf16 v[24:27], a[96:99], a[92:95], v[24:27]
    s_nop 0
    s_nop 4
    v_max3_f32 v10, v10, v16, v17
    v_max3_f32 v10, v10, v18, v19
    v_max3_f32 v11, v11, v20, v21
    v_max3_f32 v11, v11, v22, v23
    v_max3_f32 v12, v12, v24, v25
    v_max3_f32 v12, v12, v26, v27
    s_barrier
    s_add_u32 s26, s26, 16384
    s_sub_u32 s35, s35, 1
    s_cmp_lg_u32 s35, 0
    s_cbranch_scc1 L_slow
    v_mov_b32 v41, v10
    v_mov_b32 v42, v11
    v_mov_b32 v43, v12
    v_permlane32_swap_b32 v10, v41
    v_permlane32_swap_b32 v11, v42
    v_permlane32_swap_b32 v12, v43
    v_max_f32 v10, v10, v41
    v_max_f32 v11, v11, v42
    v_max_f32 v12, v12, v43
    v_mov_b32 v41, v10
    v_mov_b32 v42, v11
    v_mov_b32 v43, v12
    v_permlane16_swap_b32 v10, v41
    v_permlane16_swap_b32 v11, v42
    v_permlane16_swap_b32 v12, v43
    v_max_f32 v10, v10, v41
    v_max_f32 v11, v11, v42
    v_max_f32 v12, v12, v43
    v_sub_f32 v10, 0, v10
    v_sub_f32 v11, 0, v11
    v_sub_f32 v12, 0, v12
    v_and_b32 v41, 7, v13
    v_lshrrev_b32 v42, 4, v13
    s_mul_i32 s35, s20, 48
    v_add_u32 v41, s35, v41
    v_bfe_u32 v43, v13, 3, 1
    v_lshl_add_u32 v42, v43, 2, v42
    v_lshlrev_b32 v41, 9, v41
    v_lshl_add_u32 v6, v42, 4, v41
    s_mov_b32 s22, 1
    s_branch L_restart
L_end:
    s_endpgm
.section .rodata,"a"
.p2align 6
.amdhsa_kernel standalone__gqa_softmax__near_ridge_kernel
  .amdhsa_next_free_vgpr 512
  .amdhsa_next_free_sgpr 100
  .amdhsa_accum_offset 256
  .amdhsa_group_segment_fixed_size 0
  .amdhsa_kernarg_size 48
  .amdhsa_user_sgpr_count 2
  .amdhsa_user_sgpr_kernarg_segment_ptr 1
  .amdhsa_system_sgpr_workgroup_id_x 1
.end_amdhsa_kernel
```
